```python
import torch

def _softmax(x, axis=-1):
    return torch.softmax(x, dim=axis)
def _gelu(x):
    return torch.nn.functional.gelu(x, approximate="tanh")
def _silu(x):
    return torch.nn.functional.silu(x)
def _sigmoid(x):
    return torch.sigmoid(x)
def _layernorm(x, axis=-1, eps=1e-5):
    m = x.mean(dim=axis, keepdim=True)
    v = x.var(dim=axis, keepdim=True, unbiased=False)
    return (x - m) / torch.sqrt(v + eps)
def _scatter_add(tgt, idx, src, axis=0):
    return tgt.clone().index_add_(axis, idx, src)
def _segment_sum(src, seg, n):
    out = torch.zeros((n,) + src.shape[1:], dtype=src.dtype)
    return out.index_add_(0, seg, src)
def _pad(x, pw):
    flat = tuple(v for pair in reversed(pw) for v in pair)
    return torch.nn.functional.pad(x, flat)

kernel_name = 'concat_heads__mha_block__compressed_kv_cla__prompt'

def setup_inputs():

    _w = (lambda a: (lambda t: t.to(torch.bfloat16) if t.is_floating_point() else t)(torch.as_tensor(a)))
    def _A_setup():
        B, S, D, H = 1, 2048, 640, 32
        return {
            "x": _w((lambda *s: torch.randn(*s, dtype=torch.bfloat16) * 0.2)(B, S, D)),
            "wqkv": _w((lambda *s: torch.randn(*s, dtype=torch.bfloat16) * 0.2)(D, 3 * D)),
            "wo": _w((lambda *s: torch.randn(*s, dtype=torch.bfloat16) * 0.05)(D, D)),
        }
    _A_in = _A_setup()

    def _B_setup():
        B, H, Sq, Sk, D, M = 1, 32, 2048, 2048, 128, 640
        Dc = 4 * D
        return {
            "x": _w((lambda *s: torch.randn(*s, dtype=torch.bfloat16) * 0.4)(B, Sq, M)),
            "c_kv": _w((lambda *s: torch.randn(*s, dtype=torch.bfloat16) * 0.4)(B, Sk, Dc)),
            "w_q": _w((lambda *s: torch.randn(*s, dtype=torch.bfloat16) * 3.2)(M, H, D) * (M ** -0.5)),
            "w_uk": _w((lambda *s: torch.randn(*s, dtype=torch.bfloat16) * 3.2)(Dc, H, D) * (Dc ** -0.5)),
            "w_uv": _w((lambda *s: torch.randn(*s, dtype=torch.bfloat16) * 0.4)(Dc, H, D) * (Dc ** -0.5)),
            "w_o": _w((lambda *s: torch.randn(*s, dtype=torch.bfloat16) * 0.4)(H, D, M) * ((H * D) ** -0.5)),
        }
    _B_in = _B_setup()

    return {
        "A_x": _A_in["x"],
        "A_wqkv": _A_in["wqkv"],
        "A_wo": _A_in["wo"],
        "B_x": _B_in["x"],
        "B_c_kv": _B_in["c_kv"],
        "B_w_q": _B_in["w_q"],
        "B_w_uk": _B_in["w_uk"],
        "B_w_uv": _B_in["w_uv"],
        "B_w_o": _B_in["w_o"],
    }

def reference(A_x, A_wqkv, A_wo, B_x, B_c_kv, B_w_q, B_w_uk, B_w_uv, B_w_o):
    def _A_ref(x, wqkv, wo):
        B, S, D = x.shape
        H = 32
        Dh = D // H
        qkv = (lambda x, *d: x.permute(*d))((x @ wqkv).reshape(B, S, 3, H, Dh), 2, 0, 3, 1, 4)
        q, k, v = qkv[0], qkv[1], qkv[2]
        scores = torch.einsum("bhqd,bhkd->bhqk", q, k) * (Dh ** -0.5)
        p = _softmax(scores, axis=-1)
        o = torch.einsum("bhqk,bhkd->bhqd", p, v)
        return (lambda x, *d: x.permute(*d))(o, 0, 2, 1, 3).reshape(B, S, D) @ wo

    def _B_ref(x, c_kv, w_q, w_uk, w_uv, w_o):
        B, Sq, M = x.shape[0], x.shape[1], x.shape[2]
        Sk = c_kv.shape[1]
        H, D = w_q.shape[1], w_q.shape[2]
        q = torch.einsum("bqm,mhd->bhqd", x, w_q)
        k = torch.einsum("bkc,chd->bhkd", c_kv, w_uk)
        v = torch.einsum("bkc,chd->bhkd", c_kv, w_uv)
        scores = torch.einsum("bhqd,bhkd->bhqk", q, k) * (D ** -0.5)
        off = Sk - Sq
        qi = torch.arange(Sq)[:, None]
        kj = torch.arange(Sk)[None, :]
        cmask = kj <= (qi + off)
        scores = torch.where(cmask[None, None], scores, -1e9)
        p = _softmax(scores, axis=-1)
        ctx = torch.einsum("bhqk,bhkd->bhqd", p, v)
        return torch.einsum("bhqd,hdm->bqm", ctx, w_o)

    a = _A_ref(A_x, A_wqkv, A_wo)
    b = _B_ref(B_x, B_c_kv, B_w_q, B_w_uk, B_w_uv, B_w_o)
    return torch.concatenate([a, b], axis=-1)
```

```asm
; @launch kernel=proj_kernel grid=(448,1,1) block=(512,1,1) lds=131072
; @launch kernel=attn_kernel grid=(512,1,1) block=(256,1,1) lds=65536
; @launch kernel=outp_kernel grid=(320,1,1) block=(256,1,1) lds=131072
.amdgcn_target "amdgcn-amd-amdhsa--gfx950"
.text
.globl proj_kernel
.p2align 8
.type proj_kernel,@function
proj_kernel:
    s_cmp_ge_u32 s2, 448
    s_cbranch_scc1 gend_1
    s_load_dwordx16 s[16:31], s[0:1], 0
    s_load_dwordx8 s[32:39], s[0:1], 64
    s_waitcnt lgkmcnt(0)
    v_lshrrev_b32 v2, 6, v0
    s_nop 0
    v_readfirstlane_b32 s57, v2
    s_lshr_b32 s71, s57, 2
    s_mov_b32 s76, s22
    s_mov_b32 s77, s23
    s_mov_b32 s78, 0
    s_mov_b32 s81, 0
    s_cmp_eq_u32 s57, 5
    s_cselect_b32 s76, s28, s76
    s_cselect_b32 s77, s29, s77
    s_cselect_b32 s78, 4194304, s78
    s_cselect_b32 s81, 2097152, s81
    s_cmp_eq_u32 s57, 6
    s_cselect_b32 s76, s30, s76
    s_cselect_b32 s77, s31, s77
    s_cselect_b32 s78, 4194304, s78
    s_cselect_b32 s81, 3145728, s81
    s_and_b32 s77, s77, 0xffff
    s_mov_b32 s79, 0x00020000
    s_cmp_ge_u32 s2, 256
    s_cselect_b32 s78, 0, s78
    s_mul_i32 s60, s2, 2048
    s_sub_u32 s60, s60, s81
    v_and_b32 v3, 63, v0
    v_lshlrev_b32 v2, 7, v3
    v_add_u32 v2, s60, v2
    v_bfrev_b32 v4, 1
    v_cmp_gt_u32 vcc, 16, v3
    s_nop 1
    v_cndmask_b32 v61, v4, v2, vcc
    s_sub_u32 s3, s2, 128
    s_cmp_lt_u32 s3, 64
    s_cbranch_scc1 ja_8
    s_cmp_ge_u32 s2, 192
    s_cselect_b32 s3, 64, 0
    s_sub_u32 s3, s2, s3
    s_lshr_b32 s6, s3, 7
    s_and_b32 s3, s3, 127
    s_and_b32 s4, s3, 7
    s_bfe_u32 s5, s3, 0x30003
    s_lshr_b32 s3, s3, 6
    s_lshl_b32 s3, s3, 3
    s_add_u32 s4, s4, s3
    s_lshl_b32 s4, s4, 1
    s_add_u32 s4, s4, s71
    s_mul_i32 s52, s5, 256
    s_mul_i32 s53, s4, 128
    s_cmp_eq_u32 s6, 0
    s_cbranch_scc1 job_2
    s_cmp_eq_u32 s6, 1
    s_cbranch_scc1 job_3
    s_branch job_4
ja_8:
    s_and_b32 s5, s3, 7
    s_lshr_b32 s4, s3, 3
    s_lshl_b32 s4, s4, 1
    s_add_u32 s4, s4, s71
    s_min_u32 s4, s4, 14
    s_mul_i32 s52, s5, 256
    s_mul_i32 s53, s4, 128
    s_cmp_lt_u32 s4, 5
    s_cbranch_scc1 job_5
    s_cmp_lt_u32 s4, 10
    s_cbranch_scc1 job_6
    s_branch job_7
gend_1:
    s_endpgm
job_2:
    s_mov_b32 s40, s22
    s_mov_b32 s41, s23
    s_and_b32 s41, s41, 0xffff
    s_mov_b32 s42, 2621440
    s_mov_b32 s43, 0x00020000
    s_mov_b32 s44, s26
    s_mov_b32 s45, s27
    s_and_b32 s45, s45, 0xffff
    s_mov_b32 s46, 5242880
    s_mov_b32 s47, 0x00020000
    v_and_b32 v1, 63, v0
    s_and_b32 s70, s57, 3
    s_lshr_b32 s58, s70, 1
    s_and_b32 s59, s70, 1
    s_mul_i32 s72, s71, 32768
    s_add_u32 s72, s72, 65536
    v_lshrrev_b32 v2, 2, v1
    v_bfe_u32 v3, v1, 4, 2
    v_and_b32 v4, 3, v1
    v_xor_b32 v4, v4, v3
    s_mul_i32 s60, s57, 32
    s_add_u32 s60, s60, s52
    v_add_u32 v2, s60, v2
    s_mov_b32 s61, 1280
    v_mul_lo_u32 v2, v2, s61
    v_lshl_add_u32 v2, v4, 4, v2
    v_add_u32 v8, 0, v2
    v_add_u32 v9, 19456, v2
    v_lshrrev_b32 v2, 4, v1
    v_and_b32 v3, 15, v1
    v_lshrrev_b32 v4, 2, v3
    v_bfe_u32 v5, v1, 4, 2
    v_xor_b32 v4, v4, v5
    v_and_b32 v3, 3, v3
    v_lshlrev_b32 v3, 4, v3
    v_lshl_add_u32 v3, v4, 6, v3
    s_mul_i32 s60, s70, 8
    v_add_u32 v2, s60, v2
    s_mov_b32 s61, 8192
    v_mul_lo_u32 v2, v2, s61
    v_add_u32 v2, v2, v3
    s_lshl_b32 s60, s53, 1
    v_add_u32 v2, s60, v2
    v_add_u32 v12, 0, v2
    v_add_u32 v13, 31744, v2
    v_and_b32 v2, 31, v1
    v_lshrrev_b32 v3, 5, v1
    v_bfe_u32 v4, v1, 2, 2
    v_xor_b32 v4, v4, v3
    s_mul_i32 s60, s58, 128
    v_add_u32 v2, s60, v2
    v_lshlrev_b32 v2, 6, v2
    v_lshl_add_u32 v16, v4, 4, v2
    v_xor_b32 v17, 32, v16
    v_bfe_u32 v2, v1, 2, 2
    v_lshrrev_b32 v3, 5, v1
    v_lshl_add_u32 v3, v3, 3, v2
    v_mul_u32_u24 v3, 256, v3
    v_mov_b32 v4, v2
    s_mul_i32 s60, s59, 2
    v_xor_b32 v4, s60, v4
    v_lshl_add_u32 v3, v4, 6, v3
    v_bfe_u32 v4, v1, 4, 1
    v_and_b32 v5, 3, v1
    v_lshlrev_b32 v5, 3, v5
    v_lshl_add_u32 v5, v4, 5, v5
    v_add_u32 v3, v3, v5
    v_add_u32 v18, s72, v3
    v_xor_b32 v19, 64, v18
    s_mul_i32 s62, s57, 2048
    s_mul_i32 s63, s70, 2048
    s_add_u32 s63, s63, s72
    s_mov_b32 s54, 0
    s_mov_b32 s55, 0
    v_mov_b32 v64, 0
    v_mov_b32 v65, 0
    v_mov_b32 v66, 0
    v_mov_b32 v67, 0
    v_mov_b32 v68, 0
    v_mov_b32 v69, 0
    v_mov_b32 v70, 0
    v_mov_b32 v71, 0
    v_mov_b32 v72, 0
    v_mov_b32 v73, 0
    v_mov_b32 v74, 0
    v_mov_b32 v75, 0
    v_mov_b32 v76, 0
    v_mov_b32 v77, 0
    v_mov_b32 v78, 0
    v_mov_b32 v79, 0
    v_mov_b32 v80, 0
    v_mov_b32 v81, 0
    v_mov_b32 v82, 0
    v_mov_b32 v83, 0
    v_mov_b32 v84, 0
    v_mov_b32 v85, 0
    v_mov_b32 v86, 0
    v_mov_b32 v87, 0
    v_mov_b32 v88, 0
    v_mov_b32 v89, 0
    v_mov_b32 v90, 0
    v_mov_b32 v91, 0
    v_mov_b32 v92, 0
    v_mov_b32 v93, 0
    v_mov_b32 v94, 0
    v_mov_b32 v95, 0
    v_mov_b32 v96, 0
    v_mov_b32 v97, 0
    v_mov_b32 v98, 0
    v_mov_b32 v99, 0
    v_mov_b32 v100, 0
    v_mov_b32 v101, 0
    v_mov_b32 v102, 0
    v_mov_b32 v103, 0
    v_mov_b32 v104, 0
    v_mov_b32 v105, 0
    v_mov_b32 v106, 0
    v_mov_b32 v107, 0
    v_mov_b32 v108, 0
    v_mov_b32 v109, 0
    v_mov_b32 v110, 0
    v_mov_b32 v111, 0
    v_mov_b32 v112, 0
    v_mov_b32 v113, 0
    v_mov_b32 v114, 0
    v_mov_b32 v115, 0
    v_mov_b32 v116, 0
    v_mov_b32 v117, 0
    v_mov_b32 v118, 0
    v_mov_b32 v119, 0
    v_mov_b32 v120, 0
    v_mov_b32 v121, 0
    v_mov_b32 v122, 0
    v_mov_b32 v123, 0
    v_mov_b32 v124, 0
    v_mov_b32 v125, 0
    v_mov_b32 v126, 0
    v_mov_b32 v127, 0
    v_mov_b32 v128, 0
    v_mov_b32 v129, 0
    v_mov_b32 v130, 0
    v_mov_b32 v131, 0
    v_mov_b32 v132, 0
    v_mov_b32 v133, 0
    v_mov_b32 v134, 0
    v_mov_b32 v135, 0
    v_mov_b32 v136, 0
    v_mov_b32 v137, 0
    v_mov_b32 v138, 0
    v_mov_b32 v139, 0
    v_mov_b32 v140, 0
    v_mov_b32 v141, 0
    v_mov_b32 v142, 0
    v_mov_b32 v143, 0
    v_mov_b32 v144, 0
    v_mov_b32 v145, 0
    v_mov_b32 v146, 0
    v_mov_b32 v147, 0
    v_mov_b32 v148, 0
    v_mov_b32 v149, 0
    v_mov_b32 v150, 0
    v_mov_b32 v151, 0
    v_mov_b32 v152, 0
    v_mov_b32 v153, 0
    v_mov_b32 v154, 0
    v_mov_b32 v155, 0
    v_mov_b32 v156, 0
    v_mov_b32 v157, 0
    v_mov_b32 v158, 0
    v_mov_b32 v159, 0
    v_mov_b32 v160, 0
    v_mov_b32 v161, 0
    v_mov_b32 v162, 0
    v_mov_b32 v163, 0
    v_mov_b32 v164, 0
    v_mov_b32 v165, 0
    v_mov_b32 v166, 0
    v_mov_b32 v167, 0
    v_mov_b32 v168, 0
    v_mov_b32 v169, 0
    v_mov_b32 v170, 0
    v_mov_b32 v171, 0
    v_mov_b32 v172, 0
    v_mov_b32 v173, 0
    v_mov_b32 v174, 0
    v_mov_b32 v175, 0
    v_mov_b32 v176, 0
    v_mov_b32 v177, 0
    v_mov_b32 v178, 0
    v_mov_b32 v179, 0
    v_mov_b32 v180, 0
    v_mov_b32 v181, 0
    v_mov_b32 v182, 0
    v_mov_b32 v183, 0
    v_mov_b32 v184, 0
    v_mov_b32 v185, 0
    v_mov_b32 v186, 0
    v_mov_b32 v187, 0
    v_mov_b32 v188, 0
    v_mov_b32 v189, 0
    v_mov_b32 v190, 0
    v_mov_b32 v191, 0
    s_add_u32 m0, s62, 0
    s_nop 0
    buffer_load_dwordx4 v8, s[40:43], s54 offen offset:0 lds
    buffer_load_dwordx4 v9, s[40:43], s54 offen offset:1024 lds
    s_add_u32 m0, s63, 0
    s_nop 0
    buffer_load_dwordx4 v12, s[44:47], s55 offen offset:0 lds
    buffer_load_dwordx4 v13, s[44:47], s55 offen offset:1024 lds
    buffer_load_dword v60, v61, s[76:79], 0 offen
    v_add_u32 v61, 524288, v61
    s_add_u32 s54, s54, 64
    s_add_u32 s55, s55, 262144
    s_add_u32 m0, s62, 16384
    s_nop 0
    buffer_load_dwordx4 v8, s[40:43], s54 offen offset:0 lds
    buffer_load_dwordx4 v9, s[40:43], s54 offen offset:1024 lds
    s_add_u32 m0, s63, 8192
    s_nop 0
    buffer_load_dwordx4 v12, s[44:47], s55 offen offset:0 lds
    buffer_load_dwordx4 v13, s[44:47], s55 offen offset:1024 lds
    buffer_load_dword v60, v61, s[76:79], 0 offen
    v_add_u32 v61, 524288, v61
    s_add_u32 s54, s54, 64
    s_add_u32 s55, s55, 262144
    s_add_u32 m0, s62, 32768
    s_nop 0
    buffer_load_dwordx4 v8, s[40:43], s54 offen offset:0 lds
    buffer_load_dwordx4 v9, s[40:43], s54 offen offset:1024 lds
    s_add_u32 m0, s63, 16384
    s_nop 0
    buffer_load_dwordx4 v12, s[44:47], s55 offen offset:0 lds
    buffer_load_dwordx4 v13, s[44:47], s55 offen offset:1024 lds
    buffer_load_dword v60, v61, s[76:79], 0 offen
    v_add_u32 v61, 524288, v61
    s_add_u32 s54, s54, 64
    s_add_u32 s55, s55, 262144
    s_mov_b32 s56, 20
    s_waitcnt vmcnt(11)
    s_barrier
    ds_read_b64_tr_b16 v[224:225], v18 offset:0
    ds_read_b64_tr_b16 v[226:227], v18 offset:1024
    ds_read_b128 v[192:195], v16 offset:0
    ds_read_b64_tr_b16 v[228:229], v19 offset:0
    ds_read_b64_tr_b16 v[230:231], v19 offset:1024
    ds_read_b128 v[196:199], v16 offset:2048
    ds_read_b128 v[200:203], v16 offset:4096
    ds_read_b128 v[204:207], v16 offset:6144
    s_waitcnt lgkmcnt(0)
gl_9:
    v_mfma_f32_32x32x16_bf16 v[64:79], v[224:227], v[192:195], v[64:79]
    ds_read_b64_tr_b16 v[232:233], v18 offset:4096
    ds_read_b64_tr_b16 v[234:235], v18 offset:5120
    v_mfma_f32_32x32x16_bf16 v[80:95], v[228:231], v[192:195], v[80:95]
    ds_read_b128 v[208:211], v17 offset:0
    v_mfma_f32_32x32x16_bf16 v[96:111], v[224:227], v[196:199], v[96:111]
    ds_read_b64_tr_b16 v[236:237], v19 offset:4096
    ds_read_b64_tr_b16 v[238:239], v19 offset:5120
    v_mfma_f32_32x32x16_bf16 v[112:127], v[228:231], v[196:199], v[112:127]
    ds_read_b128 v[212:215], v17 offset:2048
    v_mfma_f32_32x32x16_bf16 v[128:143], v[224:227], v[200:203], v[128:143]
    ds_read_b128 v[216:219], v17 offset:4096
    v_mfma_f32_32x32x16_bf16 v[144:159], v[228:231], v[200:203], v[144:159]
    ds_read_b128 v[220:223], v17 offset:6144
    v_mfma_f32_32x32x16_bf16 v[160:175], v[224:227], v[204:207], v[160:175]
    v_mfma_f32_32x32x16_bf16 v[176:191], v[228:231], v[204:207], v[176:191]
    s_waitcnt vmcnt(6)
    s_barrier
    s_cmp_le_u32 s56, 3
    s_cselect_b32 s42, 0, s42
    s_cselect_b32 s46, 0, s46
    s_add_u32 m0, s62, 49152
    s_nop 0
    buffer_load_dwordx4 v8, s[40:43], s54 offen offset:0 lds
    buffer_load_dwordx4 v9, s[40:43], s54 offen offset:1024 lds
    s_add_u32 m0, s63, 24576
    s_nop 0
    buffer_load_dwordx4 v12, s[44:47], s55 offen offset:0 lds
    buffer_load_dwordx4 v13, s[44:47], s55 offen offset:1024 lds
    buffer_load_dword v60, v61, s[76:79], 0 offen
    v_add_u32 v61, 524288, v61
    s_add_u32 s54, s54, 64
    s_add_u32 s55, s55, 262144
    s_waitcnt lgkmcnt(5)
    v_mfma_f32_32x32x16_bf16 v[64:79], v[232:235], v[208:211], v[64:79]
    ds_read_b64_tr_b16 v[224:225], v18 offset:8192
    ds_read_b64_tr_b16 v[226:227], v18 offset:9216
    s_waitcnt lgkmcnt(5)
    v_mfma_f32_32x32x16_bf16 v[80:95], v[236:239], v[208:211], v[80:95]
    ds_read_b128 v[192:195], v16 offset:16384
    s_waitcnt lgkmcnt(5)
    v_mfma_f32_32x32x16_bf16 v[96:111], v[232:235], v[212:215], v[96:111]
    ds_read_b64_tr_b16 v[228:229], v19 offset:8192
    ds_read_b64_tr_b16 v[230:231], v19 offset:9216
    v_mfma_f32_32x32x16_bf16 v[112:127], v[236:239], v[212:215], v[112:127]
    ds_read_b128 v[196:199], v16 offset:18432
    s_waitcnt lgkmcnt(7)
    v_mfma_f32_32x32x16_bf16 v[128:143], v[232:235], v[216:219], v[128:143]
    ds_read_b128 v[200:203], v16 offset:20480
    v_mfma_f32_32x32x16_bf16 v[144:159], v[236:239], v[216:219], v[144:159]
    ds_read_b128 v[204:207], v16 offset:22528
    s_waitcnt lgkmcnt(8)
    v_mfma_f32_32x32x16_bf16 v[160:175], v[232:235], v[220:223], v[160:175]
    v_mfma_f32_32x32x16_bf16 v[176:191], v[236:239], v[220:223], v[176:191]
    s_sub_u32 s56, s56, 1
    s_waitcnt lgkmcnt(5)
    v_mfma_f32_32x32x16_bf16 v[64:79], v[224:227], v[192:195], v[64:79]
    ds_read_b64_tr_b16 v[232:233], v18 offset:12288
    ds_read_b64_tr_b16 v[234:235], v18 offset:13312
    s_waitcnt lgkmcnt(5)
    v_mfma_f32_32x32x16_bf16 v[80:95], v[228:231], v[192:195], v[80:95]
    ds_read_b128 v[208:211], v17 offset:16384
    s_waitcnt lgkmcnt(5)
    v_mfma_f32_32x32x16_bf16 v[96:111], v[224:227], v[196:199], v[96:111]
    ds_read_b64_tr_b16 v[236:237], v19 offset:12288
    ds_read_b64_tr_b16 v[238:239], v19 offset:13312
    v_mfma_f32_32x32x16_bf16 v[112:127], v[228:231], v[196:199], v[112:127]
    ds_read_b128 v[212:215], v17 offset:18432
    s_waitcnt lgkmcnt(7)
    v_mfma_f32_32x32x16_bf16 v[128:143], v[224:227], v[200:203], v[128:143]
    ds_read_b128 v[216:219], v17 offset:20480
    v_mfma_f32_32x32x16_bf16 v[144:159], v[228:231], v[200:203], v[144:159]
    ds_read_b128 v[220:223], v17 offset:22528
    s_waitcnt lgkmcnt(8)
    v_mfma_f32_32x32x16_bf16 v[160:175], v[224:227], v[204:207], v[160:175]
    v_mfma_f32_32x32x16_bf16 v[176:191], v[228:231], v[204:207], v[176:191]
    s_waitcnt vmcnt(6)
    s_barrier
    s_cmp_le_u32 s56, 3
    s_cselect_b32 s42, 0, s42
    s_cselect_b32 s46, 0, s46
    s_add_u32 m0, s62, 0
    s_nop 0
    buffer_load_dwordx4 v8, s[40:43], s54 offen offset:0 lds
    buffer_load_dwordx4 v9, s[40:43], s54 offen offset:1024 lds
    s_add_u32 m0, s63, 0
    s_nop 0
    buffer_load_dwordx4 v12, s[44:47], s55 offen offset:0 lds
    buffer_load_dwordx4 v13, s[44:47], s55 offen offset:1024 lds
    buffer_load_dword v60, v61, s[76:79], 0 offen
    v_add_u32 v61, 524288, v61
    s_add_u32 s54, s54, 64
    s_add_u32 s55, s55, 262144
    s_waitcnt lgkmcnt(5)
    v_mfma_f32_32x32x16_bf16 v[64:79], v[232:235], v[208:211], v[64:79]
    ds_read_b64_tr_b16 v[224:225], v18 offset:16384
    ds_read_b64_tr_b16 v[226:227], v18 offset:17408
    s_waitcnt lgkmcnt(5)
    v_mfma_f32_32x32x16_bf16 v[80:95], v[236:239], v[208:211], v[80:95]
    ds_read_b128 v[192:195], v16 offset:32768
    s_waitcnt lgkmcnt(5)
    v_mfma_f32_32x32x16_bf16 v[96:111], v[232:235], v[212:215], v[96:111]
    ds_read_b64_tr_b16 v[228:229], v19 offset:16384
    ds_read_b64_tr_b16 v[230:231], v19 offset:17408
    v_mfma_f32_32x32x16_bf16 v[112:127], v[236:239], v[212:215], v[112:127]
    ds_read_b128 v[196:199], v16 offset:34816
    s_waitcnt lgkmcnt(7)
    v_mfma_f32_32x32x16_bf16 v[128:143], v[232:235], v[216:219], v[128:143]
    ds_read_b128 v[200:203], v16 offset:36864
    v_mfma_f32_32x32x16_bf16 v[144:159], v[236:239], v[216:219], v[144:159]
    ds_read_b128 v[204:207], v16 offset:38912
    s_waitcnt lgkmcnt(8)
    v_mfma_f32_32x32x16_bf16 v[160:175], v[232:235], v[220:223], v[160:175]
    v_mfma_f32_32x32x16_bf16 v[176:191], v[236:239], v[220:223], v[176:191]
    s_sub_u32 s56, s56, 1
    s_waitcnt lgkmcnt(5)
    v_mfma_f32_32x32x16_bf16 v[64:79], v[224:227], v[192:195], v[64:79]
    ds_read_b64_tr_b16 v[232:233], v18 offset:20480
    ds_read_b64_tr_b16 v[234:235], v18 offset:21504
    s_waitcnt lgkmcnt(5)
    v_mfma_f32_32x32x16_bf16 v[80:95], v[228:231], v[192:195], v[80:95]
    ds_read_b128 v[208:211], v17 offset:32768
    s_waitcnt lgkmcnt(5)
    v_mfma_f32_32x32x16_bf16 v[96:111], v[224:227], v[196:199], v[96:111]
    ds_read_b64_tr_b16 v[236:237], v19 offset:20480
    ds_read_b64_tr_b16 v[238:239], v19 offset:21504
    v_mfma_f32_32x32x16_bf16 v[112:127], v[228:231], v[196:199], v[112:127]
    ds_read_b128 v[212:215], v17 offset:34816
    s_waitcnt lgkmcnt(7)
    v_mfma_f32_32x32x16_bf16 v[128:143], v[224:227], v[200:203], v[128:143]
    ds_read_b128 v[216:219], v17 offset:36864
    v_mfma_f32_32x32x16_bf16 v[144:159], v[228:231], v[200:203], v[144:159]
    ds_read_b128 v[220:223], v17 offset:38912
    s_waitcnt lgkmcnt(8)
    v_mfma_f32_32x32x16_bf16 v[160:175], v[224:227], v[204:207], v[160:175]
    v_mfma_f32_32x32x16_bf16 v[176:191], v[228:231], v[204:207], v[176:191]
    s_waitcnt vmcnt(6)
    s_barrier
    s_cmp_le_u32 s56, 3
    s_cselect_b32 s42, 0, s42
    s_cselect_b32 s46, 0, s46
    s_add_u32 m0, s62, 16384
    s_nop 0
    buffer_load_dwordx4 v8, s[40:43], s54 offen offset:0 lds
    buffer_load_dwordx4 v9, s[40:43], s54 offen offset:1024 lds
    s_add_u32 m0, s63, 8192
    s_nop 0
    buffer_load_dwordx4 v12, s[44:47], s55 offen offset:0 lds
    buffer_load_dwordx4 v13, s[44:47], s55 offen offset:1024 lds
    buffer_load_dword v60, v61, s[76:79], 0 offen
    v_add_u32 v61, 524288, v61
    s_add_u32 s54, s54, 64
    s_add_u32 s55, s55, 262144
    s_waitcnt lgkmcnt(5)
    v_mfma_f32_32x32x16_bf16 v[64:79], v[232:235], v[208:211], v[64:79]
    ds_read_b64_tr_b16 v[224:225], v18 offset:24576
    ds_read_b64_tr_b16 v[226:227], v18 offset:25600
    s_waitcnt lgkmcnt(5)
    v_mfma_f32_32x32x16_bf16 v[80:95], v[236:239], v[208:211], v[80:95]
    ds_read_b128 v[192:195], v16 offset:49152
    s_waitcnt lgkmcnt(5)
    v_mfma_f32_32x32x16_bf16 v[96:111], v[232:235], v[212:215], v[96:111]
    ds_read_b64_tr_b16 v[228:229], v19 offset:24576
    ds_read_b64_tr_b16 v[230:231], v19 offset:25600
    v_mfma_f32_32x32x16_bf16 v[112:127], v[236:239], v[212:215], v[112:127]
    ds_read_b128 v[196:199], v16 offset:51200
    s_waitcnt lgkmcnt(7)
    v_mfma_f32_32x32x16_bf16 v[128:143], v[232:235], v[216:219], v[128:143]
    ds_read_b128 v[200:203], v16 offset:53248
    v_mfma_f32_32x32x16_bf16 v[144:159], v[236:239], v[216:219], v[144:159]
    ds_read_b128 v[204:207], v16 offset:55296
    s_waitcnt lgkmcnt(8)
    v_mfma_f32_32x32x16_bf16 v[160:175], v[232:235], v[220:223], v[160:175]
    v_mfma_f32_32x32x16_bf16 v[176:191], v[236:239], v[220:223], v[176:191]
    s_sub_u32 s56, s56, 1
    s_waitcnt lgkmcnt(5)
    v_mfma_f32_32x32x16_bf16 v[64:79], v[224:227], v[192:195], v[64:79]
    ds_read_b64_tr_b16 v[232:233], v18 offset:28672
    ds_read_b64_tr_b16 v[234:235], v18 offset:29696
    s_waitcnt lgkmcnt(5)
    v_mfma_f32_32x32x16_bf16 v[80:95], v[228:231], v[192:195], v[80:95]
    ds_read_b128 v[208:211], v17 offset:49152
    s_waitcnt lgkmcnt(5)
    v_mfma_f32_32x32x16_bf16 v[96:111], v[224:227], v[196:199], v[96:111]
    ds_read_b64_tr_b16 v[236:237], v19 offset:28672
    ds_read_b64_tr_b16 v[238:239], v19 offset:29696
    v_mfma_f32_32x32x16_bf16 v[112:127], v[228:231], v[196:199], v[112:127]
    ds_read_b128 v[212:215], v17 offset:51200
    s_waitcnt lgkmcnt(7)
    v_mfma_f32_32x32x16_bf16 v[128:143], v[224:227], v[200:203], v[128:143]
    ds_read_b128 v[216:219], v17 offset:53248
    v_mfma_f32_32x32x16_bf16 v[144:159], v[228:231], v[200:203], v[144:159]
    ds_read_b128 v[220:223], v17 offset:55296
    s_waitcnt lgkmcnt(8)
    v_mfma_f32_32x32x16_bf16 v[160:175], v[224:227], v[204:207], v[160:175]
    v_mfma_f32_32x32x16_bf16 v[176:191], v[228:231], v[204:207], v[176:191]
    s_waitcnt vmcnt(6)
    s_barrier
    s_cmp_le_u32 s56, 3
    s_cselect_b32 s42, 0, s42
    s_cselect_b32 s46, 0, s46
    s_add_u32 m0, s62, 32768
    s_nop 0
    buffer_load_dwordx4 v8, s[40:43], s54 offen offset:0 lds
    buffer_load_dwordx4 v9, s[40:43], s54 offen offset:1024 lds
    s_add_u32 m0, s63, 16384
    s_nop 0
    buffer_load_dwordx4 v12, s[44:47], s55 offen offset:0 lds
    buffer_load_dwordx4 v13, s[44:47], s55 offen offset:1024 lds
    buffer_load_dword v60, v61, s[76:79], 0 offen
    v_add_u32 v61, 524288, v61
    s_add_u32 s54, s54, 64
    s_add_u32 s55, s55, 262144
    s_waitcnt lgkmcnt(5)
    v_mfma_f32_32x32x16_bf16 v[64:79], v[232:235], v[208:211], v[64:79]
    ds_read_b64_tr_b16 v[224:225], v18 offset:0
    ds_read_b64_tr_b16 v[226:227], v18 offset:1024
    s_waitcnt lgkmcnt(5)
    v_mfma_f32_32x32x16_bf16 v[80:95], v[236:239], v[208:211], v[80:95]
    ds_read_b128 v[192:195], v16 offset:0
    s_waitcnt lgkmcnt(5)
    v_mfma_f32_32x32x16_bf16 v[96:111], v[232:235], v[212:215], v[96:111]
    ds_read_b64_tr_b16 v[228:229], v19 offset:0
    ds_read_b64_tr_b16 v[230:231], v19 offset:1024
    v_mfma_f32_32x32x16_bf16 v[112:127], v[236:239], v[212:215], v[112:127]
    ds_read_b128 v[196:199], v16 offset:2048
    s_waitcnt lgkmcnt(7)
    v_mfma_f32_32x32x16_bf16 v[128:143], v[232:235], v[216:219], v[128:143]
    ds_read_b128 v[200:203], v16 offset:4096
    v_mfma_f32_32x32x16_bf16 v[144:159], v[236:239], v[216:219], v[144:159]
    ds_read_b128 v[204:207], v16 offset:6144
    s_waitcnt lgkmcnt(8)
    v_mfma_f32_32x32x16_bf16 v[160:175], v[232:235], v[220:223], v[160:175]
    v_mfma_f32_32x32x16_bf16 v[176:191], v[236:239], v[220:223], v[176:191]
    s_sub_u32 s56, s56, 1
    s_cmp_eq_u32 s56, 0
    s_waitcnt lgkmcnt(0)
    s_nop 8
    s_cbranch_scc1 gd_10
    s_branch gl_9
gd_10:
    s_waitcnt vmcnt(0) lgkmcnt(0)
    s_add_u32 s48, s38, 12582912
    s_addc_u32 s49, s39, 0
    s_and_b32 s49, s49, 0xffff
    s_mov_b32 s50, 16777216
    s_mov_b32 s51, 0x00020000
    s_lshl_b32 s64, s53, 12
    s_barrier
    s_mul_i32 s60, s57, 16384
    v_and_b32 v2, 31, v1
    v_lshlrev_b32 v2, 7, v2
    v_lshrrev_b32 v3, 5, v1
    v_lshl_add_u32 v2, v3, 3, v2
    v_add_u32 v2, s60, v2
    v_bfe_u32 v3, v1, 1, 3
    v_xor_b32 v4, 0, v3
    v_lshl_add_u32 v8, v4, 4, v2
    v_xor_b32 v4, 1, v3
    v_lshl_add_u32 v9, v4, 4, v2
    v_xor_b32 v4, 2, v3
    v_lshl_add_u32 v10, v4, 4, v2
    v_xor_b32 v4, 3, v3
    v_lshl_add_u32 v11, v4, 4, v2
    v_xor_b32 v4, 4, v3
    v_lshl_add_u32 v12, v4, 4, v2
    v_xor_b32 v4, 5, v3
    v_lshl_add_u32 v13, v4, 4, v2
    v_xor_b32 v4, 6, v3
    v_lshl_add_u32 v14, v4, 4, v2
    v_xor_b32 v4, 7, v3
    v_lshl_add_u32 v15, v4, 4, v2
    s_mov_b32 s65, 1040356334
    v_mul_f32 v26, s65, v64
    v_mul_f32 v27, s65, v65
    v_mul_f32 v28, s65, v66
    v_mul_f32 v29, s65, v67
    v_cvt_pk_bf16_f32 v24, v26, v27
    v_cvt_pk_bf16_f32 v25, v28, v29
    ds_write_b64 v8, v[24:25] offset:0
    v_mul_f32 v34, s65, v68
    v_mul_f32 v35, s65, v69
    v_mul_f32 v36, s65, v70
    v_mul_f32 v37, s65, v71
    v_cvt_pk_bf16_f32 v32, v34, v35
    v_cvt_pk_bf16_f32 v33, v36, v37
    ds_write_b64 v9, v[32:33] offset:0
    v_mul_f32 v42, s65, v72
    v_mul_f32 v43, s65, v73
    v_mul_f32 v44, s65, v74
    v_mul_f32 v45, s65, v75
    v_cvt_pk_bf16_f32 v40, v42, v43
    v_cvt_pk_bf16_f32 v41, v44, v45
    ds_write_b64 v10, v[40:41] offset:0
    v_mul_f32 v50, s65, v76
    v_mul_f32 v51, s65, v77
    v_mul_f32 v52, s65, v78
    v_mul_f32 v53, s65, v79
    v_cvt_pk_bf16_f32 v48, v50, v51
    v_cvt_pk_bf16_f32 v49, v52, v53
    ds_write_b64 v11, v[48:49] offset:0
    v_mul_f32 v26, s65, v80
    v_mul_f32 v27, s65, v81
    v_mul_f32 v28, s65, v82
    v_mul_f32 v29, s65, v83
    v_cvt_pk_bf16_f32 v24, v26, v27
    v_cvt_pk_bf16_f32 v25, v28, v29
    ds_write_b64 v12, v[24:25] offset:0
    v_mul_f32 v34, s65, v84
    v_mul_f32 v35, s65, v85
    v_mul_f32 v36, s65, v86
    v_mul_f32 v37, s65, v87
    v_cvt_pk_bf16_f32 v32, v34, v35
    v_cvt_pk_bf16_f32 v33, v36, v37
    ds_write_b64 v13, v[32:33] offset:0
    v_mul_f32 v42, s65, v88
    v_mul_f32 v43, s65, v89
    v_mul_f32 v44, s65, v90
    v_mul_f32 v45, s65, v91
    v_cvt_pk_bf16_f32 v40, v42, v43
    v_cvt_pk_bf16_f32 v41, v44, v45
    ds_write_b64 v14, v[40:41] offset:0
    v_mul_f32 v50, s65, v92
    v_mul_f32 v51, s65, v93
    v_mul_f32 v52, s65, v94
    v_mul_f32 v53, s65, v95
    v_cvt_pk_bf16_f32 v48, v50, v51
    v_cvt_pk_bf16_f32 v49, v52, v53
    ds_write_b64 v15, v[48:49] offset:0
    s_waitcnt lgkmcnt(0)
    v_mul_f32 v26, s65, v96
    v_mul_f32 v27, s65, v97
    v_mul_f32 v28, s65, v98
    v_mul_f32 v29, s65, v99
    v_cvt_pk_bf16_f32 v24, v26, v27
    v_cvt_pk_bf16_f32 v25, v28, v29
    ds_write_b64 v8, v[24:25] offset:4096
    v_mul_f32 v34, s65, v100
    v_mul_f32 v35, s65, v101
    v_mul_f32 v36, s65, v102
    v_mul_f32 v37, s65, v103
    v_cvt_pk_bf16_f32 v32, v34, v35
    v_cvt_pk_bf16_f32 v33, v36, v37
    ds_write_b64 v9, v[32:33] offset:4096
    v_mul_f32 v42, s65, v104
    v_mul_f32 v43, s65, v105
    v_mul_f32 v44, s65, v106
    v_mul_f32 v45, s65, v107
    v_cvt_pk_bf16_f32 v40, v42, v43
    v_cvt_pk_bf16_f32 v41, v44, v45
    ds_write_b64 v10, v[40:41] offset:4096
    v_mul_f32 v50, s65, v108
    v_mul_f32 v51, s65, v109
    v_mul_f32 v52, s65, v110
    v_mul_f32 v53, s65, v111
    v_cvt_pk_bf16_f32 v48, v50, v51
    v_cvt_pk_bf16_f32 v49, v52, v53
    ds_write_b64 v11, v[48:49] offset:4096
    v_mul_f32 v26, s65, v112
    v_mul_f32 v27, s65, v113
    v_mul_f32 v28, s65, v114
    v_mul_f32 v29, s65, v115
    v_cvt_pk_bf16_f32 v24, v26, v27
    v_cvt_pk_bf16_f32 v25, v28, v29
    ds_write_b64 v12, v[24:25] offset:4096
    v_mul_f32 v34, s65, v116
    v_mul_f32 v35, s65, v117
    v_mul_f32 v36, s65, v118
    v_mul_f32 v37, s65, v119
    v_cvt_pk_bf16_f32 v32, v34, v35
    v_cvt_pk_bf16_f32 v33, v36, v37
    ds_write_b64 v13, v[32:33] offset:4096
    v_mul_f32 v42, s65, v120
    v_mul_f32 v43, s65, v121
    v_mul_f32 v44, s65, v122
    v_mul_f32 v45, s65, v123
    v_cvt_pk_bf16_f32 v40, v42, v43
    v_cvt_pk_bf16_f32 v41, v44, v45
    ds_write_b64 v14, v[40:41] offset:4096
    v_mul_f32 v50, s65, v124
    v_mul_f32 v51, s65, v125
    v_mul_f32 v52, s65, v126
    v_mul_f32 v53, s65, v127
    v_cvt_pk_bf16_f32 v48, v50, v51
    v_cvt_pk_bf16_f32 v49, v52, v53
    ds_write_b64 v15, v[48:49] offset:4096
    s_waitcnt lgkmcnt(0)
    v_mul_f32 v26, s65, v128
    v_mul_f32 v27, s65, v129
    v_mul_f32 v28, s65, v130
    v_mul_f32 v29, s65, v131
    v_cvt_pk_bf16_f32 v24, v26, v27
    v_cvt_pk_bf16_f32 v25, v28, v29
    ds_write_b64 v8, v[24:25] offset:8192
    v_mul_f32 v34, s65, v132
    v_mul_f32 v35, s65, v133
    v_mul_f32 v36, s65, v134
    v_mul_f32 v37, s65, v135
    v_cvt_pk_bf16_f32 v32, v34, v35
    v_cvt_pk_bf16_f32 v33, v36, v37
    ds_write_b64 v9, v[32:33] offset:8192
    v_mul_f32 v42, s65, v136
    v_mul_f32 v43, s65, v137
    v_mul_f32 v44, s65, v138
    v_mul_f32 v45, s65, v139
    v_cvt_pk_bf16_f32 v40, v42, v43
    v_cvt_pk_bf16_f32 v41, v44, v45
    ds_write_b64 v10, v[40:41] offset:8192
    v_mul_f32 v50, s65, v140
    v_mul_f32 v51, s65, v141
    v_mul_f32 v52, s65, v142
    v_mul_f32 v53, s65, v143
    v_cvt_pk_bf16_f32 v48, v50, v51
    v_cvt_pk_bf16_f32 v49, v52, v53
    ds_write_b64 v11, v[48:49] offset:8192
    v_mul_f32 v26, s65, v144
    v_mul_f32 v27, s65, v145
    v_mul_f32 v28, s65, v146
    v_mul_f32 v29, s65, v147
    v_cvt_pk_bf16_f32 v24, v26, v27
    v_cvt_pk_bf16_f32 v25, v28, v29
    ds_write_b64 v12, v[24:25] offset:8192
    v_mul_f32 v34, s65, v148
    v_mul_f32 v35, s65, v149
    v_mul_f32 v36, s65, v150
    v_mul_f32 v37, s65, v151
    v_cvt_pk_bf16_f32 v32, v34, v35
    v_cvt_pk_bf16_f32 v33, v36, v37
    ds_write_b64 v13, v[32:33] offset:8192
    v_mul_f32 v42, s65, v152
    v_mul_f32 v43, s65, v153
    v_mul_f32 v44, s65, v154
    v_mul_f32 v45, s65, v155
    v_cvt_pk_bf16_f32 v40, v42, v43
    v_cvt_pk_bf16_f32 v41, v44, v45
    ds_write_b64 v14, v[40:41] offset:8192
    v_mul_f32 v50, s65, v156
    v_mul_f32 v51, s65, v157
    v_mul_f32 v52, s65, v158
    v_mul_f32 v53, s65, v159
    v_cvt_pk_bf16_f32 v48, v50, v51
    v_cvt_pk_bf16_f32 v49, v52, v53
    ds_write_b64 v15, v[48:49] offset:8192
    s_waitcnt lgkmcnt(0)
    v_mul_f32 v26, s65, v160
    v_mul_f32 v27, s65, v161
    v_mul_f32 v28, s65, v162
    v_mul_f32 v29, s65, v163
    v_cvt_pk_bf16_f32 v24, v26, v27
    v_cvt_pk_bf16_f32 v25, v28, v29
    ds_write_b64 v8, v[24:25] offset:12288
    v_mul_f32 v34, s65, v164
    v_mul_f32 v35, s65, v165
    v_mul_f32 v36, s65, v166
    v_mul_f32 v37, s65, v167
    v_cvt_pk_bf16_f32 v32, v34, v35
    v_cvt_pk_bf16_f32 v33, v36, v37
    ds_write_b64 v9, v[32:33] offset:12288
    v_mul_f32 v42, s65, v168
    v_mul_f32 v43, s65, v169
    v_mul_f32 v44, s65, v170
    v_mul_f32 v45, s65, v171
    v_cvt_pk_bf16_f32 v40, v42, v43
    v_cvt_pk_bf16_f32 v41, v44, v45
    ds_write_b64 v10, v[40:41] offset:12288
    v_mul_f32 v50, s65, v172
    v_mul_f32 v51, s65, v173
    v_mul_f32 v52, s65, v174
    v_mul_f32 v53, s65, v175
    v_cvt_pk_bf16_f32 v48, v50, v51
    v_cvt_pk_bf16_f32 v49, v52, v53
    ds_write_b64 v11, v[48:49] offset:12288
    v_mul_f32 v26, s65, v176
    v_mul_f32 v27, s65, v177
    v_mul_f32 v28, s65, v178
    v_mul_f32 v29, s65, v179
    v_cvt_pk_bf16_f32 v24, v26, v27
    v_cvt_pk_bf16_f32 v25, v28, v29
    ds_write_b64 v12, v[24:25] offset:12288
    v_mul_f32 v34, s65, v180
    v_mul_f32 v35, s65, v181
    v_mul_f32 v36, s65, v182
    v_mul_f32 v37, s65, v183
    v_cvt_pk_bf16_f32 v32, v34, v35
    v_cvt_pk_bf16_f32 v33, v36, v37
    ds_write_b64 v13, v[32:33] offset:12288
    v_mul_f32 v42, s65, v184
    v_mul_f32 v43, s65, v185
    v_mul_f32 v44, s65, v186
    v_mul_f32 v45, s65, v187
    v_cvt_pk_bf16_f32 v40, v42, v43
    v_cvt_pk_bf16_f32 v41, v44, v45
    ds_write_b64 v14, v[40:41] offset:12288
    v_mul_f32 v50, s65, v188
    v_mul_f32 v51, s65, v189
    v_mul_f32 v52, s65, v190
    v_mul_f32 v53, s65, v191
    v_cvt_pk_bf16_f32 v48, v50, v51
    v_cvt_pk_bf16_f32 v49, v52, v53
    ds_write_b64 v15, v[48:49] offset:12288
    s_waitcnt lgkmcnt(0)
    v_lshrrev_b32 v2, 3, v1
    v_and_b32 v3, 7, v1
    v_lshrrev_b32 v4, 4, v1
    v_xor_b32 v4, v4, v3
    v_lshlrev_b32 v5, 7, v2
    v_lshl_add_u32 v5, v4, 4, v5
    v_add_u32 v5, s60, v5
    v_xor_b32 v6, 64, v5
    s_mul_i32 s60, s58, 128
    s_add_u32 s60, s60, s52
    v_add_u32 v2, s60, v2
    s_mov_b32 s61, 256
    v_mul_lo_u32 v2, v2, s61
    v_lshlrev_b32 v3, 4, v3
    s_mul_i32 s60, s59, 128
    s_add_u32 s60, s60, s64
    v_add3_u32 v2, v2, v3, s60
    ds_read_b128 v[192:195], v5 offset:0
    ds_read_b128 v[196:199], v6 offset:1024
    ds_read_b128 v[200:203], v5 offset:2048
    ds_read_b128 v[204:207], v6 offset:3072
    ds_read_b128 v[208:211], v5 offset:4096
    ds_read_b128 v[212:215], v6 offset:5120
    ds_read_b128 v[216:219], v5 offset:6144
    ds_read_b128 v[220:223], v6 offset:7168
    s_mov_b32 s66, 0
    s_waitcnt lgkmcnt(7)
    buffer_store_dwordx4 v[192:195], v2, s[48:51], s66 offen
    s_nop 1
    ds_read_b128 v[192:195], v5 offset:8192
    s_mov_b32 s66, 2048
    s_waitcnt lgkmcnt(7)
    buffer_store_dwordx4 v[196:199], v2, s[48:51], s66 offen
    s_nop 1
    ds_read_b128 v[196:199], v6 offset:9216
    s_mov_b32 s66, 4096
    s_waitcnt lgkmcnt(7)
    buffer_store_dwordx4 v[200:203], v2, s[48:51], s66 offen
    s_nop 1
    ds_read_b128 v[200:203], v5 offset:10240
    s_mov_b32 s66, 6144
    s_waitcnt lgkmcnt(7)
    buffer_store_dwordx4 v[204:207], v2, s[48:51], s66 offen
    s_nop 1
    ds_read_b128 v[204:207], v6 offset:11264
    s_mov_b32 s66, 8192
    s_waitcnt lgkmcnt(7)
    buffer_store_dwordx4 v[208:211], v2, s[48:51], s66 offen
    s_nop 1
    ds_read_b128 v[208:211], v5 offset:12288
    s_mov_b32 s66, 10240
    s_waitcnt lgkmcnt(7)
    buffer_store_dwordx4 v[212:215], v2, s[48:51], s66 offen
    s_nop 1
    ds_read_b128 v[212:215], v6 offset:13312
    s_mov_b32 s66, 12288
    s_waitcnt lgkmcnt(7)
    buffer_store_dwordx4 v[216:219], v2, s[48:51], s66 offen
    s_nop 1
    ds_read_b128 v[216:219], v5 offset:14336
    s_mov_b32 s66, 14336
    s_waitcnt lgkmcnt(7)
    buffer_store_dwordx4 v[220:223], v2, s[48:51], s66 offen
    s_nop 1
    ds_read_b128 v[220:223], v6 offset:15360
    s_mov_b32 s66, 16384
    s_waitcnt lgkmcnt(7)
    buffer_store_dwordx4 v[192:195], v2, s[48:51], s66 offen
    s_mov_b32 s66, 18432
    s_waitcnt lgkmcnt(6)
    buffer_store_dwordx4 v[196:199], v2, s[48:51], s66 offen
    s_mov_b32 s66, 20480
    s_waitcnt lgkmcnt(5)
    buffer_store_dwordx4 v[200:203], v2, s[48:51], s66 offen
    s_mov_b32 s66, 22528
    s_waitcnt lgkmcnt(4)
    buffer_store_dwordx4 v[204:207], v2, s[48:51], s66 offen
    s_mov_b32 s66, 24576
    s_waitcnt lgkmcnt(3)
    buffer_store_dwordx4 v[208:211], v2, s[48:51], s66 offen
    s_mov_b32 s66, 26624
    s_waitcnt lgkmcnt(2)
    buffer_store_dwordx4 v[212:215], v2, s[48:51], s66 offen
    s_mov_b32 s66, 28672
    s_waitcnt lgkmcnt(1)
    buffer_store_dwordx4 v[216:219], v2, s[48:51], s66 offen
    s_mov_b32 s66, 30720
    s_waitcnt lgkmcnt(0)
    buffer_store_dwordx4 v[220:223], v2, s[48:51], s66 offen
    s_endpgm
    s_nop 0
job_3:
    s_mov_b32 s40, s24
    s_mov_b32 s41, s25
    s_and_b32 s41, s41, 0xffff
    s_mov_b32 s42, 2097152
    s_mov_b32 s43, 0x00020000
    s_mov_b32 s44, s28
    s_mov_b32 s45, s29
    s_and_b32 s45, s45, 0xffff
    s_mov_b32 s46, 4194304
    s_mov_b32 s47, 0x00020000
    v_and_b32 v1, 63, v0
    s_and_b32 s70, s57, 3
    s_lshr_b32 s58, s70, 1
    s_and_b32 s59, s70, 1
    s_mul_i32 s72, s71, 32768
    s_add_u32 s72, s72, 65536
    v_lshrrev_b32 v2, 2, v1
    v_bfe_u32 v3, v1, 4, 2
    v_and_b32 v4, 3, v1
    v_xor_b32 v4, v4, v3
    s_mul_i32 s60, s57, 32
    s_add_u32 s60, s60, s52
    v_add_u32 v2, s60, v2
    s_mov_b32 s61, 1024
    v_mul_lo_u32 v2, v2, s61
    v_lshl_add_u32 v2, v4, 4, v2
    v_add_u32 v8, 0, v2
    v_add_u32 v9, 15360, v2
    v_lshrrev_b32 v2, 4, v1
    v_and_b32 v3, 15, v1
    v_lshrrev_b32 v4, 2, v3
    v_bfe_u32 v5, v1, 4, 2
    v_xor_b32 v4, v4, v5
    v_and_b32 v3, 3, v3
    v_lshlrev_b32 v3, 4, v3
    v_lshl_add_u32 v3, v4, 6, v3
    s_mul_i32 s60, s70, 8
    v_add_u32 v2, s60, v2
    s_mov_b32 s61, 8192
    v_mul_lo_u32 v2, v2, s61
    v_add_u32 v2, v2, v3
    s_lshl_b32 s60, s53, 1
    v_add_u32 v2, s60, v2
    v_add_u32 v12, 0, v2
    v_add_u32 v13, 31744, v2
    v_and_b32 v2, 31, v1
    v_lshrrev_b32 v3, 5, v1
    v_bfe_u32 v4, v1, 2, 2
    v_xor_b32 v4, v4, v3
    s_mul_i32 s60, s58, 128
    v_add_u32 v2, s60, v2
    v_lshlrev_b32 v2, 6, v2
    v_lshl_add_u32 v16, v4, 4, v2
    v_xor_b32 v17, 32, v16
    v_bfe_u32 v2, v1, 2, 2
    v_lshrrev_b32 v3, 5, v1
    v_lshl_add_u32 v3, v3, 3, v2
    v_mul_u32_u24 v3, 256, v3
    v_mov_b32 v4, v2
    s_mul_i32 s60, s59, 2
    v_xor_b32 v4, s60, v4
    v_lshl_add_u32 v3, v4, 6, v3
    v_bfe_u32 v4, v1, 4, 1
    v_and_b32 v5, 3, v1
    v_lshlrev_b32 v5, 3, v5
    v_lshl_add_u32 v5, v4, 5, v5
    v_add_u32 v3, v3, v5
    v_add_u32 v18, s72, v3
    v_xor_b32 v19, 64, v18
    s_mul_i32 s62, s57, 2048
    s_mul_i32 s63, s70, 2048
    s_add_u32 s63, s63, s72
    s_mov_b32 s54, 0
    s_mov_b32 s55, 0
    v_mov_b32 v64, 0
    v_mov_b32 v65, 0
    v_mov_b32 v66, 0
    v_mov_b32 v67, 0
    v_mov_b32 v68, 0
    v_mov_b32 v69, 0
    v_mov_b32 v70, 0
    v_mov_b32 v71, 0
    v_mov_b32 v72, 0
    v_mov_b32 v73, 0
    v_mov_b32 v74, 0
    v_mov_b32 v75, 0
    v_mov_b32 v76, 0
    v_mov_b32 v77, 0
    v_mov_b32 v78, 0
    v_mov_b32 v79, 0
    v_mov_b32 v80, 0
    v_mov_b32 v81, 0
    v_mov_b32 v82, 0
    v_mov_b32 v83, 0
    v_mov_b32 v84, 0
    v_mov_b32 v85, 0
    v_mov_b32 v86, 0
    v_mov_b32 v87, 0
    v_mov_b32 v88, 0
    v_mov_b32 v89, 0
    v_mov_b32 v90, 0
    v_mov_b32 v91, 0
    v_mov_b32 v92, 0
    v_mov_b32 v93, 0
    v_mov_b32 v94, 0
    v_mov_b32 v95, 0
    v_mov_b32 v96, 0
    v_mov_b32 v97, 0
    v_mov_b32 v98, 0
    v_mov_b32 v99, 0
    v_mov_b32 v100, 0
    v_mov_b32 v101, 0
    v_mov_b32 v102, 0
    v_mov_b32 v103, 0
    v_mov_b32 v104, 0
    v_mov_b32 v105, 0
    v_mov_b32 v106, 0
    v_mov_b32 v107, 0
    v_mov_b32 v108, 0
    v_mov_b32 v109, 0
    v_mov_b32 v110, 0
    v_mov_b32 v111, 0
    v_mov_b32 v112, 0
    v_mov_b32 v113, 0
    v_mov_b32 v114, 0
    v_mov_b32 v115, 0
    v_mov_b32 v116, 0
    v_mov_b32 v117, 0
    v_mov_b32 v118, 0
    v_mov_b32 v119, 0
    v_mov_b32 v120, 0
    v_mov_b32 v121, 0
    v_mov_b32 v122, 0
    v_mov_b32 v123, 0
    v_mov_b32 v124, 0
    v_mov_b32 v125, 0
    v_mov_b32 v126, 0
    v_mov_b32 v127, 0
    v_mov_b32 v128, 0
    v_mov_b32 v129, 0
    v_mov_b32 v130, 0
    v_mov_b32 v131, 0
    v_mov_b32 v132, 0
    v_mov_b32 v133, 0
    v_mov_b32 v134, 0
    v_mov_b32 v135, 0
    v_mov_b32 v136, 0
    v_mov_b32 v137, 0
    v_mov_b32 v138, 0
    v_mov_b32 v139, 0
    v_mov_b32 v140, 0
    v_mov_b32 v141, 0
    v_mov_b32 v142, 0
    v_mov_b32 v143, 0
    v_mov_b32 v144, 0
    v_mov_b32 v145, 0
    v_mov_b32 v146, 0
    v_mov_b32 v147, 0
    v_mov_b32 v148, 0
    v_mov_b32 v149, 0
    v_mov_b32 v150, 0
    v_mov_b32 v151, 0
    v_mov_b32 v152, 0
    v_mov_b32 v153, 0
    v_mov_b32 v154, 0
    v_mov_b32 v155, 0
    v_mov_b32 v156, 0
    v_mov_b32 v157, 0
    v_mov_b32 v158, 0
    v_mov_b32 v159, 0
    v_mov_b32 v160, 0
    v_mov_b32 v161, 0
    v_mov_b32 v162, 0
    v_mov_b32 v163, 0
    v_mov_b32 v164, 0
    v_mov_b32 v165, 0
    v_mov_b32 v166, 0
    v_mov_b32 v167, 0
    v_mov_b32 v168, 0
    v_mov_b32 v169, 0
    v_mov_b32 v170, 0
    v_mov_b32 v171, 0
    v_mov_b32 v172, 0
    v_mov_b32 v173, 0
    v_mov_b32 v174, 0
    v_mov_b32 v175, 0
    v_mov_b32 v176, 0
    v_mov_b32 v177, 0
    v_mov_b32 v178, 0
    v_mov_b32 v179, 0
    v_mov_b32 v180, 0
    v_mov_b32 v181, 0
    v_mov_b32 v182, 0
    v_mov_b32 v183, 0
    v_mov_b32 v184, 0
    v_mov_b32 v185, 0
    v_mov_b32 v186, 0
    v_mov_b32 v187, 0
    v_mov_b32 v188, 0
    v_mov_b32 v189, 0
    v_mov_b32 v190, 0
    v_mov_b32 v191, 0
    s_add_u32 m0, s62, 0
    s_nop 0
    buffer_load_dwordx4 v8, s[40:43], s54 offen offset:0 lds
    buffer_load_dwordx4 v9, s[40:43], s54 offen offset:1024 lds
    s_add_u32 m0, s63, 0
    s_nop 0
    buffer_load_dwordx4 v12, s[44:47], s55 offen offset:0 lds
    buffer_load_dwordx4 v13, s[44:47], s55 offen offset:1024 lds
    buffer_load_dword v60, v61, s[76:79], 0 offen
    v_add_u32 v61, 524288, v61
    s_add_u32 s54, s54, 64
    s_add_u32 s55, s55, 262144
    s_add_u32 m0, s62, 16384
    s_nop 0
    buffer_load_dwordx4 v8, s[40:43], s54 offen offset:0 lds
    buffer_load_dwordx4 v9, s[40:43], s54 offen offset:1024 lds
    s_add_u32 m0, s63, 8192
    s_nop 0
    buffer_load_dwordx4 v12, s[44:47], s55 offen offset:0 lds
    buffer_load_dwordx4 v13, s[44:47], s55 offen offset:1024 lds
    buffer_load_dword v60, v61, s[76:79], 0 offen
    v_add_u32 v61, 524288, v61
    s_add_u32 s54, s54, 64
    s_add_u32 s55, s55, 262144
    s_add_u32 m0, s62, 32768
    s_nop 0
    buffer_load_dwordx4 v8, s[40:43], s54 offen offset:0 lds
    buffer_load_dwordx4 v9, s[40:43], s54 offen offset:1024 lds
    s_add_u32 m0, s63, 16384
    s_nop 0
    buffer_load_dwordx4 v12, s[44:47], s55 offen offset:0 lds
    buffer_load_dwordx4 v13, s[44:47], s55 offen offset:1024 lds
    buffer_load_dword v60, v61, s[76:79], 0 offen
    v_add_u32 v61, 524288, v61
    s_add_u32 s54, s54, 64
    s_add_u32 s55, s55, 262144
    s_mov_b32 s56, 16
    s_waitcnt vmcnt(11)
    s_barrier
    ds_read_b64_tr_b16 v[224:225], v18 offset:0
    ds_read_b64_tr_b16 v[226:227], v18 offset:1024
    ds_read_b128 v[192:195], v16 offset:0
    ds_read_b64_tr_b16 v[228:229], v19 offset:0
    ds_read_b64_tr_b16 v[230:231], v19 offset:1024
    ds_read_b128 v[196:199], v16 offset:2048
    ds_read_b128 v[200:203], v16 offset:4096
    ds_read_b128 v[204:207], v16 offset:6144
    s_waitcnt lgkmcnt(0)
gl_11:
    v_mfma_f32_32x32x16_bf16 v[64:79], v[224:227], v[192:195], v[64:79]
    ds_read_b64_tr_b16 v[232:233], v18 offset:4096
    ds_read_b64_tr_b16 v[234:235], v18 offset:5120
    v_mfma_f32_32x32x16_bf16 v[80:95], v[228:231], v[192:195], v[80:95]
    ds_read_b128 v[208:211], v17 offset:0
    v_mfma_f32_32x32x16_bf16 v[96:111], v[224:227], v[196:199], v[96:111]
    ds_read_b64_tr_b16 v[236:237], v19 offset:4096
    ds_read_b64_tr_b16 v[238:239], v19 offset:5120
    v_mfma_f32_32x32x16_bf16 v[112:127], v[228:231], v[196:199], v[112:127]
    ds_read_b128 v[212:215], v17 offset:2048
    v_mfma_f32_32x32x16_bf16 v[128:143], v[224:227], v[200:203], v[128:143]
    ds_read_b128 v[216:219], v17 offset:4096
    v_mfma_f32_32x32x16_bf16 v[144:159], v[228:231], v[200:203], v[144:159]
    ds_read_b128 v[220:223], v17 offset:6144
    v_mfma_f32_32x32x16_bf16 v[160:175], v[224:227], v[204:207], v[160:175]
    v_mfma_f32_32x32x16_bf16 v[176:191], v[228:231], v[204:207], v[176:191]
    s_waitcnt vmcnt(6)
    s_barrier
    s_cmp_le_u32 s56, 3
    s_cselect_b32 s42, 0, s42
    s_cselect_b32 s46, 0, s46
    s_add_u32 m0, s62, 49152
    s_nop 0
    buffer_load_dwordx4 v8, s[40:43], s54 offen offset:0 lds
    buffer_load_dwordx4 v9, s[40:43], s54 offen offset:1024 lds
    s_add_u32 m0, s63, 24576
    s_nop 0
    buffer_load_dwordx4 v12, s[44:47], s55 offen offset:0 lds
    buffer_load_dwordx4 v13, s[44:47], s55 offen offset:1024 lds
    buffer_load_dword v60, v61, s[76:79], 0 offen
    v_add_u32 v61, 524288, v61
    s_add_u32 s54, s54, 64
    s_add_u32 s55, s55, 262144
    s_waitcnt lgkmcnt(5)
    v_mfma_f32_32x32x16_bf16 v[64:79], v[232:235], v[208:211], v[64:79]
    ds_read_b64_tr_b16 v[224:225], v18 offset:8192
    ds_read_b64_tr_b16 v[226:227], v18 offset:9216
    s_waitcnt lgkmcnt(5)
    v_mfma_f32_32x32x16_bf16 v[80:95], v[236:239], v[208:211], v[80:95]
    ds_read_b128 v[192:195], v16 offset:16384
    s_waitcnt lgkmcnt(5)
    v_mfma_f32_32x32x16_bf16 v[96:111], v[232:235], v[212:215], v[96:111]
    ds_read_b64_tr_b16 v[228:229], v19 offset:8192
    ds_read_b64_tr_b16 v[230:231], v19 offset:9216
    v_mfma_f32_32x32x16_bf16 v[112:127], v[236:239], v[212:215], v[112:127]
    ds_read_b128 v[196:199], v16 offset:18432
    s_waitcnt lgkmcnt(7)
    v_mfma_f32_32x32x16_bf16 v[128:143], v[232:235], v[216:219], v[128:143]
    ds_read_b128 v[200:203], v16 offset:20480
    v_mfma_f32_32x32x16_bf16 v[144:159], v[236:239], v[216:219], v[144:159]
    ds_read_b128 v[204:207], v16 offset:22528
    s_waitcnt lgkmcnt(8)
    v_mfma_f32_32x32x16_bf16 v[160:175], v[232:235], v[220:223], v[160:175]
    v_mfma_f32_32x32x16_bf16 v[176:191], v[236:239], v[220:223], v[176:191]
    s_sub_u32 s56, s56, 1
    s_waitcnt lgkmcnt(5)
    v_mfma_f32_32x32x16_bf16 v[64:79], v[224:227], v[192:195], v[64:79]
    ds_read_b64_tr_b16 v[232:233], v18 offset:12288
    ds_read_b64_tr_b16 v[234:235], v18 offset:13312
    s_waitcnt lgkmcnt(5)
    v_mfma_f32_32x32x16_bf16 v[80:95], v[228:231], v[192:195], v[80:95]
    ds_read_b128 v[208:211], v17 offset:16384
    s_waitcnt lgkmcnt(5)
    v_mfma_f32_32x32x16_bf16 v[96:111], v[224:227], v[196:199], v[96:111]
    ds_read_b64_tr_b16 v[236:237], v19 offset:12288
    ds_read_b64_tr_b16 v[238:239], v19 offset:13312
    v_mfma_f32_32x32x16_bf16 v[112:127], v[228:231], v[196:199], v[112:127]
    ds_read_b128 v[212:215], v17 offset:18432
    s_waitcnt lgkmcnt(7)
    v_mfma_f32_32x32x16_bf16 v[128:143], v[224:227], v[200:203], v[128:143]
    ds_read_b128 v[216:219], v17 offset:20480
    v_mfma_f32_32x32x16_bf16 v[144:159], v[228:231], v[200:203], v[144:159]
    ds_read_b128 v[220:223], v17 offset:22528
    s_waitcnt lgkmcnt(8)
    v_mfma_f32_32x32x16_bf16 v[160:175], v[224:227], v[204:207], v[160:175]
    v_mfma_f32_32x32x16_bf16 v[176:191], v[228:231], v[204:207], v[176:191]
    s_waitcnt vmcnt(6)
    s_barrier
    s_cmp_le_u32 s56, 3
    s_cselect_b32 s42, 0, s42
    s_cselect_b32 s46, 0, s46
    s_add_u32 m0, s62, 0
    s_nop 0
    buffer_load_dwordx4 v8, s[40:43], s54 offen offset:0 lds
    buffer_load_dwordx4 v9, s[40:43], s54 offen offset:1024 lds
    s_add_u32 m0, s63, 0
    s_nop 0
    buffer_load_dwordx4 v12, s[44:47], s55 offen offset:0 lds
    buffer_load_dwordx4 v13, s[44:47], s55 offen offset:1024 lds
    buffer_load_dword v60, v61, s[76:79], 0 offen
    v_add_u32 v61, 524288, v61
    s_add_u32 s54, s54, 64
    s_add_u32 s55, s55, 262144
    s_waitcnt lgkmcnt(5)
    v_mfma_f32_32x32x16_bf16 v[64:79], v[232:235], v[208:211], v[64:79]
    ds_read_b64_tr_b16 v[224:225], v18 offset:16384
    ds_read_b64_tr_b16 v[226:227], v18 offset:17408
    s_waitcnt lgkmcnt(5)
    v_mfma_f32_32x32x16_bf16 v[80:95], v[236:239], v[208:211], v[80:95]
    ds_read_b128 v[192:195], v16 offset:32768
    s_waitcnt lgkmcnt(5)
    v_mfma_f32_32x32x16_bf16 v[96:111], v[232:235], v[212:215], v[96:111]
    ds_read_b64_tr_b16 v[228:229], v19 offset:16384
    ds_read_b64_tr_b16 v[230:231], v19 offset:17408
    v_mfma_f32_32x32x16_bf16 v[112:127], v[236:239], v[212:215], v[112:127]
    ds_read_b128 v[196:199], v16 offset:34816
    s_waitcnt lgkmcnt(7)
    v_mfma_f32_32x32x16_bf16 v[128:143], v[232:235], v[216:219], v[128:143]
    ds_read_b128 v[200:203], v16 offset:36864
    v_mfma_f32_32x32x16_bf16 v[144:159], v[236:239], v[216:219], v[144:159]
    ds_read_b128 v[204:207], v16 offset:38912
    s_waitcnt lgkmcnt(8)
    v_mfma_f32_32x32x16_bf16 v[160:175], v[232:235], v[220:223], v[160:175]
    v_mfma_f32_32x32x16_bf16 v[176:191], v[236:239], v[220:223], v[176:191]
    s_sub_u32 s56, s56, 1
    s_waitcnt lgkmcnt(5)
    v_mfma_f32_32x32x16_bf16 v[64:79], v[224:227], v[192:195], v[64:79]
    ds_read_b64_tr_b16 v[232:233], v18 offset:20480
    ds_read_b64_tr_b16 v[234:235], v18 offset:21504
    s_waitcnt lgkmcnt(5)
    v_mfma_f32_32x32x16_bf16 v[80:95], v[228:231], v[192:195], v[80:95]
    ds_read_b128 v[208:211], v17 offset:32768
    s_waitcnt lgkmcnt(5)
    v_mfma_f32_32x32x16_bf16 v[96:111], v[224:227], v[196:199], v[96:111]
    ds_read_b64_tr_b16 v[236:237], v19 offset:20480
    ds_read_b64_tr_b16 v[238:239], v19 offset:21504
    v_mfma_f32_32x32x16_bf16 v[112:127], v[228:231], v[196:199], v[112:127]
    ds_read_b128 v[212:215], v17 offset:34816
    s_waitcnt lgkmcnt(7)
    v_mfma_f32_32x32x16_bf16 v[128:143], v[224:227], v[200:203], v[128:143]
    ds_read_b128 v[216:219], v17 offset:36864
    v_mfma_f32_32x32x16_bf16 v[144:159], v[228:231], v[200:203], v[144:159]
    ds_read_b128 v[220:223], v17 offset:38912
    s_waitcnt lgkmcnt(8)
    v_mfma_f32_32x32x16_bf16 v[160:175], v[224:227], v[204:207], v[160:175]
    v_mfma_f32_32x32x16_bf16 v[176:191], v[228:231], v[204:207], v[176:191]
    s_waitcnt vmcnt(6)
    s_barrier
    s_cmp_le_u32 s56, 3
    s_cselect_b32 s42, 0, s42
    s_cselect_b32 s46, 0, s46
    s_add_u32 m0, s62, 16384
    s_nop 0
    buffer_load_dwordx4 v8, s[40:43], s54 offen offset:0 lds
    buffer_load_dwordx4 v9, s[40:43], s54 offen offset:1024 lds
    s_add_u32 m0, s63, 8192
    s_nop 0
    buffer_load_dwordx4 v12, s[44:47], s55 offen offset:0 lds
    buffer_load_dwordx4 v13, s[44:47], s55 offen offset:1024 lds
    buffer_load_dword v60, v61, s[76:79], 0 offen
    v_add_u32 v61, 524288, v61
    s_add_u32 s54, s54, 64
    s_add_u32 s55, s55, 262144
    s_waitcnt lgkmcnt(5)
    v_mfma_f32_32x32x16_bf16 v[64:79], v[232:235], v[208:211], v[64:79]
    ds_read_b64_tr_b16 v[224:225], v18 offset:24576
    ds_read_b64_tr_b16 v[226:227], v18 offset:25600
    s_waitcnt lgkmcnt(5)
    v_mfma_f32_32x32x16_bf16 v[80:95], v[236:239], v[208:211], v[80:95]
    ds_read_b128 v[192:195], v16 offset:49152
    s_waitcnt lgkmcnt(5)
    v_mfma_f32_32x32x16_bf16 v[96:111], v[232:235], v[212:215], v[96:111]
    ds_read_b64_tr_b16 v[228:229], v19 offset:24576
    ds_read_b64_tr_b16 v[230:231], v19 offset:25600
    v_mfma_f32_32x32x16_bf16 v[112:127], v[236:239], v[212:215], v[112:127]
    ds_read_b128 v[196:199], v16 offset:51200
    s_waitcnt lgkmcnt(7)
    v_mfma_f32_32x32x16_bf16 v[128:143], v[232:235], v[216:219], v[128:143]
    ds_read_b128 v[200:203], v16 offset:53248
    v_mfma_f32_32x32x16_bf16 v[144:159], v[236:239], v[216:219], v[144:159]
    ds_read_b128 v[204:207], v16 offset:55296
    s_waitcnt lgkmcnt(8)
    v_mfma_f32_32x32x16_bf16 v[160:175], v[232:235], v[220:223], v[160:175]
    v_mfma_f32_32x32x16_bf16 v[176:191], v[236:239], v[220:223], v[176:191]
    s_sub_u32 s56, s56, 1
    s_waitcnt lgkmcnt(5)
    v_mfma_f32_32x32x16_bf16 v[64:79], v[224:227], v[192:195], v[64:79]
    ds_read_b64_tr_b16 v[232:233], v18 offset:28672
    ds_read_b64_tr_b16 v[234:235], v18 offset:29696
    s_waitcnt lgkmcnt(5)
    v_mfma_f32_32x32x16_bf16 v[80:95], v[228:231], v[192:195], v[80:95]
    ds_read_b128 v[208:211], v17 offset:49152
    s_waitcnt lgkmcnt(5)
    v_mfma_f32_32x32x16_bf16 v[96:111], v[224:227], v[196:199], v[96:111]
    ds_read_b64_tr_b16 v[236:237], v19 offset:28672
    ds_read_b64_tr_b16 v[238:239], v19 offset:29696
    v_mfma_f32_32x32x16_bf16 v[112:127], v[228:231], v[196:199], v[112:127]
    ds_read_b128 v[212:215], v17 offset:51200
    s_waitcnt lgkmcnt(7)
    v_mfma_f32_32x32x16_bf16 v[128:143], v[224:227], v[200:203], v[128:143]
    ds_read_b128 v[216:219], v17 offset:53248
    v_mfma_f32_32x32x16_bf16 v[144:159], v[228:231], v[200:203], v[144:159]
    ds_read_b128 v[220:223], v17 offset:55296
    s_waitcnt lgkmcnt(8)
    v_mfma_f32_32x32x16_bf16 v[160:175], v[224:227], v[204:207], v[160:175]
    v_mfma_f32_32x32x16_bf16 v[176:191], v[228:231], v[204:207], v[176:191]
    s_waitcnt vmcnt(6)
    s_barrier
    s_cmp_le_u32 s56, 3
    s_cselect_b32 s42, 0, s42
    s_cselect_b32 s46, 0, s46
    s_add_u32 m0, s62, 32768
    s_nop 0
    buffer_load_dwordx4 v8, s[40:43], s54 offen offset:0 lds
    buffer_load_dwordx4 v9, s[40:43], s54 offen offset:1024 lds
    s_add_u32 m0, s63, 16384
    s_nop 0
    buffer_load_dwordx4 v12, s[44:47], s55 offen offset:0 lds
    buffer_load_dwordx4 v13, s[44:47], s55 offen offset:1024 lds
    buffer_load_dword v60, v61, s[76:79], 0 offen
    v_add_u32 v61, 524288, v61
    s_add_u32 s54, s54, 64
    s_add_u32 s55, s55, 262144
    s_waitcnt lgkmcnt(5)
    v_mfma_f32_32x32x16_bf16 v[64:79], v[232:235], v[208:211], v[64:79]
    ds_read_b64_tr_b16 v[224:225], v18 offset:0
    ds_read_b64_tr_b16 v[226:227], v18 offset:1024
    s_waitcnt lgkmcnt(5)
    v_mfma_f32_32x32x16_bf16 v[80:95], v[236:239], v[208:211], v[80:95]
    ds_read_b128 v[192:195], v16 offset:0
    s_waitcnt lgkmcnt(5)
    v_mfma_f32_32x32x16_bf16 v[96:111], v[232:235], v[212:215], v[96:111]
    ds_read_b64_tr_b16 v[228:229], v19 offset:0
    ds_read_b64_tr_b16 v[230:231], v19 offset:1024
    v_mfma_f32_32x32x16_bf16 v[112:127], v[236:239], v[212:215], v[112:127]
    ds_read_b128 v[196:199], v16 offset:2048
    s_waitcnt lgkmcnt(7)
    v_mfma_f32_32x32x16_bf16 v[128:143], v[232:235], v[216:219], v[128:143]
    ds_read_b128 v[200:203], v16 offset:4096
    v_mfma_f32_32x32x16_bf16 v[144:159], v[236:239], v[216:219], v[144:159]
    ds_read_b128 v[204:207], v16 offset:6144
    s_waitcnt lgkmcnt(8)
    v_mfma_f32_32x32x16_bf16 v[160:175], v[232:235], v[220:223], v[160:175]
    v_mfma_f32_32x32x16_bf16 v[176:191], v[236:239], v[220:223], v[176:191]
    s_sub_u32 s56, s56, 1
    s_cmp_eq_u32 s56, 0
    s_waitcnt lgkmcnt(0)
    s_nop 8
    s_cbranch_scc1 gd_12
    s_branch gl_11
gd_12:
    s_waitcnt vmcnt(0) lgkmcnt(0)
    s_add_u32 s48, s38, 29360128
    s_addc_u32 s49, s39, 0
    s_and_b32 s49, s49, 0xffff
    s_mov_b32 s50, 16777216
    s_mov_b32 s51, 0x00020000
    s_lshl_b32 s64, s53, 12
    s_barrier
    s_mul_i32 s60, s57, 16384
    v_and_b32 v2, 31, v1
    v_lshlrev_b32 v2, 7, v2
    v_lshrrev_b32 v3, 5, v1
    v_lshl_add_u32 v2, v3, 3, v2
    v_add_u32 v2, s60, v2
    v_bfe_u32 v3, v1, 1, 3
    v_xor_b32 v4, 0, v3
    v_lshl_add_u32 v8, v4, 4, v2
    v_xor_b32 v4, 1, v3
    v_lshl_add_u32 v9, v4, 4, v2
    v_xor_b32 v4, 2, v3
    v_lshl_add_u32 v10, v4, 4, v2
    v_xor_b32 v4, 3, v3
    v_lshl_add_u32 v11, v4, 4, v2
    v_xor_b32 v4, 4, v3
    v_lshl_add_u32 v12, v4, 4, v2
    v_xor_b32 v4, 5, v3
    v_lshl_add_u32 v13, v4, 4, v2
    v_xor_b32 v4, 6, v3
    v_lshl_add_u32 v14, v4, 4, v2
    v_xor_b32 v4, 7, v3
    v_lshl_add_u32 v15, v4, 4, v2
    v_cvt_pk_bf16_f32 v24, v64, v65
    v_cvt_pk_bf16_f32 v25, v66, v67
    ds_write_b64 v8, v[24:25] offset:0
    v_cvt_pk_bf16_f32 v32, v68, v69
    v_cvt_pk_bf16_f32 v33, v70, v71
    ds_write_b64 v9, v[32:33] offset:0
    v_cvt_pk_bf16_f32 v40, v72, v73
    v_cvt_pk_bf16_f32 v41, v74, v75
    ds_write_b64 v10, v[40:41] offset:0
    v_cvt_pk_bf16_f32 v48, v76, v77
    v_cvt_pk_bf16_f32 v49, v78, v79
    ds_write_b64 v11, v[48:49] offset:0
    v_cvt_pk_bf16_f32 v24, v80, v81
    v_cvt_pk_bf16_f32 v25, v82, v83
    ds_write_b64 v12, v[24:25] offset:0
    v_cvt_pk_bf16_f32 v32, v84, v85
    v_cvt_pk_bf16_f32 v33, v86, v87
    ds_write_b64 v13, v[32:33] offset:0
    v_cvt_pk_bf16_f32 v40, v88, v89
    v_cvt_pk_bf16_f32 v41, v90, v91
    ds_write_b64 v14, v[40:41] offset:0
    v_cvt_pk_bf16_f32 v48, v92, v93
    v_cvt_pk_bf16_f32 v49, v94, v95
    ds_write_b64 v15, v[48:49] offset:0
    s_waitcnt lgkmcnt(0)
    v_cvt_pk_bf16_f32 v24, v96, v97
    v_cvt_pk_bf16_f32 v25, v98, v99
    ds_write_b64 v8, v[24:25] offset:4096
    v_cvt_pk_bf16_f32 v32, v100, v101
    v_cvt_pk_bf16_f32 v33, v102, v103
    ds_write_b64 v9, v[32:33] offset:4096
    v_cvt_pk_bf16_f32 v40, v104, v105
    v_cvt_pk_bf16_f32 v41, v106, v107
    ds_write_b64 v10, v[40:41] offset:4096
    v_cvt_pk_bf16_f32 v48, v108, v109
    v_cvt_pk_bf16_f32 v49, v110, v111
    ds_write_b64 v11, v[48:49] offset:4096
    v_cvt_pk_bf16_f32 v24, v112, v113
    v_cvt_pk_bf16_f32 v25, v114, v115
    ds_write_b64 v12, v[24:25] offset:4096
    v_cvt_pk_bf16_f32 v32, v116, v117
    v_cvt_pk_bf16_f32 v33, v118, v119
    ds_write_b64 v13, v[32:33] offset:4096
    v_cvt_pk_bf16_f32 v40, v120, v121
    v_cvt_pk_bf16_f32 v41, v122, v123
    ds_write_b64 v14, v[40:41] offset:4096
    v_cvt_pk_bf16_f32 v48, v124, v125
    v_cvt_pk_bf16_f32 v49, v126, v127
    ds_write_b64 v15, v[48:49] offset:4096
    s_waitcnt lgkmcnt(0)
    v_cvt_pk_bf16_f32 v24, v128, v129
    v_cvt_pk_bf16_f32 v25, v130, v131
    ds_write_b64 v8, v[24:25] offset:8192
    v_cvt_pk_bf16_f32 v32, v132, v133
    v_cvt_pk_bf16_f32 v33, v134, v135
    ds_write_b64 v9, v[32:33] offset:8192
    v_cvt_pk_bf16_f32 v40, v136, v137
    v_cvt_pk_bf16_f32 v41, v138, v139
    ds_write_b64 v10, v[40:41] offset:8192
    v_cvt_pk_bf16_f32 v48, v140, v141
    v_cvt_pk_bf16_f32 v49, v142, v143
    ds_write_b64 v11, v[48:49] offset:8192
    v_cvt_pk_bf16_f32 v24, v144, v145
    v_cvt_pk_bf16_f32 v25, v146, v147
    ds_write_b64 v12, v[24:25] offset:8192
    v_cvt_pk_bf16_f32 v32, v148, v149
    v_cvt_pk_bf16_f32 v33, v150, v151
    ds_write_b64 v13, v[32:33] offset:8192
    v_cvt_pk_bf16_f32 v40, v152, v153
    v_cvt_pk_bf16_f32 v41, v154, v155
    ds_write_b64 v14, v[40:41] offset:8192
    v_cvt_pk_bf16_f32 v48, v156, v157
    v_cvt_pk_bf16_f32 v49, v158, v159
    ds_write_b64 v15, v[48:49] offset:8192
    s_waitcnt lgkmcnt(0)
    v_cvt_pk_bf16_f32 v24, v160, v161
    v_cvt_pk_bf16_f32 v25, v162, v163
    ds_write_b64 v8, v[24:25] offset:12288
    v_cvt_pk_bf16_f32 v32, v164, v165
    v_cvt_pk_bf16_f32 v33, v166, v167
    ds_write_b64 v9, v[32:33] offset:12288
    v_cvt_pk_bf16_f32 v40, v168, v169
    v_cvt_pk_bf16_f32 v41, v170, v171
    ds_write_b64 v10, v[40:41] offset:12288
    v_cvt_pk_bf16_f32 v48, v172, v173
    v_cvt_pk_bf16_f32 v49, v174, v175
    ds_write_b64 v11, v[48:49] offset:12288
    v_cvt_pk_bf16_f32 v24, v176, v177
    v_cvt_pk_bf16_f32 v25, v178, v179
    ds_write_b64 v12, v[24:25] offset:12288
    v_cvt_pk_bf16_f32 v32, v180, v181
    v_cvt_pk_bf16_f32 v33, v182, v183
    ds_write_b64 v13, v[32:33] offset:12288
    v_cvt_pk_bf16_f32 v40, v184, v185
    v_cvt_pk_bf16_f32 v41, v186, v187
    ds_write_b64 v14, v[40:41] offset:12288
    v_cvt_pk_bf16_f32 v48, v188, v189
    v_cvt_pk_bf16_f32 v49, v190, v191
    ds_write_b64 v15, v[48:49] offset:12288
    s_waitcnt lgkmcnt(0)
    v_lshrrev_b32 v2, 3, v1
    v_and_b32 v3, 7, v1
    v_lshrrev_b32 v4, 4, v1
    v_xor_b32 v4, v4, v3
    v_lshlrev_b32 v5, 7, v2
    v_lshl_add_u32 v5, v4, 4, v5
    v_add_u32 v5, s60, v5
    v_xor_b32 v6, 64, v5
    s_mul_i32 s60, s58, 128
    s_add_u32 s60, s60, s52
    v_add_u32 v2, s60, v2
    s_mov_b32 s61, 256
    v_mul_lo_u32 v2, v2, s61
    v_lshlrev_b32 v3, 4, v3
    s_mul_i32 s60, s59, 128
    s_add_u32 s60, s60, s64
    v_add3_u32 v2, v2, v3, s60
    ds_read_b128 v[192:195], v5 offset:0
    ds_read_b128 v[196:199], v6 offset:1024
    ds_read_b128 v[200:203], v5 offset:2048
    ds_read_b128 v[204:207], v6 offset:3072
    ds_read_b128 v[208:211], v5 offset:4096
    ds_read_b128 v[212:215], v6 offset:5120
    ds_read_b128 v[216:219], v5 offset:6144
    ds_read_b128 v[220:223], v6 offset:7168
    s_mov_b32 s66, 0
    s_waitcnt lgkmcnt(7)
    buffer_store_dwordx4 v[192:195], v2, s[48:51], s66 offen
    s_nop 1
    ds_read_b128 v[192:195], v5 offset:8192
    s_mov_b32 s66, 2048
    s_waitcnt lgkmcnt(7)
    buffer_store_dwordx4 v[196:199], v2, s[48:51], s66 offen
    s_nop 1
    ds_read_b128 v[196:199], v6 offset:9216
    s_mov_b32 s66, 4096
    s_waitcnt lgkmcnt(7)
    buffer_store_dwordx4 v[200:203], v2, s[48:51], s66 offen
    s_nop 1
    ds_read_b128 v[200:203], v5 offset:10240
    s_mov_b32 s66, 6144
    s_waitcnt lgkmcnt(7)
    buffer_store_dwordx4 v[204:207], v2, s[48:51], s66 offen
    s_nop 1
    ds_read_b128 v[204:207], v6 offset:11264
    s_mov_b32 s66, 8192
    s_waitcnt lgkmcnt(7)
    buffer_store_dwordx4 v[208:211], v2, s[48:51], s66 offen
    s_nop 1
    ds_read_b128 v[208:211], v5 offset:12288
    s_mov_b32 s66, 10240
    s_waitcnt lgkmcnt(7)
    buffer_store_dwordx4 v[212:215], v2, s[48:51], s66 offen
    s_nop 1
    ds_read_b128 v[212:215], v6 offset:13312
    s_mov_b32 s66, 12288
    s_waitcnt lgkmcnt(7)
    buffer_store_dwordx4 v[216:219], v2, s[48:51], s66 offen
    s_nop 1
    ds_read_b128 v[216:219], v5 offset:14336
    s_mov_b32 s66, 14336
    s_waitcnt lgkmcnt(7)
    buffer_store_dwordx4 v[220:223], v2, s[48:51], s66 offen
    s_nop 1
    ds_read_b128 v[220:223], v6 offset:15360
    s_mov_b32 s66, 16384
    s_waitcnt lgkmcnt(7)
    buffer_store_dwordx4 v[192:195], v2, s[48:51], s66 offen
    s_mov_b32 s66, 18432
    s_waitcnt lgkmcnt(6)
    buffer_store_dwordx4 v[196:199], v2, s[48:51], s66 offen
    s_mov_b32 s66, 20480
    s_waitcnt lgkmcnt(5)
    buffer_store_dwordx4 v[200:203], v2, s[48:51], s66 offen
    s_mov_b32 s66, 22528
    s_waitcnt lgkmcnt(4)
    buffer_store_dwordx4 v[204:207], v2, s[48:51], s66 offen
    s_mov_b32 s66, 24576
    s_waitcnt lgkmcnt(3)
    buffer_store_dwordx4 v[208:211], v2, s[48:51], s66 offen
    s_mov_b32 s66, 26624
    s_waitcnt lgkmcnt(2)
    buffer_store_dwordx4 v[212:215], v2, s[48:51], s66 offen
    s_mov_b32 s66, 28672
    s_waitcnt lgkmcnt(1)
    buffer_store_dwordx4 v[216:219], v2, s[48:51], s66 offen
    s_mov_b32 s66, 30720
    s_waitcnt lgkmcnt(0)
    buffer_store_dwordx4 v[220:223], v2, s[48:51], s66 offen
    s_endpgm
    s_nop 0
job_4:
    s_mov_b32 s40, s24
    s_mov_b32 s41, s25
    s_and_b32 s41, s41, 0xffff
    s_mov_b32 s42, 2097152
    s_mov_b32 s43, 0x00020000
    s_mov_b32 s44, s30
    s_mov_b32 s45, s31
    s_and_b32 s45, s45, 0xffff
    s_mov_b32 s46, 4194304
    s_mov_b32 s47, 0x00020000
    v_and_b32 v1, 63, v0
    s_and_b32 s70, s57, 3
    s_lshr_b32 s58, s70, 1
    s_and_b32 s59, s70, 1
    s_mul_i32 s72, s71, 32768
    s_add_u32 s72, s72, 65536
    v_lshrrev_b32 v2, 2, v1
    v_bfe_u32 v3, v1, 4, 2
    v_and_b32 v4, 3, v1
    v_xor_b32 v4, v4, v3
    s_mul_i32 s60, s57, 32
    s_add_u32 s60, s60, s52
    v_add_u32 v2, s60, v2
    s_mov_b32 s61, 1024
    v_mul_lo_u32 v2, v2, s61
    v_lshl_add_u32 v2, v4, 4, v2
    v_add_u32 v8, 0, v2
    v_add_u32 v9, 15360, v2
    v_lshrrev_b32 v2, 4, v1
    v_and_b32 v3, 15, v1
    v_lshrrev_b32 v4, 2, v3
    v_bfe_u32 v5, v1, 4, 2
    v_xor_b32 v4, v4, v5
    v_and_b32 v3, 3, v3
    v_lshlrev_b32 v3, 4, v3
    v_lshl_add_u32 v3, v4, 6, v3
    s_mul_i32 s60, s70, 8
    v_add_u32 v2, s60, v2
    s_mov_b32 s61, 8192
    v_mul_lo_u32 v2, v2, s61
    v_add_u32 v2, v2, v3
    s_lshl_b32 s60, s53, 1
    v_add_u32 v2, s60, v2
    v_add_u32 v12, 0, v2
    v_add_u32 v13, 31744, v2
    v_and_b32 v2, 31, v1
    v_lshrrev_b32 v3, 5, v1
    v_bfe_u32 v4, v1, 2, 2
    v_xor_b32 v4, v4, v3
    s_mul_i32 s60, s58, 128
    v_add_u32 v2, s60, v2
    v_lshlrev_b32 v2, 6, v2
    v_lshl_add_u32 v16, v4, 4, v2
    v_xor_b32 v17, 32, v16
    v_bfe_u32 v2, v1, 2, 2
    v_lshrrev_b32 v3, 5, v1
    v_lshl_add_u32 v3, v3, 3, v2
    v_mul_u32_u24 v3, 256, v3
    v_mov_b32 v4, v2
    s_mul_i32 s60, s59, 2
    v_xor_b32 v4, s60, v4
    v_lshl_add_u32 v3, v4, 6, v3
    v_bfe_u32 v4, v1, 4, 1
    v_and_b32 v5, 3, v1
    v_lshlrev_b32 v5, 3, v5
    v_lshl_add_u32 v5, v4, 5, v5
    v_add_u32 v3, v3, v5
    v_add_u32 v18, s72, v3
    v_xor_b32 v19, 64, v18
    s_mul_i32 s62, s57, 2048
    s_mul_i32 s63, s70, 2048
    s_add_u32 s63, s63, s72
    s_mov_b32 s54, 0
    s_mov_b32 s55, 0
    v_mov_b32 v64, 0
    v_mov_b32 v65, 0
    v_mov_b32 v66, 0
    v_mov_b32 v67, 0
    v_mov_b32 v68, 0
    v_mov_b32 v69, 0
    v_mov_b32 v70, 0
    v_mov_b32 v71, 0
    v_mov_b32 v72, 0
    v_mov_b32 v73, 0
    v_mov_b32 v74, 0
    v_mov_b32 v75, 0
    v_mov_b32 v76, 0
    v_mov_b32 v77, 0
    v_mov_b32 v78, 0
    v_mov_b32 v79, 0
    v_mov_b32 v80, 0
    v_mov_b32 v81, 0
    v_mov_b32 v82, 0
    v_mov_b32 v83, 0
    v_mov_b32 v84, 0
    v_mov_b32 v85, 0
    v_mov_b32 v86, 0
    v_mov_b32 v87, 0
    v_mov_b32 v88, 0
    v_mov_b32 v89, 0
    v_mov_b32 v90, 0
    v_mov_b32 v91, 0
    v_mov_b32 v92, 0
    v_mov_b32 v93, 0
    v_mov_b32 v94, 0
    v_mov_b32 v95, 0
    v_mov_b32 v96, 0
    v_mov_b32 v97, 0
    v_mov_b32 v98, 0
    v_mov_b32 v99, 0
    v_mov_b32 v100, 0
    v_mov_b32 v101, 0
    v_mov_b32 v102, 0
    v_mov_b32 v103, 0
    v_mov_b32 v104, 0
    v_mov_b32 v105, 0
    v_mov_b32 v106, 0
    v_mov_b32 v107, 0
    v_mov_b32 v108, 0
    v_mov_b32 v109, 0
    v_mov_b32 v110, 0
    v_mov_b32 v111, 0
    v_mov_b32 v112, 0
    v_mov_b32 v113, 0
    v_mov_b32 v114, 0
    v_mov_b32 v115, 0
    v_mov_b32 v116, 0
    v_mov_b32 v117, 0
    v_mov_b32 v118, 0
    v_mov_b32 v119, 0
    v_mov_b32 v120, 0
    v_mov_b32 v121, 0
    v_mov_b32 v122, 0
    v_mov_b32 v123, 0
    v_mov_b32 v124, 0
    v_mov_b32 v125, 0
    v_mov_b32 v126, 0
    v_mov_b32 v127, 0
    v_mov_b32 v128, 0
    v_mov_b32 v129, 0
    v_mov_b32 v130, 0
    v_mov_b32 v131, 0
    v_mov_b32 v132, 0
    v_mov_b32 v133, 0
    v_mov_b32 v134, 0
    v_mov_b32 v135, 0
    v_mov_b32 v136, 0
    v_mov_b32 v137, 0
    v_mov_b32 v138, 0
    v_mov_b32 v139, 0
    v_mov_b32 v140, 0
    v_mov_b32 v141, 0
    v_mov_b32 v142, 0
    v_mov_b32 v143, 0
    v_mov_b32 v144, 0
    v_mov_b32 v145, 0
    v_mov_b32 v146, 0
    v_mov_b32 v147, 0
    v_mov_b32 v148, 0
    v_mov_b32 v149, 0
    v_mov_b32 v150, 0
    v_mov_b32 v151, 0
    v_mov_b32 v152, 0
    v_mov_b32 v153, 0
    v_mov_b32 v154, 0
    v_mov_b32 v155, 0
    v_mov_b32 v156, 0
    v_mov_b32 v157, 0
    v_mov_b32 v158, 0
    v_mov_b32 v159, 0
    v_mov_b32 v160, 0
    v_mov_b32 v161, 0
    v_mov_b32 v162, 0
    v_mov_b32 v163, 0
    v_mov_b32 v164, 0
    v_mov_b32 v165, 0
    v_mov_b32 v166, 0
    v_mov_b32 v167, 0
    v_mov_b32 v168, 0
    v_mov_b32 v169, 0
    v_mov_b32 v170, 0
    v_mov_b32 v171, 0
    v_mov_b32 v172, 0
    v_mov_b32 v173, 0
    v_mov_b32 v174, 0
    v_mov_b32 v175, 0
    v_mov_b32 v176, 0
    v_mov_b32 v177, 0
    v_mov_b32 v178, 0
    v_mov_b32 v179, 0
    v_mov_b32 v180, 0
    v_mov_b32 v181, 0
    v_mov_b32 v182, 0
    v_mov_b32 v183, 0
    v_mov_b32 v184, 0
    v_mov_b32 v185, 0
    v_mov_b32 v186, 0
    v_mov_b32 v187, 0
    v_mov_b32 v188, 0
    v_mov_b32 v189, 0
    v_mov_b32 v190, 0
    v_mov_b32 v191, 0
    s_add_u32 m0, s62, 0
    s_nop 0
    buffer_load_dwordx4 v8, s[40:43], s54 offen offset:0 lds
    buffer_load_dwordx4 v9, s[40:43], s54 offen offset:1024 lds
    s_add_u32 m0, s63, 0
    s_nop 0
    buffer_load_dwordx4 v12, s[44:47], s55 offen offset:0 lds
    buffer_load_dwordx4 v13, s[44:47], s55 offen offset:1024 lds
    buffer_load_dword v60, v61, s[76:79], 0 offen
    v_add_u32 v61, 524288, v61
    s_add_u32 s54, s54, 64
    s_add_u32 s55, s55, 262144
    s_add_u32 m0, s62, 16384
    s_nop 0
    buffer_load_dwordx4 v8, s[40:43], s54 offen offset:0 lds
    buffer_load_dwordx4 v9, s[40:43], s54 offen offset:1024 lds
    s_add_u32 m0, s63, 8192
    s_nop 0
    buffer_load_dwordx4 v12, s[44:47], s55 offen offset:0 lds
    buffer_load_dwordx4 v13, s[44:47], s55 offen offset:1024 lds
    buffer_load_dword v60, v61, s[76:79], 0 offen
    v_add_u32 v61, 524288, v61
    s_add_u32 s54, s54, 64
    s_add_u32 s55, s55, 262144
    s_add_u32 m0, s62, 32768
    s_nop 0
    buffer_load_dwordx4 v8, s[40:43], s54 offen offset:0 lds
    buffer_load_dwordx4 v9, s[40:43], s54 offen offset:1024 lds
    s_add_u32 m0, s63, 16384
    s_nop 0
    buffer_load_dwordx4 v12, s[44:47], s55 offen offset:0 lds
    buffer_load_dwordx4 v13, s[44:47], s55 offen offset:1024 lds
    buffer_load_dword v60, v61, s[76:79], 0 offen
    v_add_u32 v61, 524288, v61
    s_add_u32 s54, s54, 64
    s_add_u32 s55, s55, 262144
    s_mov_b32 s56, 16
    s_waitcnt vmcnt(11)
    s_barrier
    ds_read_b64_tr_b16 v[224:225], v18 offset:0
    ds_read_b64_tr_b16 v[226:227], v18 offset:1024
    ds_read_b128 v[192:195], v16 offset:0
    ds_read_b64_tr_b16 v[228:229], v19 offset:0
    ds_read_b64_tr_b16 v[230:231], v19 offset:1024
    ds_read_b128 v[196:199], v16 offset:2048
    ds_read_b128 v[200:203], v16 offset:4096
    ds_read_b128 v[204:207], v16 offset:6144
    s_waitcnt lgkmcnt(0)
gl_13:
    v_mfma_f32_32x32x16_bf16 v[64:79], v[192:195], v[224:227], v[64:79]
    ds_read_b64_tr_b16 v[232:233], v18 offset:4096
    ds_read_b64_tr_b16 v[234:235], v18 offset:5120
    v_mfma_f32_32x32x16_bf16 v[80:95], v[192:195], v[228:231], v[80:95]
    ds_read_b128 v[208:211], v17 offset:0
    v_mfma_f32_32x32x16_bf16 v[96:111], v[196:199], v[224:227], v[96:111]
    ds_read_b64_tr_b16 v[236:237], v19 offset:4096
    ds_read_b64_tr_b16 v[238:239], v19 offset:5120
    v_mfma_f32_32x32x16_bf16 v[112:127], v[196:199], v[228:231], v[112:127]
    ds_read_b128 v[212:215], v17 offset:2048
    v_mfma_f32_32x32x16_bf16 v[128:143], v[200:203], v[224:227], v[128:143]
    ds_read_b128 v[216:219], v17 offset:4096
    v_mfma_f32_32x32x16_bf16 v[144:159], v[200:203], v[228:231], v[144:159]
    ds_read_b128 v[220:223], v17 offset:6144
    v_mfma_f32_32x32x16_bf16 v[160:175], v[204:207], v[224:227], v[160:175]
    v_mfma_f32_32x32x16_bf16 v[176:191], v[204:207], v[228:231], v[176:191]
    s_waitcnt vmcnt(6)
    s_barrier
    s_cmp_le_u32 s56, 3
    s_cselect_b32 s42, 0, s42
    s_cselect_b32 s46, 0, s46
    s_add_u32 m0, s62, 49152
    s_nop 0
    buffer_load_dwordx4 v8, s[40:43], s54 offen offset:0 lds
    buffer_load_dwordx4 v9, s[40:43], s54 offen offset:1024 lds
    s_add_u32 m0, s63, 24576
    s_nop 0
    buffer_load_dwordx4 v12, s[44:47], s55 offen offset:0 lds
    buffer_load_dwordx4 v13, s[44:47], s55 offen offset:1024 lds
    buffer_load_dword v60, v61, s[76:79], 0 offen
    v_add_u32 v61, 524288, v61
    s_add_u32 s54, s54, 64
    s_add_u32 s55, s55, 262144
    s_waitcnt lgkmcnt(5)
    v_mfma_f32_32x32x16_bf16 v[64:79], v[208:211], v[232:235], v[64:79]
    ds_read_b64_tr_b16 v[224:225], v18 offset:8192
    ds_read_b64_tr_b16 v[226:227], v18 offset:9216
    s_waitcnt lgkmcnt(5)
    v_mfma_f32_32x32x16_bf16 v[80:95], v[208:211], v[236:239], v[80:95]
    ds_read_b128 v[192:195], v16 offset:16384
    s_waitcnt lgkmcnt(5)
    v_mfma_f32_32x32x16_bf16 v[96:111], v[212:215], v[232:235], v[96:111]
    ds_read_b64_tr_b16 v[228:229], v19 offset:8192
    ds_read_b64_tr_b16 v[230:231], v19 offset:9216
    v_mfma_f32_32x32x16_bf16 v[112:127], v[212:215], v[236:239], v[112:127]
    ds_read_b128 v[196:199], v16 offset:18432
    s_waitcnt lgkmcnt(7)
    v_mfma_f32_32x32x16_bf16 v[128:143], v[216:219], v[232:235], v[128:143]
    ds_read_b128 v[200:203], v16 offset:20480
    v_mfma_f32_32x32x16_bf16 v[144:159], v[216:219], v[236:239], v[144:159]
    ds_read_b128 v[204:207], v16 offset:22528
    s_waitcnt lgkmcnt(8)
    v_mfma_f32_32x32x16_bf16 v[160:175], v[220:223], v[232:235], v[160:175]
    v_mfma_f32_32x32x16_bf16 v[176:191], v[220:223], v[236:239], v[176:191]
    s_sub_u32 s56, s56, 1
    s_waitcnt lgkmcnt(5)
    v_mfma_f32_32x32x16_bf16 v[64:79], v[192:195], v[224:227], v[64:79]
    ds_read_b64_tr_b16 v[232:233], v18 offset:12288
    ds_read_b64_tr_b16 v[234:235], v18 offset:13312
    s_waitcnt lgkmcnt(5)
    v_mfma_f32_32x32x16_bf16 v[80:95], v[192:195], v[228:231], v[80:95]
    ds_read_b128 v[208:211], v17 offset:16384
    s_waitcnt lgkmcnt(5)
    v_mfma_f32_32x32x16_bf16 v[96:111], v[196:199], v[224:227], v[96:111]
    ds_read_b64_tr_b16 v[236:237], v19 offset:12288
    ds_read_b64_tr_b16 v[238:239], v19 offset:13312
    v_mfma_f32_32x32x16_bf16 v[112:127], v[196:199], v[228:231], v[112:127]
    ds_read_b128 v[212:215], v17 offset:18432
    s_waitcnt lgkmcnt(7)
    v_mfma_f32_32x32x16_bf16 v[128:143], v[200:203], v[224:227], v[128:143]
    ds_read_b128 v[216:219], v17 offset:20480
    v_mfma_f32_32x32x16_bf16 v[144:159], v[200:203], v[228:231], v[144:159]
    ds_read_b128 v[220:223], v17 offset:22528
    s_waitcnt lgkmcnt(8)
    v_mfma_f32_32x32x16_bf16 v[160:175], v[204:207], v[224:227], v[160:175]
    v_mfma_f32_32x32x16_bf16 v[176:191], v[204:207], v[228:231], v[176:191]
    s_waitcnt vmcnt(6)
    s_barrier
    s_cmp_le_u32 s56, 3
    s_cselect_b32 s42, 0, s42
    s_cselect_b32 s46, 0, s46
    s_add_u32 m0, s62, 0
    s_nop 0
    buffer_load_dwordx4 v8, s[40:43], s54 offen offset:0 lds
    buffer_load_dwordx4 v9, s[40:43], s54 offen offset:1024 lds
    s_add_u32 m0, s63, 0
    s_nop 0
    buffer_load_dwordx4 v12, s[44:47], s55 offen offset:0 lds
    buffer_load_dwordx4 v13, s[44:47], s55 offen offset:1024 lds
    buffer_load_dword v60, v61, s[76:79], 0 offen
    v_add_u32 v61, 524288, v61
    s_add_u32 s54, s54, 64
    s_add_u32 s55, s55, 262144
    s_waitcnt lgkmcnt(5)
    v_mfma_f32_32x32x16_bf16 v[64:79], v[208:211], v[232:235], v[64:79]
    ds_read_b64_tr_b16 v[224:225], v18 offset:16384
    ds_read_b64_tr_b16 v[226:227], v18 offset:17408
    s_waitcnt lgkmcnt(5)
    v_mfma_f32_32x32x16_bf16 v[80:95], v[208:211], v[236:239], v[80:95]
    ds_read_b128 v[192:195], v16 offset:32768
    s_waitcnt lgkmcnt(5)
    v_mfma_f32_32x32x16_bf16 v[96:111], v[212:215], v[232:235], v[96:111]
    ds_read_b64_tr_b16 v[228:229], v19 offset:16384
    ds_read_b64_tr_b16 v[230:231], v19 offset:17408
    v_mfma_f32_32x32x16_bf16 v[112:127], v[212:215], v[236:239], v[112:127]
    ds_read_b128 v[196:199], v16 offset:34816
    s_waitcnt lgkmcnt(7)
    v_mfma_f32_32x32x16_bf16 v[128:143], v[216:219], v[232:235], v[128:143]
    ds_read_b128 v[200:203], v16 offset:36864
    v_mfma_f32_32x32x16_bf16 v[144:159], v[216:219], v[236:239], v[144:159]
    ds_read_b128 v[204:207], v16 offset:38912
    s_waitcnt lgkmcnt(8)
    v_mfma_f32_32x32x16_bf16 v[160:175], v[220:223], v[232:235], v[160:175]
    v_mfma_f32_32x32x16_bf16 v[176:191], v[220:223], v[236:239], v[176:191]
    s_sub_u32 s56, s56, 1
    s_waitcnt lgkmcnt(5)
    v_mfma_f32_32x32x16_bf16 v[64:79], v[192:195], v[224:227], v[64:79]
    ds_read_b64_tr_b16 v[232:233], v18 offset:20480
    ds_read_b64_tr_b16 v[234:235], v18 offset:21504
    s_waitcnt lgkmcnt(5)
    v_mfma_f32_32x32x16_bf16 v[80:95], v[192:195], v[228:231], v[80:95]
    ds_read_b128 v[208:211], v17 offset:32768
    s_waitcnt lgkmcnt(5)
    v_mfma_f32_32x32x16_bf16 v[96:111], v[196:199], v[224:227], v[96:111]
    ds_read_b64_tr_b16 v[236:237], v19 offset:20480
    ds_read_b64_tr_b16 v[238:239], v19 offset:21504
    v_mfma_f32_32x32x16_bf16 v[112:127], v[196:199], v[228:231], v[112:127]
    ds_read_b128 v[212:215], v17 offset:34816
    s_waitcnt lgkmcnt(7)
    v_mfma_f32_32x32x16_bf16 v[128:143], v[200:203], v[224:227], v[128:143]
    ds_read_b128 v[216:219], v17 offset:36864
    v_mfma_f32_32x32x16_bf16 v[144:159], v[200:203], v[228:231], v[144:159]
    ds_read_b128 v[220:223], v17 offset:38912
    s_waitcnt lgkmcnt(8)
    v_mfma_f32_32x32x16_bf16 v[160:175], v[204:207], v[224:227], v[160:175]
    v_mfma_f32_32x32x16_bf16 v[176:191], v[204:207], v[228:231], v[176:191]
    s_waitcnt vmcnt(6)
    s_barrier
    s_cmp_le_u32 s56, 3
    s_cselect_b32 s42, 0, s42
    s_cselect_b32 s46, 0, s46
    s_add_u32 m0, s62, 16384
    s_nop 0
    buffer_load_dwordx4 v8, s[40:43], s54 offen offset:0 lds
    buffer_load_dwordx4 v9, s[40:43], s54 offen offset:1024 lds
    s_add_u32 m0, s63, 8192
    s_nop 0
    buffer_load_dwordx4 v12, s[44:47], s55 offen offset:0 lds
    buffer_load_dwordx4 v13, s[44:47], s55 offen offset:1024 lds
    buffer_load_dword v60, v61, s[76:79], 0 offen
    v_add_u32 v61, 524288, v61
    s_add_u32 s54, s54, 64
    s_add_u32 s55, s55, 262144
    s_waitcnt lgkmcnt(5)
    v_mfma_f32_32x32x16_bf16 v[64:79], v[208:211], v[232:235], v[64:79]
    ds_read_b64_tr_b16 v[224:225], v18 offset:24576
    ds_read_b64_tr_b16 v[226:227], v18 offset:25600
    s_waitcnt lgkmcnt(5)
    v_mfma_f32_32x32x16_bf16 v[80:95], v[208:211], v[236:239], v[80:95]
    ds_read_b128 v[192:195], v16 offset:49152
    s_waitcnt lgkmcnt(5)
    v_mfma_f32_32x32x16_bf16 v[96:111], v[212:215], v[232:235], v[96:111]
    ds_read_b64_tr_b16 v[228:229], v19 offset:24576
    ds_read_b64_tr_b16 v[230:231], v19 offset:25600
    v_mfma_f32_32x32x16_bf16 v[112:127], v[212:215], v[236:239], v[112:127]
    ds_read_b128 v[196:199], v16 offset:51200
    s_waitcnt lgkmcnt(7)
    v_mfma_f32_32x32x16_bf16 v[128:143], v[216:219], v[232:235], v[128:143]
    ds_read_b128 v[200:203], v16 offset:53248
    v_mfma_f32_32x32x16_bf16 v[144:159], v[216:219], v[236:239], v[144:159]
    ds_read_b128 v[204:207], v16 offset:55296
    s_waitcnt lgkmcnt(8)
    v_mfma_f32_32x32x16_bf16 v[160:175], v[220:223], v[232:235], v[160:175]
    v_mfma_f32_32x32x16_bf16 v[176:191], v[220:223], v[236:239], v[176:191]
    s_sub_u32 s56, s56, 1
    s_waitcnt lgkmcnt(5)
    v_mfma_f32_32x32x16_bf16 v[64:79], v[192:195], v[224:227], v[64:79]
    ds_read_b64_tr_b16 v[232:233], v18 offset:28672
    ds_read_b64_tr_b16 v[234:235], v18 offset:29696
    s_waitcnt lgkmcnt(5)
    v_mfma_f32_32x32x16_bf16 v[80:95], v[192:195], v[228:231], v[80:95]
    ds_read_b128 v[208:211], v17 offset:49152
    s_waitcnt lgkmcnt(5)
    v_mfma_f32_32x32x16_bf16 v[96:111], v[196:199], v[224:227], v[96:111]
    ds_read_b64_tr_b16 v[236:237], v19 offset:28672
    ds_read_b64_tr_b16 v[238:239], v19 offset:29696
    v_mfma_f32_32x32x16_bf16 v[112:127], v[196:199], v[228:231], v[112:127]
    ds_read_b128 v[212:215], v17 offset:51200
    s_waitcnt lgkmcnt(7)
    v_mfma_f32_32x32x16_bf16 v[128:143], v[200:203], v[224:227], v[128:143]
    ds_read_b128 v[216:219], v17 offset:53248
    v_mfma_f32_32x32x16_bf16 v[144:159], v[200:203], v[228:231], v[144:159]
    ds_read_b128 v[220:223], v17 offset:55296
    s_waitcnt lgkmcnt(8)
    v_mfma_f32_32x32x16_bf16 v[160:175], v[204:207], v[224:227], v[160:175]
    v_mfma_f32_32x32x16_bf16 v[176:191], v[204:207], v[228:231], v[176:191]
    s_waitcnt vmcnt(6)
    s_barrier
    s_cmp_le_u32 s56, 3
    s_cselect_b32 s42, 0, s42
    s_cselect_b32 s46, 0, s46
    s_add_u32 m0, s62, 32768
    s_nop 0
    buffer_load_dwordx4 v8, s[40:43], s54 offen offset:0 lds
    buffer_load_dwordx4 v9, s[40:43], s54 offen offset:1024 lds
    s_add_u32 m0, s63, 16384
    s_nop 0
    buffer_load_dwordx4 v12, s[44:47], s55 offen offset:0 lds
    buffer_load_dwordx4 v13, s[44:47], s55 offen offset:1024 lds
    buffer_load_dword v60, v61, s[76:79], 0 offen
    v_add_u32 v61, 524288, v61
    s_add_u32 s54, s54, 64
    s_add_u32 s55, s55, 262144
    s_waitcnt lgkmcnt(5)
    v_mfma_f32_32x32x16_bf16 v[64:79], v[208:211], v[232:235], v[64:79]
    ds_read_b64_tr_b16 v[224:225], v18 offset:0
    ds_read_b64_tr_b16 v[226:227], v18 offset:1024
    s_waitcnt lgkmcnt(5)
    v_mfma_f32_32x32x16_bf16 v[80:95], v[208:211], v[236:239], v[80:95]
    ds_read_b128 v[192:195], v16 offset:0
    s_waitcnt lgkmcnt(5)
    v_mfma_f32_32x32x16_bf16 v[96:111], v[212:215], v[232:235], v[96:111]
    ds_read_b64_tr_b16 v[228:229], v19 offset:0
    ds_read_b64_tr_b16 v[230:231], v19 offset:1024
    v_mfma_f32_32x32x16_bf16 v[112:127], v[212:215], v[236:239], v[112:127]
    ds_read_b128 v[196:199], v16 offset:2048
    s_waitcnt lgkmcnt(7)
    v_mfma_f32_32x32x16_bf16 v[128:143], v[216:219], v[232:235], v[128:143]
    ds_read_b128 v[200:203], v16 offset:4096
    v_mfma_f32_32x32x16_bf16 v[144:159], v[216:219], v[236:239], v[144:159]
    ds_read_b128 v[204:207], v16 offset:6144
    s_waitcnt lgkmcnt(8)
    v_mfma_f32_32x32x16_bf16 v[160:175], v[220:223], v[232:235], v[160:175]
    v_mfma_f32_32x32x16_bf16 v[176:191], v[220:223], v[236:239], v[176:191]
    s_sub_u32 s56, s56, 1
    s_cmp_eq_u32 s56, 0
    s_waitcnt lgkmcnt(0)
    s_nop 8
    s_cbranch_scc1 gd_14
    s_branch gl_13
gd_14:
    s_waitcnt vmcnt(0) lgkmcnt(0)
    s_add_u32 s48, s38, 46137344
    s_addc_u32 s49, s39, 0
    s_and_b32 s49, s49, 0xffff
    s_mov_b32 s50, 16777216
    s_mov_b32 s51, 0x00020000
    s_barrier
    s_mul_i32 s60, s57, 16384
    v_and_b32 v2, 31, v1
    v_lshlrev_b32 v2, 8, v2
    v_add_u32 v2, s60, v2
    v_and_b32 v3, 15, v1
    v_lshrrev_b32 v4, 5, v1
    v_xor_b32 v3, v3, v4
    v_xor_b32 v4, 0, v3
    v_lshl_add_u32 v8, v4, 4, v2
    v_xor_b32 v4, 2, v3
    v_lshl_add_u32 v9, v4, 4, v2
    v_xor_b32 v4, 4, v3
    v_lshl_add_u32 v10, v4, 4, v2
    v_xor_b32 v4, 6, v3
    v_lshl_add_u32 v11, v4, 4, v2
    v_xor_b32 v4, 8, v3
    v_lshl_add_u32 v12, v4, 4, v2
    v_xor_b32 v4, 10, v3
    v_lshl_add_u32 v13, v4, 4, v2
    v_xor_b32 v4, 12, v3
    v_lshl_add_u32 v14, v4, 4, v2
    v_xor_b32 v4, 14, v3
    v_lshl_add_u32 v15, v4, 4, v2
    v_cvt_pk_bf16_f32 v24, v64, v65
    v_cvt_pk_bf16_f32 v25, v66, v67
    ds_write_b64 v8, v[24:25] offset:0
    v_cvt_pk_bf16_f32 v32, v68, v69
    v_cvt_pk_bf16_f32 v33, v70, v71
    ds_write_b64 v8, v[32:33] offset:8
    v_cvt_pk_bf16_f32 v40, v72, v73
    v_cvt_pk_bf16_f32 v41, v74, v75
    ds_write_b64 v9, v[40:41] offset:0
    v_cvt_pk_bf16_f32 v48, v76, v77
    v_cvt_pk_bf16_f32 v49, v78, v79
    ds_write_b64 v9, v[48:49] offset:8
    s_waitcnt lgkmcnt(0)
    v_cvt_pk_bf16_f32 v24, v96, v97
    v_cvt_pk_bf16_f32 v25, v98, v99
    ds_write_b64 v10, v[24:25] offset:0
    v_cvt_pk_bf16_f32 v32, v100, v101
    v_cvt_pk_bf16_f32 v33, v102, v103
    ds_write_b64 v10, v[32:33] offset:8
    v_cvt_pk_bf16_f32 v40, v104, v105
    v_cvt_pk_bf16_f32 v41, v106, v107
    ds_write_b64 v11, v[40:41] offset:0
    v_cvt_pk_bf16_f32 v48, v108, v109
    v_cvt_pk_bf16_f32 v49, v110, v111
    ds_write_b64 v11, v[48:49] offset:8
    s_waitcnt lgkmcnt(0)
    v_cvt_pk_bf16_f32 v24, v128, v129
    v_cvt_pk_bf16_f32 v25, v130, v131
    ds_write_b64 v12, v[24:25] offset:0
    v_cvt_pk_bf16_f32 v32, v132, v133
    v_cvt_pk_bf16_f32 v33, v134, v135
    ds_write_b64 v12, v[32:33] offset:8
    v_cvt_pk_bf16_f32 v40, v136, v137
    v_cvt_pk_bf16_f32 v41, v138, v139
    ds_write_b64 v13, v[40:41] offset:0
    v_cvt_pk_bf16_f32 v48, v140, v141
    v_cvt_pk_bf16_f32 v49, v142, v143
    ds_write_b64 v13, v[48:49] offset:8
    s_waitcnt lgkmcnt(0)
    v_cvt_pk_bf16_f32 v24, v160, v161
    v_cvt_pk_bf16_f32 v25, v162, v163
    ds_write_b64 v14, v[24:25] offset:0
    v_cvt_pk_bf16_f32 v32, v164, v165
    v_cvt_pk_bf16_f32 v33, v166, v167
    ds_write_b64 v14, v[32:33] offset:8
    v_cvt_pk_bf16_f32 v40, v168, v169
    v_cvt_pk_bf16_f32 v41, v170, v171
    ds_write_b64 v15, v[40:41] offset:0
    v_cvt_pk_bf16_f32 v48, v172, v173
    v_cvt_pk_bf16_f32 v49, v174, v175
    ds_write_b64 v15, v[48:49] offset:8
    s_waitcnt lgkmcnt(0)
    v_cvt_pk_bf16_f32 v24, v80, v81
    v_cvt_pk_bf16_f32 v25, v82, v83
    ds_write_b64 v8, v[24:25] offset:8192
    v_cvt_pk_bf16_f32 v32, v84, v85
    v_cvt_pk_bf16_f32 v33, v86, v87
    ds_write_b64 v8, v[32:33] offset:8200
    v_cvt_pk_bf16_f32 v40, v88, v89
    v_cvt_pk_bf16_f32 v41, v90, v91
    ds_write_b64 v9, v[40:41] offset:8192
    v_cvt_pk_bf16_f32 v48, v92, v93
    v_cvt_pk_bf16_f32 v49, v94, v95
    ds_write_b64 v9, v[48:49] offset:8200
    s_waitcnt lgkmcnt(0)
    v_cvt_pk_bf16_f32 v24, v112, v113
    v_cvt_pk_bf16_f32 v25, v114, v115
    ds_write_b64 v10, v[24:25] offset:8192
    v_cvt_pk_bf16_f32 v32, v116, v117
    v_cvt_pk_bf16_f32 v33, v118, v119
    ds_write_b64 v10, v[32:33] offset:8200
    v_cvt_pk_bf16_f32 v40, v120, v121
    v_cvt_pk_bf16_f32 v41, v122, v123
    ds_write_b64 v11, v[40:41] offset:8192
    v_cvt_pk_bf16_f32 v48, v124, v125
    v_cvt_pk_bf16_f32 v49, v126, v127
    ds_write_b64 v11, v[48:49] offset:8200
    s_waitcnt lgkmcnt(0)
    v_cvt_pk_bf16_f32 v24, v144, v145
    v_cvt_pk_bf16_f32 v25, v146, v147
    ds_write_b64 v12, v[24:25] offset:8192
    v_cvt_pk_bf16_f32 v32, v148, v149
    v_cvt_pk_bf16_f32 v33, v150, v151
    ds_write_b64 v12, v[32:33] offset:8200
    v_cvt_pk_bf16_f32 v40, v152, v153
    v_cvt_pk_bf16_f32 v41, v154, v155
    ds_write_b64 v13, v[40:41] offset:8192
    v_cvt_pk_bf16_f32 v48, v156, v157
    v_cvt_pk_bf16_f32 v49, v158, v159
    ds_write_b64 v13, v[48:49] offset:8200
    s_waitcnt lgkmcnt(0)
    v_cvt_pk_bf16_f32 v24, v176, v177
    v_cvt_pk_bf16_f32 v25, v178, v179
    ds_write_b64 v14, v[24:25] offset:8192
    v_cvt_pk_bf16_f32 v32, v180, v181
    v_cvt_pk_bf16_f32 v33, v182, v183
    ds_write_b64 v14, v[32:33] offset:8200
    v_cvt_pk_bf16_f32 v40, v184, v185
    v_cvt_pk_bf16_f32 v41, v186, v187
    ds_write_b64 v15, v[40:41] offset:8192
    v_cvt_pk_bf16_f32 v48, v188, v189
    v_cvt_pk_bf16_f32 v49, v190, v191
    ds_write_b64 v15, v[48:49] offset:8200
    s_waitcnt lgkmcnt(0)
    v_lshrrev_b32 v2, 4, v1
    v_and_b32 v3, 15, v1
    v_lshlrev_b32 v5, 8, v2
    v_add_u32 v5, s60, v5
    v_add_u32 v4, 0, v2
    v_xor_b32 v4, v4, v3
    v_lshl_add_u32 v8, v4, 4, v5
    v_add_u32 v4, 4, v2
    v_xor_b32 v4, v4, v3
    v_lshl_add_u32 v9, v4, 4, v5
    v_add_u32 v4, 8, v2
    v_xor_b32 v4, v4, v3
    v_lshl_add_u32 v10, v4, 4, v5
    v_add_u32 v4, 12, v2
    v_xor_b32 v4, v4, v3
    v_lshl_add_u32 v11, v4, 4, v5
    s_mul_i32 s60, s58, 128
    s_add_u32 s60, s60, s52
    s_lshl_b32 s60, s60, 1
    v_lshl_add_u32 v3, v3, 4, s60
    s_mul_i32 s60, s59, 64
    s_add_u32 s60, s60, s53
    s_sub_u32 s60, s60, 0
    v_add_u32 v2, s60, v2
    v_mov_b32 v20, 0x3f803f80
    v_mov_b32 v21, 0x3f803f80
    v_mov_b32 v22, 0x3f803f80
    v_mov_b32 v23, 0x3f803f80
    s_mov_b32 s66, 81920
    ds_read_b128 v[192:195], v8 offset:0
    ds_read_b128 v[196:199], v9 offset:1024
    ds_read_b128 v[200:203], v10 offset:2048
    ds_read_b128 v[204:207], v11 offset:3072
    ds_read_b128 v[208:211], v8 offset:4096
    ds_read_b128 v[212:215], v9 offset:5120
    ds_read_b128 v[216:219], v10 offset:6144
    ds_read_b128 v[220:223], v11 offset:7168
    v_add_u32 v4, 0, v2
    v_lshl_add_u32 v12, v4, 12, v3
    s_waitcnt lgkmcnt(7)
    buffer_store_dwordx4 v[192:195], v12, s[48:51], 0 offen
    s_nop 1
    ds_read_b128 v[192:195], v8 offset:8192
    v_add_u32 v4, 4, v2
    v_lshl_add_u32 v13, v4, 12, v3
    s_waitcnt lgkmcnt(7)
    buffer_store_dwordx4 v[196:199], v13, s[48:51], 0 offen
    s_nop 1
    ds_read_b128 v[196:199], v9 offset:9216
    v_add_u32 v4, 8, v2
    v_lshl_add_u32 v14, v4, 12, v3
    s_waitcnt lgkmcnt(7)
    buffer_store_dwordx4 v[200:203], v14, s[48:51], 0 offen
    s_nop 1
    ds_read_b128 v[200:203], v10 offset:10240
    v_add_u32 v4, 12, v2
    v_lshl_add_u32 v15, v4, 12, v3
    s_waitcnt lgkmcnt(7)
    buffer_store_dwordx4 v[204:207], v15, s[48:51], 0 offen
    s_nop 1
    ds_read_b128 v[204:207], v11 offset:11264
    v_add_u32 v4, 16, v2
    v_lshl_add_u32 v12, v4, 12, v3
    s_waitcnt lgkmcnt(7)
    buffer_store_dwordx4 v[208:211], v12, s[48:51], 0 offen
    s_nop 1
    ds_read_b128 v[208:211], v8 offset:12288
    v_add_u32 v4, 20, v2
    v_lshl_add_u32 v13, v4, 12, v3
    s_waitcnt lgkmcnt(7)
    buffer_store_dwordx4 v[212:215], v13, s[48:51], 0 offen
    s_nop 1
    ds_read_b128 v[212:215], v9 offset:13312
    v_add_u32 v4, 24, v2
    v_lshl_add_u32 v14, v4, 12, v3
    s_waitcnt lgkmcnt(7)
    buffer_store_dwordx4 v[216:219], v14, s[48:51], 0 offen
    s_nop 1
    ds_read_b128 v[216:219], v10 offset:14336
    v_add_u32 v4, 28, v2
    v_lshl_add_u32 v15, v4, 12, v3
    s_waitcnt lgkmcnt(7)
    buffer_store_dwordx4 v[220:223], v15, s[48:51], 0 offen
    s_nop 1
    ds_read_b128 v[220:223], v11 offset:15360
    v_add_u32 v4, 32, v2
    v_lshl_add_u32 v12, v4, 12, v3
    s_waitcnt lgkmcnt(7)
    buffer_store_dwordx4 v[192:195], v12, s[48:51], 0 offen
    v_add_u32 v4, 36, v2
    v_lshl_add_u32 v13, v4, 12, v3
    s_waitcnt lgkmcnt(6)
    buffer_store_dwordx4 v[196:199], v13, s[48:51], 0 offen
    v_add_u32 v4, 40, v2
    v_lshl_add_u32 v14, v4, 12, v3
    s_waitcnt lgkmcnt(5)
    buffer_store_dwordx4 v[200:203], v14, s[48:51], 0 offen
    v_add_u32 v4, 44, v2
    v_lshl_add_u32 v15, v4, 12, v3
    s_waitcnt lgkmcnt(4)
    buffer_store_dwordx4 v[204:207], v15, s[48:51], 0 offen
    v_add_u32 v4, 48, v2
    v_lshl_add_u32 v12, v4, 12, v3
    s_waitcnt lgkmcnt(3)
    buffer_store_dwordx4 v[208:211], v12, s[48:51], 0 offen
    v_add_u32 v4, 52, v2
    v_lshl_add_u32 v13, v4, 12, v3
    s_waitcnt lgkmcnt(2)
    buffer_store_dwordx4 v[212:215], v13, s[48:51], 0 offen
    v_add_u32 v4, 56, v2
    v_lshl_add_u32 v14, v4, 12, v3
    s_waitcnt lgkmcnt(1)
    buffer_store_dwordx4 v[216:219], v14, s[48:51], 0 offen
    v_add_u32 v4, 60, v2
    v_lshl_add_u32 v15, v4, 12, v3
    s_waitcnt lgkmcnt(0)
    buffer_store_dwordx4 v[220:223], v15, s[48:51], 0 offen
    s_endpgm
    s_nop 0
job_5:
    s_mov_b32 s40, s16
    s_mov_b32 s41, s17
    s_and_b32 s41, s41, 0xffff
    s_mov_b32 s42, 2621440
    s_mov_b32 s43, 0x00020000
    s_mov_b32 s44, s18
    s_mov_b32 s45, s19
    s_and_b32 s45, s45, 0xffff
    s_mov_b32 s46, 2457600
    s_mov_b32 s47, 0x00020000
    v_and_b32 v1, 63, v0
    s_and_b32 s70, s57, 3
    s_lshr_b32 s58, s70, 1
    s_and_b32 s59, s70, 1
    s_mul_i32 s72, s71, 32768
    s_add_u32 s72, s72, 65536
    v_lshrrev_b32 v2, 2, v1
    v_bfe_u32 v3, v1, 4, 2
    v_and_b32 v4, 3, v1
    v_xor_b32 v4, v4, v3
    s_mul_i32 s60, s57, 32
    s_add_u32 s60, s60, s52
    v_add_u32 v2, s60, v2
    s_mov_b32 s61, 1280
    v_mul_lo_u32 v2, v2, s61
    v_lshl_add_u32 v2, v4, 4, v2
    v_add_u32 v8, 0, v2
    v_add_u32 v9, 19456, v2
    v_lshrrev_b32 v2, 4, v1
    v_and_b32 v3, 15, v1
    v_lshrrev_b32 v4, 2, v3
    v_bfe_u32 v5, v1, 4, 2
    v_xor_b32 v4, v4, v5
    v_and_b32 v3, 3, v3
    v_lshlrev_b32 v3, 4, v3
    v_lshl_add_u32 v3, v4, 6, v3
    s_mul_i32 s60, s70, 8
    v_add_u32 v2, s60, v2
    s_mov_b32 s61, 3840
    v_mul_lo_u32 v2, v2, s61
    v_add_u32 v2, v2, v3
    s_lshl_b32 s60, s53, 1
    v_add_u32 v2, s60, v2
    v_add_u32 v12, 0, v2
    v_add_u32 v13, 14336, v2
    v_and_b32 v2, 31, v1
    v_lshrrev_b32 v3, 5, v1
    v_bfe_u32 v4, v1, 2, 2
    v_xor_b32 v4, v4, v3
    s_mul_i32 s60, s58, 128
    v_add_u32 v2, s60, v2
    v_lshlrev_b32 v2, 6, v2
    v_lshl_add_u32 v16, v4, 4, v2
    v_xor_b32 v17, 32, v16
    v_bfe_u32 v2, v1, 2, 2
    v_lshrrev_b32 v3, 5, v1
    v_lshl_add_u32 v3, v3, 3, v2
    v_mul_u32_u24 v3, 256, v3
    v_mov_b32 v4, v2
    s_mul_i32 s60, s59, 2
    v_xor_b32 v4, s60, v4
    v_lshl_add_u32 v3, v4, 6, v3
    v_bfe_u32 v4, v1, 4, 1
    v_and_b32 v5, 3, v1
    v_lshlrev_b32 v5, 3, v5
    v_lshl_add_u32 v5, v4, 5, v5
    v_add_u32 v3, v3, v5
    v_add_u32 v18, s72, v3
    v_xor_b32 v19, 64, v18
    s_mul_i32 s62, s57, 2048
    s_mul_i32 s63, s70, 2048
    s_add_u32 s63, s63, s72
    s_mov_b32 s54, 0
    s_mov_b32 s55, 0
    v_mov_b32 v64, 0
    v_mov_b32 v65, 0
    v_mov_b32 v66, 0
    v_mov_b32 v67, 0
    v_mov_b32 v68, 0
    v_mov_b32 v69, 0
    v_mov_b32 v70, 0
    v_mov_b32 v71, 0
    v_mov_b32 v72, 0
    v_mov_b32 v73, 0
    v_mov_b32 v74, 0
    v_mov_b32 v75, 0
    v_mov_b32 v76, 0
    v_mov_b32 v77, 0
    v_mov_b32 v78, 0
    v_mov_b32 v79, 0
    v_mov_b32 v80, 0
    v_mov_b32 v81, 0
    v_mov_b32 v82, 0
    v_mov_b32 v83, 0
    v_mov_b32 v84, 0
    v_mov_b32 v85, 0
    v_mov_b32 v86, 0
    v_mov_b32 v87, 0
    v_mov_b32 v88, 0
    v_mov_b32 v89, 0
    v_mov_b32 v90, 0
    v_mov_b32 v91, 0
    v_mov_b32 v92, 0
    v_mov_b32 v93, 0
    v_mov_b32 v94, 0
    v_mov_b32 v95, 0
    v_mov_b32 v96, 0
    v_mov_b32 v97, 0
    v_mov_b32 v98, 0
    v_mov_b32 v99, 0
    v_mov_b32 v100, 0
    v_mov_b32 v101, 0
    v_mov_b32 v102, 0
    v_mov_b32 v103, 0
    v_mov_b32 v104, 0
    v_mov_b32 v105, 0
    v_mov_b32 v106, 0
    v_mov_b32 v107, 0
    v_mov_b32 v108, 0
    v_mov_b32 v109, 0
    v_mov_b32 v110, 0
    v_mov_b32 v111, 0
    v_mov_b32 v112, 0
    v_mov_b32 v113, 0
    v_mov_b32 v114, 0
    v_mov_b32 v115, 0
    v_mov_b32 v116, 0
    v_mov_b32 v117, 0
    v_mov_b32 v118, 0
    v_mov_b32 v119, 0
    v_mov_b32 v120, 0
    v_mov_b32 v121, 0
    v_mov_b32 v122, 0
    v_mov_b32 v123, 0
    v_mov_b32 v124, 0
    v_mov_b32 v125, 0
    v_mov_b32 v126, 0
    v_mov_b32 v127, 0
    v_mov_b32 v128, 0
    v_mov_b32 v129, 0
    v_mov_b32 v130, 0
    v_mov_b32 v131, 0
    v_mov_b32 v132, 0
    v_mov_b32 v133, 0
    v_mov_b32 v134, 0
    v_mov_b32 v135, 0
    v_mov_b32 v136, 0
    v_mov_b32 v137, 0
    v_mov_b32 v138, 0
    v_mov_b32 v139, 0
    v_mov_b32 v140, 0
    v_mov_b32 v141, 0
    v_mov_b32 v142, 0
    v_mov_b32 v143, 0
    v_mov_b32 v144, 0
    v_mov_b32 v145, 0
    v_mov_b32 v146, 0
    v_mov_b32 v147, 0
    v_mov_b32 v148, 0
    v_mov_b32 v149, 0
    v_mov_b32 v150, 0
    v_mov_b32 v151, 0
    v_mov_b32 v152, 0
    v_mov_b32 v153, 0
    v_mov_b32 v154, 0
    v_mov_b32 v155, 0
    v_mov_b32 v156, 0
    v_mov_b32 v157, 0
    v_mov_b32 v158, 0
    v_mov_b32 v159, 0
    v_mov_b32 v160, 0
    v_mov_b32 v161, 0
    v_mov_b32 v162, 0
    v_mov_b32 v163, 0
    v_mov_b32 v164, 0
    v_mov_b32 v165, 0
    v_mov_b32 v166, 0
    v_mov_b32 v167, 0
    v_mov_b32 v168, 0
    v_mov_b32 v169, 0
    v_mov_b32 v170, 0
    v_mov_b32 v171, 0
    v_mov_b32 v172, 0
    v_mov_b32 v173, 0
    v_mov_b32 v174, 0
    v_mov_b32 v175, 0
    v_mov_b32 v176, 0
    v_mov_b32 v177, 0
    v_mov_b32 v178, 0
    v_mov_b32 v179, 0
    v_mov_b32 v180, 0
    v_mov_b32 v181, 0
    v_mov_b32 v182, 0
    v_mov_b32 v183, 0
    v_mov_b32 v184, 0
    v_mov_b32 v185, 0
    v_mov_b32 v186, 0
    v_mov_b32 v187, 0
    v_mov_b32 v188, 0
    v_mov_b32 v189, 0
    v_mov_b32 v190, 0
    v_mov_b32 v191, 0
    s_add_u32 m0, s62, 0
    s_nop 0
    buffer_load_dwordx4 v8, s[40:43], s54 offen offset:0 lds
    buffer_load_dwordx4 v9, s[40:43], s54 offen offset:1024 lds
    s_add_u32 m0, s63, 0
    s_nop 0
    buffer_load_dwordx4 v12, s[44:47], s55 offen offset:0 lds
    buffer_load_dwordx4 v13, s[44:47], s55 offen offset:1024 lds
    buffer_load_dword v60, v61, s[76:79], 0 offen
    v_add_u32 v61, 524288, v61
    s_add_u32 s54, s54, 64
    s_add_u32 s55, s55, 122880
    s_add_u32 m0, s62, 16384
    s_nop 0
    buffer_load_dwordx4 v8, s[40:43], s54 offen offset:0 lds
    buffer_load_dwordx4 v9, s[40:43], s54 offen offset:1024 lds
    s_add_u32 m0, s63, 8192
    s_nop 0
    buffer_load_dwordx4 v12, s[44:47], s55 offen offset:0 lds
    buffer_load_dwordx4 v13, s[44:47], s55 offen offset:1024 lds
    buffer_load_dword v60, v61, s[76:79], 0 offen
    v_add_u32 v61, 524288, v61
    s_add_u32 s54, s54, 64
    s_add_u32 s55, s55, 122880
    s_add_u32 m0, s62, 32768
    s_nop 0
    buffer_load_dwordx4 v8, s[40:43], s54 offen offset:0 lds
    buffer_load_dwordx4 v9, s[40:43], s54 offen offset:1024 lds
    s_add_u32 m0, s63, 16384
    s_nop 0
    buffer_load_dwordx4 v12, s[44:47], s55 offen offset:0 lds
    buffer_load_dwordx4 v13, s[44:47], s55 offen offset:1024 lds
    buffer_load_dword v60, v61, s[76:79], 0 offen
    v_add_u32 v61, 524288, v61
    s_add_u32 s54, s54, 64
    s_add_u32 s55, s55, 122880
    s_mov_b32 s56, 20
    s_waitcnt vmcnt(11)
    s_barrier
    ds_read_b64_tr_b16 v[224:225], v18 offset:0
    ds_read_b64_tr_b16 v[226:227], v18 offset:1024
    ds_read_b128 v[192:195], v16 offset:0
    ds_read_b64_tr_b16 v[228:229], v19 offset:0
    ds_read_b64_tr_b16 v[230:231], v19 offset:1024
    ds_read_b128 v[196:199], v16 offset:2048
    ds_read_b128 v[200:203], v16 offset:4096
    ds_read_b128 v[204:207], v16 offset:6144
    s_waitcnt lgkmcnt(0)
gl_15:
    v_mfma_f32_32x32x16_bf16 v[64:79], v[224:227], v[192:195], v[64:79]
    ds_read_b64_tr_b16 v[232:233], v18 offset:4096
    ds_read_b64_tr_b16 v[234:235], v18 offset:5120
    v_mfma_f32_32x32x16_bf16 v[80:95], v[228:231], v[192:195], v[80:95]
    ds_read_b128 v[208:211], v17 offset:0
    v_mfma_f32_32x32x16_bf16 v[96:111], v[224:227], v[196:199], v[96:111]
    ds_read_b64_tr_b16 v[236:237], v19 offset:4096
    ds_read_b64_tr_b16 v[238:239], v19 offset:5120
    v_mfma_f32_32x32x16_bf16 v[112:127], v[228:231], v[196:199], v[112:127]
    ds_read_b128 v[212:215], v17 offset:2048
    v_mfma_f32_32x32x16_bf16 v[128:143], v[224:227], v[200:203], v[128:143]
    ds_read_b128 v[216:219], v17 offset:4096
    v_mfma_f32_32x32x16_bf16 v[144:159], v[228:231], v[200:203], v[144:159]
    ds_read_b128 v[220:223], v17 offset:6144
    v_mfma_f32_32x32x16_bf16 v[160:175], v[224:227], v[204:207], v[160:175]
    v_mfma_f32_32x32x16_bf16 v[176:191], v[228:231], v[204:207], v[176:191]
    s_waitcnt vmcnt(6)
    s_barrier
    s_cmp_le_u32 s56, 3
    s_cselect_b32 s42, 0, s42
    s_cselect_b32 s46, 0, s46
    s_add_u32 m0, s62, 49152
    s_nop 0
    buffer_load_dwordx4 v8, s[40:43], s54 offen offset:0 lds
    buffer_load_dwordx4 v9, s[40:43], s54 offen offset:1024 lds
    s_add_u32 m0, s63, 24576
    s_nop 0
    buffer_load_dwordx4 v12, s[44:47], s55 offen offset:0 lds
    buffer_load_dwordx4 v13, s[44:47], s55 offen offset:1024 lds
    buffer_load_dword v60, v61, s[76:79], 0 offen
    v_add_u32 v61, 524288, v61
    s_add_u32 s54, s54, 64
    s_add_u32 s55, s55, 122880
    s_waitcnt lgkmcnt(5)
    v_mfma_f32_32x32x16_bf16 v[64:79], v[232:235], v[208:211], v[64:79]
    ds_read_b64_tr_b16 v[224:225], v18 offset:8192
    ds_read_b64_tr_b16 v[226:227], v18 offset:9216
    s_waitcnt lgkmcnt(5)
    v_mfma_f32_32x32x16_bf16 v[80:95], v[236:239], v[208:211], v[80:95]
    ds_read_b128 v[192:195], v16 offset:16384
    s_waitcnt lgkmcnt(5)
    v_mfma_f32_32x32x16_bf16 v[96:111], v[232:235], v[212:215], v[96:111]
    ds_read_b64_tr_b16 v[228:229], v19 offset:8192
    ds_read_b64_tr_b16 v[230:231], v19 offset:9216
    v_mfma_f32_32x32x16_bf16 v[112:127], v[236:239], v[212:215], v[112:127]
    ds_read_b128 v[196:199], v16 offset:18432
    s_waitcnt lgkmcnt(7)
    v_mfma_f32_32x32x16_bf16 v[128:143], v[232:235], v[216:219], v[128:143]
    ds_read_b128 v[200:203], v16 offset:20480
    v_mfma_f32_32x32x16_bf16 v[144:159], v[236:239], v[216:219], v[144:159]
    ds_read_b128 v[204:207], v16 offset:22528
    s_waitcnt lgkmcnt(8)
    v_mfma_f32_32x32x16_bf16 v[160:175], v[232:235], v[220:223], v[160:175]
    v_mfma_f32_32x32x16_bf16 v[176:191], v[236:239], v[220:223], v[176:191]
    s_sub_u32 s56, s56, 1
    s_waitcnt lgkmcnt(5)
    v_mfma_f32_32x32x16_bf16 v[64:79], v[224:227], v[192:195], v[64:79]
    ds_read_b64_tr_b16 v[232:233], v18 offset:12288
    ds_read_b64_tr_b16 v[234:235], v18 offset:13312
    s_waitcnt lgkmcnt(5)
    v_mfma_f32_32x32x16_bf16 v[80:95], v[228:231], v[192:195], v[80:95]
    ds_read_b128 v[208:211], v17 offset:16384
    s_waitcnt lgkmcnt(5)
    v_mfma_f32_32x32x16_bf16 v[96:111], v[224:227], v[196:199], v[96:111]
    ds_read_b64_tr_b16 v[236:237], v19 offset:12288
    ds_read_b64_tr_b16 v[238:239], v19 offset:13312
    v_mfma_f32_32x32x16_bf16 v[112:127], v[228:231], v[196:199], v[112:127]
    ds_read_b128 v[212:215], v17 offset:18432
    s_waitcnt lgkmcnt(7)
    v_mfma_f32_32x32x16_bf16 v[128:143], v[224:227], v[200:203], v[128:143]
    ds_read_b128 v[216:219], v17 offset:20480
    v_mfma_f32_32x32x16_bf16 v[144:159], v[228:231], v[200:203], v[144:159]
    ds_read_b128 v[220:223], v17 offset:22528
    s_waitcnt lgkmcnt(8)
    v_mfma_f32_32x32x16_bf16 v[160:175], v[224:227], v[204:207], v[160:175]
    v_mfma_f32_32x32x16_bf16 v[176:191], v[228:231], v[204:207], v[176:191]
    s_waitcnt vmcnt(6)
    s_barrier
    s_cmp_le_u32 s56, 3
    s_cselect_b32 s42, 0, s42
    s_cselect_b32 s46, 0, s46
    s_add_u32 m0, s62, 0
    s_nop 0
    buffer_load_dwordx4 v8, s[40:43], s54 offen offset:0 lds
    buffer_load_dwordx4 v9, s[40:43], s54 offen offset:1024 lds
    s_add_u32 m0, s63, 0
    s_nop 0
    buffer_load_dwordx4 v12, s[44:47], s55 offen offset:0 lds
    buffer_load_dwordx4 v13, s[44:47], s55 offen offset:1024 lds
    buffer_load_dword v60, v61, s[76:79], 0 offen
    v_add_u32 v61, 524288, v61
    s_add_u32 s54, s54, 64
    s_add_u32 s55, s55, 122880
    s_waitcnt lgkmcnt(5)
    v_mfma_f32_32x32x16_bf16 v[64:79], v[232:235], v[208:211], v[64:79]
    ds_read_b64_tr_b16 v[224:225], v18 offset:16384
    ds_read_b64_tr_b16 v[226:227], v18 offset:17408
    s_waitcnt lgkmcnt(5)
    v_mfma_f32_32x32x16_bf16 v[80:95], v[236:239], v[208:211], v[80:95]
    ds_read_b128 v[192:195], v16 offset:32768
    s_waitcnt lgkmcnt(5)
    v_mfma_f32_32x32x16_bf16 v[96:111], v[232:235], v[212:215], v[96:111]
    ds_read_b64_tr_b16 v[228:229], v19 offset:16384
    ds_read_b64_tr_b16 v[230:231], v19 offset:17408
    v_mfma_f32_32x32x16_bf16 v[112:127], v[236:239], v[212:215], v[112:127]
    ds_read_b128 v[196:199], v16 offset:34816
    s_waitcnt lgkmcnt(7)
    v_mfma_f32_32x32x16_bf16 v[128:143], v[232:235], v[216:219], v[128:143]
    ds_read_b128 v[200:203], v16 offset:36864
    v_mfma_f32_32x32x16_bf16 v[144:159], v[236:239], v[216:219], v[144:159]
    ds_read_b128 v[204:207], v16 offset:38912
    s_waitcnt lgkmcnt(8)
    v_mfma_f32_32x32x16_bf16 v[160:175], v[232:235], v[220:223], v[160:175]
    v_mfma_f32_32x32x16_bf16 v[176:191], v[236:239], v[220:223], v[176:191]
    s_sub_u32 s56, s56, 1
    s_waitcnt lgkmcnt(5)
    v_mfma_f32_32x32x16_bf16 v[64:79], v[224:227], v[192:195], v[64:79]
    ds_read_b64_tr_b16 v[232:233], v18 offset:20480
    ds_read_b64_tr_b16 v[234:235], v18 offset:21504
    s_waitcnt lgkmcnt(5)
    v_mfma_f32_32x32x16_bf16 v[80:95], v[228:231], v[192:195], v[80:95]
    ds_read_b128 v[208:211], v17 offset:32768
    s_waitcnt lgkmcnt(5)
    v_mfma_f32_32x32x16_bf16 v[96:111], v[224:227], v[196:199], v[96:111]
    ds_read_b64_tr_b16 v[236:237], v19 offset:20480
    ds_read_b64_tr_b16 v[238:239], v19 offset:21504
    v_mfma_f32_32x32x16_bf16 v[112:127], v[228:231], v[196:199], v[112:127]
    ds_read_b128 v[212:215], v17 offset:34816
    s_waitcnt lgkmcnt(7)
    v_mfma_f32_32x32x16_bf16 v[128:143], v[224:227], v[200:203], v[128:143]
    ds_read_b128 v[216:219], v17 offset:36864
    v_mfma_f32_32x32x16_bf16 v[144:159], v[228:231], v[200:203], v[144:159]
    ds_read_b128 v[220:223], v17 offset:38912
    s_waitcnt lgkmcnt(8)
    v_mfma_f32_32x32x16_bf16 v[160:175], v[224:227], v[204:207], v[160:175]
    v_mfma_f32_32x32x16_bf16 v[176:191], v[228:231], v[204:207], v[176:191]
    s_waitcnt vmcnt(6)
    s_barrier
    s_cmp_le_u32 s56, 3
    s_cselect_b32 s42, 0, s42
    s_cselect_b32 s46, 0, s46
    s_add_u32 m0, s62, 16384
    s_nop 0
    buffer_load_dwordx4 v8, s[40:43], s54 offen offset:0 lds
    buffer_load_dwordx4 v9, s[40:43], s54 offen offset:1024 lds
    s_add_u32 m0, s63, 8192
    s_nop 0
    buffer_load_dwordx4 v12, s[44:47], s55 offen offset:0 lds
    buffer_load_dwordx4 v13, s[44:47], s55 offen offset:1024 lds
    buffer_load_dword v60, v61, s[76:79], 0 offen
    v_add_u32 v61, 524288, v61
    s_add_u32 s54, s54, 64
    s_add_u32 s55, s55, 122880
    s_waitcnt lgkmcnt(5)
    v_mfma_f32_32x32x16_bf16 v[64:79], v[232:235], v[208:211], v[64:79]
    ds_read_b64_tr_b16 v[224:225], v18 offset:24576
    ds_read_b64_tr_b16 v[226:227], v18 offset:25600
    s_waitcnt lgkmcnt(5)
    v_mfma_f32_32x32x16_bf16 v[80:95], v[236:239], v[208:211], v[80:95]
    ds_read_b128 v[192:195], v16 offset:49152
    s_waitcnt lgkmcnt(5)
    v_mfma_f32_32x32x16_bf16 v[96:111], v[232:235], v[212:215], v[96:111]
    ds_read_b64_tr_b16 v[228:229], v19 offset:24576
    ds_read_b64_tr_b16 v[230:231], v19 offset:25600
    v_mfma_f32_32x32x16_bf16 v[112:127], v[236:239], v[212:215], v[112:127]
    ds_read_b128 v[196:199], v16 offset:51200
    s_waitcnt lgkmcnt(7)
    v_mfma_f32_32x32x16_bf16 v[128:143], v[232:235], v[216:219], v[128:143]
    ds_read_b128 v[200:203], v16 offset:53248
    v_mfma_f32_32x32x16_bf16 v[144:159], v[236:239], v[216:219], v[144:159]
    ds_read_b128 v[204:207], v16 offset:55296
    s_waitcnt lgkmcnt(8)
    v_mfma_f32_32x32x16_bf16 v[160:175], v[232:235], v[220:223], v[160:175]
    v_mfma_f32_32x32x16_bf16 v[176:191], v[236:239], v[220:223], v[176:191]
    s_sub_u32 s56, s56, 1
    s_waitcnt lgkmcnt(5)
    v_mfma_f32_32x32x16_bf16 v[64:79], v[224:227], v[192:195], v[64:79]
    ds_read_b64_tr_b16 v[232:233], v18 offset:28672
    ds_read_b64_tr_b16 v[234:235], v18 offset:29696
    s_waitcnt lgkmcnt(5)
    v_mfma_f32_32x32x16_bf16 v[80:95], v[228:231], v[192:195], v[80:95]
    ds_read_b128 v[208:211], v17 offset:49152
    s_waitcnt lgkmcnt(5)
    v_mfma_f32_32x32x16_bf16 v[96:111], v[224:227], v[196:199], v[96:111]
    ds_read_b64_tr_b16 v[236:237], v19 offset:28672
    ds_read_b64_tr_b16 v[238:239], v19 offset:29696
    v_mfma_f32_32x32x16_bf16 v[112:127], v[228:231], v[196:199], v[112:127]
    ds_read_b128 v[212:215], v17 offset:51200
    s_waitcnt lgkmcnt(7)
    v_mfma_f32_32x32x16_bf16 v[128:143], v[224:227], v[200:203], v[128:143]
    ds_read_b128 v[216:219], v17 offset:53248
    v_mfma_f32_32x32x16_bf16 v[144:159], v[228:231], v[200:203], v[144:159]
    ds_read_b128 v[220:223], v17 offset:55296
    s_waitcnt lgkmcnt(8)
    v_mfma_f32_32x32x16_bf16 v[160:175], v[224:227], v[204:207], v[160:175]
    v_mfma_f32_32x32x16_bf16 v[176:191], v[228:231], v[204:207], v[176:191]
    s_waitcnt vmcnt(6)
    s_barrier
    s_cmp_le_u32 s56, 3
    s_cselect_b32 s42, 0, s42
    s_cselect_b32 s46, 0, s46
    s_add_u32 m0, s62, 32768
    s_nop 0
    buffer_load_dwordx4 v8, s[40:43], s54 offen offset:0 lds
    buffer_load_dwordx4 v9, s[40:43], s54 offen offset:1024 lds
    s_add_u32 m0, s63, 16384
    s_nop 0
    buffer_load_dwordx4 v12, s[44:47], s55 offen offset:0 lds
    buffer_load_dwordx4 v13, s[44:47], s55 offen offset:1024 lds
    buffer_load_dword v60, v61, s[76:79], 0 offen
    v_add_u32 v61, 524288, v61
    s_add_u32 s54, s54, 64
    s_add_u32 s55, s55, 122880
    s_waitcnt lgkmcnt(5)
    v_mfma_f32_32x32x16_bf16 v[64:79], v[232:235], v[208:211], v[64:79]
    ds_read_b64_tr_b16 v[224:225], v18 offset:0
    ds_read_b64_tr_b16 v[226:227], v18 offset:1024
    s_waitcnt lgkmcnt(5)
    v_mfma_f32_32x32x16_bf16 v[80:95], v[236:239], v[208:211], v[80:95]
    ds_read_b128 v[192:195], v16 offset:0
    s_waitcnt lgkmcnt(5)
    v_mfma_f32_32x32x16_bf16 v[96:111], v[232:235], v[212:215], v[96:111]
    ds_read_b64_tr_b16 v[228:229], v19 offset:0
    ds_read_b64_tr_b16 v[230:231], v19 offset:1024
    v_mfma_f32_32x32x16_bf16 v[112:127], v[236:239], v[212:215], v[112:127]
    ds_read_b128 v[196:199], v16 offset:2048
    s_waitcnt lgkmcnt(7)
    v_mfma_f32_32x32x16_bf16 v[128:143], v[232:235], v[216:219], v[128:143]
    ds_read_b128 v[200:203], v16 offset:4096
    v_mfma_f32_32x32x16_bf16 v[144:159], v[236:239], v[216:219], v[144:159]
    ds_read_b128 v[204:207], v16 offset:6144
    s_waitcnt lgkmcnt(8)
    v_mfma_f32_32x32x16_bf16 v[160:175], v[232:235], v[220:223], v[160:175]
    v_mfma_f32_32x32x16_bf16 v[176:191], v[236:239], v[220:223], v[176:191]
    s_sub_u32 s56, s56, 1
    s_cmp_eq_u32 s56, 0
    s_waitcnt lgkmcnt(0)
    s_nop 8
    s_cbranch_scc1 gd_16
    s_branch gl_15
gd_16:
    s_waitcnt vmcnt(0) lgkmcnt(0)
    s_barrier
    s_mov_b32 s48, s38
    s_mov_b32 s49, s39
    s_and_b32 s49, s49, 0xffff
    s_mov_b32 s50, 8388608
    s_mov_b32 s51, 0x00020000
    v_and_b32 v2, 31, v1
    s_mul_i32 s60, s58, 128
    s_add_u32 s60, s60, s52
    v_add_u32 v2, s60, v2
    v_lshlrev_b32 v2, 6, v2
    v_lshrrev_b32 v3, 5, v1
    v_lshlrev_b32 v3, 2, v3
    s_mul_i32 s60, s59, 64
    s_add_u32 s60, s60, s53
    v_add_u32 v3, s60, v3
    s_mov_b32 s65, 1051011932
    v_mov_b32 v20, 0
    v_mov_b32 v21, 0
    v_mov_b32 v22, 0
    v_mov_b32 v23, 0
    v_add_u32 v4, 0, v3
    v_mul_u32_u24 v5, 0xcccd, v4
    v_lshrrev_b32 v5, 20, v5
    v_mul_u32_u24 v6, 20, v5
    v_sub_u32 v6, v4, v6
    v_lshlrev_b32 v5, 17, v5
    v_lshl_add_u32 v5, v6, 1, v5
    v_add_u32 v5, v5, v2
    s_mov_b32 s66, 0
    v_mul_f32 v26, s65, v64
    v_mul_f32 v27, s65, v65
    v_mul_f32 v28, s65, v66
    v_mul_f32 v29, s65, v67
    v_cvt_pk_bf16_f32 v24, v26, v27
    v_cvt_pk_bf16_f32 v25, v28, v29
    buffer_store_dwordx2 v[24:25], v5, s[48:51], s66 offen offset:0
    s_mov_b32 s66, 2048
    v_mul_f32 v34, s65, v96
    v_mul_f32 v35, s65, v97
    v_mul_f32 v36, s65, v98
    v_mul_f32 v37, s65, v99
    v_cvt_pk_bf16_f32 v32, v34, v35
    v_cvt_pk_bf16_f32 v33, v36, v37
    buffer_store_dwordx2 v[32:33], v5, s[48:51], s66 offen offset:0
    s_mov_b32 s66, 4096
    v_mul_f32 v42, s65, v128
    v_mul_f32 v43, s65, v129
    v_mul_f32 v44, s65, v130
    v_mul_f32 v45, s65, v131
    v_cvt_pk_bf16_f32 v40, v42, v43
    v_cvt_pk_bf16_f32 v41, v44, v45
    buffer_store_dwordx2 v[40:41], v5, s[48:51], s66 offen offset:0
    s_mov_b32 s66, 6144
    v_mul_f32 v50, s65, v160
    v_mul_f32 v51, s65, v161
    v_mul_f32 v52, s65, v162
    v_mul_f32 v53, s65, v163
    v_cvt_pk_bf16_f32 v48, v50, v51
    v_cvt_pk_bf16_f32 v49, v52, v53
    buffer_store_dwordx2 v[48:49], v5, s[48:51], s66 offen offset:0
    v_cmp_eq_u32 vcc, 16, v6
    s_and_saveexec_b64 s[68:69], vcc
    s_mov_b32 s66, 0
    buffer_store_dwordx2 v[20:21], v5, s[48:51], s66 offen offset:8
    buffer_store_dwordx4 v[20:23], v5, s[48:51], s66 offen offset:16
    s_mov_b32 s66, 2048
    buffer_store_dwordx2 v[20:21], v5, s[48:51], s66 offen offset:8
    buffer_store_dwordx4 v[20:23], v5, s[48:51], s66 offen offset:16
    s_mov_b32 s66, 4096
    buffer_store_dwordx2 v[20:21], v5, s[48:51], s66 offen offset:8
    buffer_store_dwordx4 v[20:23], v5, s[48:51], s66 offen offset:16
    s_mov_b32 s66, 6144
    buffer_store_dwordx2 v[20:21], v5, s[48:51], s66 offen offset:8
    buffer_store_dwordx4 v[20:23], v5, s[48:51], s66 offen offset:16
    s_mov_b64 exec, s[68:69]
    v_add_u32 v4, 8, v3
    v_mul_u32_u24 v5, 0xcccd, v4
    v_lshrrev_b32 v5, 20, v5
    v_mul_u32_u24 v6, 20, v5
    v_sub_u32 v6, v4, v6
    v_lshlrev_b32 v5, 17, v5
    v_lshl_add_u32 v5, v6, 1, v5
    v_add_u32 v5, v5, v2
    s_mov_b32 s66, 0
    v_mul_f32 v26, s65, v68
    v_mul_f32 v27, s65, v69
    v_mul_f32 v28, s65, v70
    v_mul_f32 v29, s65, v71
    v_cvt_pk_bf16_f32 v24, v26, v27
    v_cvt_pk_bf16_f32 v25, v28, v29
    buffer_store_dwordx2 v[24:25], v5, s[48:51], s66 offen offset:0
    s_mov_b32 s66, 2048
    v_mul_f32 v34, s65, v100
    v_mul_f32 v35, s65, v101
    v_mul_f32 v36, s65, v102
    v_mul_f32 v37, s65, v103
    v_cvt_pk_bf16_f32 v32, v34, v35
    v_cvt_pk_bf16_f32 v33, v36, v37
    buffer_store_dwordx2 v[32:33], v5, s[48:51], s66 offen offset:0
    s_mov_b32 s66, 4096
    v_mul_f32 v42, s65, v132
    v_mul_f32 v43, s65, v133
    v_mul_f32 v44, s65, v134
    v_mul_f32 v45, s65, v135
    v_cvt_pk_bf16_f32 v40, v42, v43
    v_cvt_pk_bf16_f32 v41, v44, v45
    buffer_store_dwordx2 v[40:41], v5, s[48:51], s66 offen offset:0
    s_mov_b32 s66, 6144
    v_mul_f32 v50, s65, v164
    v_mul_f32 v51, s65, v165
    v_mul_f32 v52, s65, v166
    v_mul_f32 v53, s65, v167
    v_cvt_pk_bf16_f32 v48, v50, v51
    v_cvt_pk_bf16_f32 v49, v52, v53
    buffer_store_dwordx2 v[48:49], v5, s[48:51], s66 offen offset:0
    v_cmp_eq_u32 vcc, 16, v6
    s_and_saveexec_b64 s[68:69], vcc
    s_mov_b32 s66, 0
    buffer_store_dwordx2 v[20:21], v5, s[48:51], s66 offen offset:8
    buffer_store_dwordx4 v[20:23], v5, s[48:51], s66 offen offset:16
    s_mov_b32 s66, 2048
    buffer_store_dwordx2 v[20:21], v5, s[48:51], s66 offen offset:8
    buffer_store_dwordx4 v[20:23], v5, s[48:51], s66 offen offset:16
    s_mov_b32 s66, 4096
    buffer_store_dwordx2 v[20:21], v5, s[48:51], s66 offen offset:8
    buffer_store_dwordx4 v[20:23], v5, s[48:51], s66 offen offset:16
    s_mov_b32 s66, 6144
    buffer_store_dwordx2 v[20:21], v5, s[48:51], s66 offen offset:8
    buffer_store_dwordx4 v[20:23], v5, s[48:51], s66 offen offset:16
    s_mov_b64 exec, s[68:69]
    v_add_u32 v4, 16, v3
    v_mul_u32_u24 v5, 0xcccd, v4
    v_lshrrev_b32 v5, 20, v5
    v_mul_u32_u24 v6, 20, v5
    v_sub_u32 v6, v4, v6
    v_lshlrev_b32 v5, 17, v5
    v_lshl_add_u32 v5, v6, 1, v5
    v_add_u32 v5, v5, v2
    s_mov_b32 s66, 0
    v_mul_f32 v26, s65, v72
    v_mul_f32 v27, s65, v73
    v_mul_f32 v28, s65, v74
    v_mul_f32 v29, s65, v75
    v_cvt_pk_bf16_f32 v24, v26, v27
    v_cvt_pk_bf16_f32 v25, v28, v29
    buffer_store_dwordx2 v[24:25], v5, s[48:51], s66 offen offset:0
    s_mov_b32 s66, 2048
    v_mul_f32 v34, s65, v104
    v_mul_f32 v35, s65, v105
    v_mul_f32 v36, s65, v106
    v_mul_f32 v37, s65, v107
    v_cvt_pk_bf16_f32 v32, v34, v35
    v_cvt_pk_bf16_f32 v33, v36, v37
    buffer_store_dwordx2 v[32:33], v5, s[48:51], s66 offen offset:0
    s_mov_b32 s66, 4096
    v_mul_f32 v42, s65, v136
    v_mul_f32 v43, s65, v137
    v_mul_f32 v44, s65, v138
    v_mul_f32 v45, s65, v139
    v_cvt_pk_bf16_f32 v40, v42, v43
    v_cvt_pk_bf16_f32 v41, v44, v45
    buffer_store_dwordx2 v[40:41], v5, s[48:51], s66 offen offset:0
    s_mov_b32 s66, 6144
    v_mul_f32 v50, s65, v168
    v_mul_f32 v51, s65, v169
    v_mul_f32 v52, s65, v170
    v_mul_f32 v53, s65, v171
    v_cvt_pk_bf16_f32 v48, v50, v51
    v_cvt_pk_bf16_f32 v49, v52, v53
    buffer_store_dwordx2 v[48:49], v5, s[48:51], s66 offen offset:0
    v_cmp_eq_u32 vcc, 16, v6
    s_and_saveexec_b64 s[68:69], vcc
    s_mov_b32 s66, 0
    buffer_store_dwordx2 v[20:21], v5, s[48:51], s66 offen offset:8
    buffer_store_dwordx4 v[20:23], v5, s[48:51], s66 offen offset:16
    s_mov_b32 s66, 2048
    buffer_store_dwordx2 v[20:21], v5, s[48:51], s66 offen offset:8
    buffer_store_dwordx4 v[20:23], v5, s[48:51], s66 offen offset:16
    s_mov_b32 s66, 4096
    buffer_store_dwordx2 v[20:21], v5, s[48:51], s66 offen offset:8
    buffer_store_dwordx4 v[20:23], v5, s[48:51], s66 offen offset:16
    s_mov_b32 s66, 6144
    buffer_store_dwordx2 v[20:21], v5, s[48:51], s66 offen offset:8
    buffer_store_dwordx4 v[20:23], v5, s[48:51], s66 offen offset:16
    s_mov_b64 exec, s[68:69]
    v_add_u32 v4, 24, v3
    v_mul_u32_u24 v5, 0xcccd, v4
    v_lshrrev_b32 v5, 20, v5
    v_mul_u32_u24 v6, 20, v5
    v_sub_u32 v6, v4, v6
    v_lshlrev_b32 v5, 17, v5
    v_lshl_add_u32 v5, v6, 1, v5
    v_add_u32 v5, v5, v2
    s_mov_b32 s66, 0
    v_mul_f32 v26, s65, v76
    v_mul_f32 v27, s65, v77
    v_mul_f32 v28, s65, v78
    v_mul_f32 v29, s65, v79
    v_cvt_pk_bf16_f32 v24, v26, v27
    v_cvt_pk_bf16_f32 v25, v28, v29
    buffer_store_dwordx2 v[24:25], v5, s[48:51], s66 offen offset:0
    s_mov_b32 s66, 2048
    v_mul_f32 v34, s65, v108
    v_mul_f32 v35, s65, v109
    v_mul_f32 v36, s65, v110
    v_mul_f32 v37, s65, v111
    v_cvt_pk_bf16_f32 v32, v34, v35
    v_cvt_pk_bf16_f32 v33, v36, v37
    buffer_store_dwordx2 v[32:33], v5, s[48:51], s66 offen offset:0
    s_mov_b32 s66, 4096
    v_mul_f32 v42, s65, v140
    v_mul_f32 v43, s65, v141
    v_mul_f32 v44, s65, v142
    v_mul_f32 v45, s65, v143
    v_cvt_pk_bf16_f32 v40, v42, v43
    v_cvt_pk_bf16_f32 v41, v44, v45
    buffer_store_dwordx2 v[40:41], v5, s[48:51], s66 offen offset:0
    s_mov_b32 s66, 6144
    v_mul_f32 v50, s65, v172
    v_mul_f32 v51, s65, v173
    v_mul_f32 v52, s65, v174
    v_mul_f32 v53, s65, v175
    v_cvt_pk_bf16_f32 v48, v50, v51
    v_cvt_pk_bf16_f32 v49, v52, v53
    buffer_store_dwordx2 v[48:49], v5, s[48:51], s66 offen offset:0
    v_cmp_eq_u32 vcc, 16, v6
    s_and_saveexec_b64 s[68:69], vcc
    s_mov_b32 s66, 0
    buffer_store_dwordx2 v[20:21], v5, s[48:51], s66 offen offset:8
    buffer_store_dwordx4 v[20:23], v5, s[48:51], s66 offen offset:16
    s_mov_b32 s66, 2048
    buffer_store_dwordx2 v[20:21], v5, s[48:51], s66 offen offset:8
    buffer_store_dwordx4 v[20:23], v5, s[48:51], s66 offen offset:16
    s_mov_b32 s66, 4096
    buffer_store_dwordx2 v[20:21], v5, s[48:51], s66 offen offset:8
    buffer_store_dwordx4 v[20:23], v5, s[48:51], s66 offen offset:16
    s_mov_b32 s66, 6144
    buffer_store_dwordx2 v[20:21], v5, s[48:51], s66 offen offset:8
    buffer_store_dwordx4 v[20:23], v5, s[48:51], s66 offen offset:16
    s_mov_b64 exec, s[68:69]
    v_add_u32 v4, 32, v3
    v_mul_u32_u24 v5, 0xcccd, v4
    v_lshrrev_b32 v5, 20, v5
    v_mul_u32_u24 v6, 20, v5
    v_sub_u32 v6, v4, v6
    v_lshlrev_b32 v5, 17, v5
    v_lshl_add_u32 v5, v6, 1, v5
    v_add_u32 v5, v5, v2
    s_mov_b32 s66, 0
    v_mul_f32 v26, s65, v80
    v_mul_f32 v27, s65, v81
    v_mul_f32 v28, s65, v82
    v_mul_f32 v29, s65, v83
    v_cvt_pk_bf16_f32 v24, v26, v27
    v_cvt_pk_bf16_f32 v25, v28, v29
    buffer_store_dwordx2 v[24:25], v5, s[48:51], s66 offen offset:0
    s_mov_b32 s66, 2048
    v_mul_f32 v34, s65, v112
    v_mul_f32 v35, s65, v113
    v_mul_f32 v36, s65, v114
    v_mul_f32 v37, s65, v115
    v_cvt_pk_bf16_f32 v32, v34, v35
    v_cvt_pk_bf16_f32 v33, v36, v37
    buffer_store_dwordx2 v[32:33], v5, s[48:51], s66 offen offset:0
    s_mov_b32 s66, 4096
    v_mul_f32 v42, s65, v144
    v_mul_f32 v43, s65, v145
    v_mul_f32 v44, s65, v146
    v_mul_f32 v45, s65, v147
    v_cvt_pk_bf16_f32 v40, v42, v43
    v_cvt_pk_bf16_f32 v41, v44, v45
    buffer_store_dwordx2 v[40:41], v5, s[48:51], s66 offen offset:0
    s_mov_b32 s66, 6144
    v_mul_f32 v50, s65, v176
    v_mul_f32 v51, s65, v177
    v_mul_f32 v52, s65, v178
    v_mul_f32 v53, s65, v179
    v_cvt_pk_bf16_f32 v48, v50, v51
    v_cvt_pk_bf16_f32 v49, v52, v53
    buffer_store_dwordx2 v[48:49], v5, s[48:51], s66 offen offset:0
    v_cmp_eq_u32 vcc, 16, v6
    s_and_saveexec_b64 s[68:69], vcc
    s_mov_b32 s66, 0
    buffer_store_dwordx2 v[20:21], v5, s[48:51], s66 offen offset:8
    buffer_store_dwordx4 v[20:23], v5, s[48:51], s66 offen offset:16
    s_mov_b32 s66, 2048
    buffer_store_dwordx2 v[20:21], v5, s[48:51], s66 offen offset:8
    buffer_store_dwordx4 v[20:23], v5, s[48:51], s66 offen offset:16
    s_mov_b32 s66, 4096
    buffer_store_dwordx2 v[20:21], v5, s[48:51], s66 offen offset:8
    buffer_store_dwordx4 v[20:23], v5, s[48:51], s66 offen offset:16
    s_mov_b32 s66, 6144
    buffer_store_dwordx2 v[20:21], v5, s[48:51], s66 offen offset:8
    buffer_store_dwordx4 v[20:23], v5, s[48:51], s66 offen offset:16
    s_mov_b64 exec, s[68:69]
    v_add_u32 v4, 40, v3
    v_mul_u32_u24 v5, 0xcccd, v4
    v_lshrrev_b32 v5, 20, v5
    v_mul_u32_u24 v6, 20, v5
    v_sub_u32 v6, v4, v6
    v_lshlrev_b32 v5, 17, v5
    v_lshl_add_u32 v5, v6, 1, v5
    v_add_u32 v5, v5, v2
    s_mov_b32 s66, 0
    v_mul_f32 v26, s65, v84
    v_mul_f32 v27, s65, v85
    v_mul_f32 v28, s65, v86
    v_mul_f32 v29, s65, v87
    v_cvt_pk_bf16_f32 v24, v26, v27
    v_cvt_pk_bf16_f32 v25, v28, v29
    buffer_store_dwordx2 v[24:25], v5, s[48:51], s66 offen offset:0
    s_mov_b32 s66, 2048
    v_mul_f32 v34, s65, v116
    v_mul_f32 v35, s65, v117
    v_mul_f32 v36, s65, v118
    v_mul_f32 v37, s65, v119
    v_cvt_pk_bf16_f32 v32, v34, v35
    v_cvt_pk_bf16_f32 v33, v36, v37
    buffer_store_dwordx2 v[32:33], v5, s[48:51], s66 offen offset:0
    s_mov_b32 s66, 4096
    v_mul_f32 v42, s65, v148
    v_mul_f32 v43, s65, v149
    v_mul_f32 v44, s65, v150
    v_mul_f32 v45, s65, v151
    v_cvt_pk_bf16_f32 v40, v42, v43
    v_cvt_pk_bf16_f32 v41, v44, v45
    buffer_store_dwordx2 v[40:41], v5, s[48:51], s66 offen offset:0
    s_mov_b32 s66, 6144
    v_mul_f32 v50, s65, v180
    v_mul_f32 v51, s65, v181
    v_mul_f32 v52, s65, v182
    v_mul_f32 v53, s65, v183
    v_cvt_pk_bf16_f32 v48, v50, v51
    v_cvt_pk_bf16_f32 v49, v52, v53
    buffer_store_dwordx2 v[48:49], v5, s[48:51], s66 offen offset:0
    v_cmp_eq_u32 vcc, 16, v6
    s_and_saveexec_b64 s[68:69], vcc
    s_mov_b32 s66, 0
    buffer_store_dwordx2 v[20:21], v5, s[48:51], s66 offen offset:8
    buffer_store_dwordx4 v[20:23], v5, s[48:51], s66 offen offset:16
    s_mov_b32 s66, 2048
    buffer_store_dwordx2 v[20:21], v5, s[48:51], s66 offen offset:8
    buffer_store_dwordx4 v[20:23], v5, s[48:51], s66 offen offset:16
    s_mov_b32 s66, 4096
    buffer_store_dwordx2 v[20:21], v5, s[48:51], s66 offen offset:8
    buffer_store_dwordx4 v[20:23], v5, s[48:51], s66 offen offset:16
    s_mov_b32 s66, 6144
    buffer_store_dwordx2 v[20:21], v5, s[48:51], s66 offen offset:8
    buffer_store_dwordx4 v[20:23], v5, s[48:51], s66 offen offset:16
    s_mov_b64 exec, s[68:69]
    v_add_u32 v4, 48, v3
    v_mul_u32_u24 v5, 0xcccd, v4
    v_lshrrev_b32 v5, 20, v5
    v_mul_u32_u24 v6, 20, v5
    v_sub_u32 v6, v4, v6
    v_lshlrev_b32 v5, 17, v5
    v_lshl_add_u32 v5, v6, 1, v5
    v_add_u32 v5, v5, v2
    s_mov_b32 s66, 0
    v_mul_f32 v26, s65, v88
    v_mul_f32 v27, s65, v89
    v_mul_f32 v28, s65, v90
    v_mul_f32 v29, s65, v91
    v_cvt_pk_bf16_f32 v24, v26, v27
    v_cvt_pk_bf16_f32 v25, v28, v29
    buffer_store_dwordx2 v[24:25], v5, s[48:51], s66 offen offset:0
    s_mov_b32 s66, 2048
    v_mul_f32 v34, s65, v120
    v_mul_f32 v35, s65, v121
    v_mul_f32 v36, s65, v122
    v_mul_f32 v37, s65, v123
    v_cvt_pk_bf16_f32 v32, v34, v35
    v_cvt_pk_bf16_f32 v33, v36, v37
    buffer_store_dwordx2 v[32:33], v5, s[48:51], s66 offen offset:0
    s_mov_b32 s66, 4096
    v_mul_f32 v42, s65, v152
    v_mul_f32 v43, s65, v153
    v_mul_f32 v44, s65, v154
    v_mul_f32 v45, s65, v155
    v_cvt_pk_bf16_f32 v40, v42, v43
    v_cvt_pk_bf16_f32 v41, v44, v45
    buffer_store_dwordx2 v[40:41], v5, s[48:51], s66 offen offset:0
    s_mov_b32 s66, 6144
    v_mul_f32 v50, s65, v184
    v_mul_f32 v51, s65, v185
    v_mul_f32 v52, s65, v186
    v_mul_f32 v53, s65, v187
    v_cvt_pk_bf16_f32 v48, v50, v51
    v_cvt_pk_bf16_f32 v49, v52, v53
    buffer_store_dwordx2 v[48:49], v5, s[48:51], s66 offen offset:0
    v_cmp_eq_u32 vcc, 16, v6
    s_and_saveexec_b64 s[68:69], vcc
    s_mov_b32 s66, 0
    buffer_store_dwordx2 v[20:21], v5, s[48:51], s66 offen offset:8
    buffer_store_dwordx4 v[20:23], v5, s[48:51], s66 offen offset:16
    s_mov_b32 s66, 2048
    buffer_store_dwordx2 v[20:21], v5, s[48:51], s66 offen offset:8
    buffer_store_dwordx4 v[20:23], v5, s[48:51], s66 offen offset:16
    s_mov_b32 s66, 4096
    buffer_store_dwordx2 v[20:21], v5, s[48:51], s66 offen offset:8
    buffer_store_dwordx4 v[20:23], v5, s[48:51], s66 offen offset:16
    s_mov_b32 s66, 6144
    buffer_store_dwordx2 v[20:21], v5, s[48:51], s66 offen offset:8
    buffer_store_dwordx4 v[20:23], v5, s[48:51], s66 offen offset:16
    s_mov_b64 exec, s[68:69]
    v_add_u32 v4, 56, v3
    v_mul_u32_u24 v5, 0xcccd, v4
    v_lshrrev_b32 v5, 20, v5
    v_mul_u32_u24 v6, 20, v5
    v_sub_u32 v6, v4, v6
    v_lshlrev_b32 v5, 17, v5
    v_lshl_add_u32 v5, v6, 1, v5
    v_add_u32 v5, v5, v2
    s_mov_b32 s66, 0
    v_mul_f32 v26, s65, v92
    v_mul_f32 v27, s65, v93
    v_mul_f32 v28, s65, v94
    v_mul_f32 v29, s65, v95
    v_cvt_pk_bf16_f32 v24, v26, v27
    v_cvt_pk_bf16_f32 v25, v28, v29
    buffer_store_dwordx2 v[24:25], v5, s[48:51], s66 offen offset:0
    s_mov_b32 s66, 2048
    v_mul_f32 v34, s65, v124
    v_mul_f32 v35, s65, v125
    v_mul_f32 v36, s65, v126
    v_mul_f32 v37, s65, v127
    v_cvt_pk_bf16_f32 v32, v34, v35
    v_cvt_pk_bf16_f32 v33, v36, v37
    buffer_store_dwordx2 v[32:33], v5, s[48:51], s66 offen offset:0
    s_mov_b32 s66, 4096
    v_mul_f32 v42, s65, v156
    v_mul_f32 v43, s65, v157
    v_mul_f32 v44, s65, v158
    v_mul_f32 v45, s65, v159
    v_cvt_pk_bf16_f32 v40, v42, v43
    v_cvt_pk_bf16_f32 v41, v44, v45
    buffer_store_dwordx2 v[40:41], v5, s[48:51], s66 offen offset:0
    s_mov_b32 s66, 6144
    v_mul_f32 v50, s65, v188
    v_mul_f32 v51, s65, v189
    v_mul_f32 v52, s65, v190
    v_mul_f32 v53, s65, v191
    v_cvt_pk_bf16_f32 v48, v50, v51
    v_cvt_pk_bf16_f32 v49, v52, v53
    buffer_store_dwordx2 v[48:49], v5, s[48:51], s66 offen offset:0
    v_cmp_eq_u32 vcc, 16, v6
    s_and_saveexec_b64 s[68:69], vcc
    s_mov_b32 s66, 0
    buffer_store_dwordx2 v[20:21], v5, s[48:51], s66 offen offset:8
    buffer_store_dwordx4 v[20:23], v5, s[48:51], s66 offen offset:16
    s_mov_b32 s66, 2048
    buffer_store_dwordx2 v[20:21], v5, s[48:51], s66 offen offset:8
    buffer_store_dwordx4 v[20:23], v5, s[48:51], s66 offen offset:16
    s_mov_b32 s66, 4096
    buffer_store_dwordx2 v[20:21], v5, s[48:51], s66 offen offset:8
    buffer_store_dwordx4 v[20:23], v5, s[48:51], s66 offen offset:16
    s_mov_b32 s66, 6144
    buffer_store_dwordx2 v[20:21], v5, s[48:51], s66 offen offset:8
    buffer_store_dwordx4 v[20:23], v5, s[48:51], s66 offen offset:16
    s_mov_b64 exec, s[68:69]
    s_endpgm
job_6:
    s_mov_b32 s40, s16
    s_mov_b32 s41, s17
    s_and_b32 s41, s41, 0xffff
    s_mov_b32 s42, 2621440
    s_mov_b32 s43, 0x00020000
    s_mov_b32 s44, s18
    s_mov_b32 s45, s19
    s_and_b32 s45, s45, 0xffff
    s_mov_b32 s46, 2457600
    s_mov_b32 s47, 0x00020000
    v_and_b32 v1, 63, v0
    s_and_b32 s70, s57, 3
    s_lshr_b32 s58, s70, 1
    s_and_b32 s59, s70, 1
    s_mul_i32 s72, s71, 32768
    s_add_u32 s72, s72, 65536
    v_lshrrev_b32 v2, 2, v1
    v_bfe_u32 v3, v1, 4, 2
    v_and_b32 v4, 3, v1
    v_xor_b32 v4, v4, v3
    s_mul_i32 s60, s57, 32
    s_add_u32 s60, s60, s52
    v_add_u32 v2, s60, v2
    s_mov_b32 s61, 1280
    v_mul_lo_u32 v2, v2, s61
    v_lshl_add_u32 v2, v4, 4, v2
    v_add_u32 v8, 0, v2
    v_add_u32 v9, 19456, v2
    v_lshrrev_b32 v2, 4, v1
    v_and_b32 v3, 15, v1
    v_lshrrev_b32 v4, 2, v3
    v_bfe_u32 v5, v1, 4, 2
    v_xor_b32 v4, v4, v5
    v_and_b32 v3, 3, v3
    v_lshlrev_b32 v3, 4, v3
    v_lshl_add_u32 v3, v4, 6, v3
    s_mul_i32 s60, s70, 8
    v_add_u32 v2, s60, v2
    s_mov_b32 s61, 3840
    v_mul_lo_u32 v2, v2, s61
    v_add_u32 v2, v2, v3
    s_lshl_b32 s60, s53, 1
    v_add_u32 v2, s60, v2
    v_add_u32 v12, 0, v2
    v_add_u32 v13, 14336, v2
    v_and_b32 v2, 31, v1
    v_lshrrev_b32 v3, 5, v1
    v_bfe_u32 v4, v1, 2, 2
    v_xor_b32 v4, v4, v3
    s_mul_i32 s60, s58, 128
    v_add_u32 v2, s60, v2
    v_lshlrev_b32 v2, 6, v2
    v_lshl_add_u32 v16, v4, 4, v2
    v_xor_b32 v17, 32, v16
    v_bfe_u32 v2, v1, 2, 2
    v_lshrrev_b32 v3, 5, v1
    v_lshl_add_u32 v3, v3, 3, v2
    v_mul_u32_u24 v3, 256, v3
    v_mov_b32 v4, v2
    s_mul_i32 s60, s59, 2
    v_xor_b32 v4, s60, v4
    v_lshl_add_u32 v3, v4, 6, v3
    v_bfe_u32 v4, v1, 4, 1
    v_and_b32 v5, 3, v1
    v_lshlrev_b32 v5, 3, v5
    v_lshl_add_u32 v5, v4, 5, v5
    v_add_u32 v3, v3, v5
    v_add_u32 v18, s72, v3
    v_xor_b32 v19, 64, v18
    s_mul_i32 s62, s57, 2048
    s_mul_i32 s63, s70, 2048
    s_add_u32 s63, s63, s72
    s_mov_b32 s54, 0
    s_mov_b32 s55, 0
    v_mov_b32 v64, 0
    v_mov_b32 v65, 0
    v_mov_b32 v66, 0
    v_mov_b32 v67, 0
    v_mov_b32 v68, 0
    v_mov_b32 v69, 0
    v_mov_b32 v70, 0
    v_mov_b32 v71, 0
    v_mov_b32 v72, 0
    v_mov_b32 v73, 0
    v_mov_b32 v74, 0
    v_mov_b32 v75, 0
    v_mov_b32 v76, 0
    v_mov_b32 v77, 0
    v_mov_b32 v78, 0
    v_mov_b32 v79, 0
    v_mov_b32 v80, 0
    v_mov_b32 v81, 0
    v_mov_b32 v82, 0
    v_mov_b32 v83, 0
    v_mov_b32 v84, 0
    v_mov_b32 v85, 0
    v_mov_b32 v86, 0
    v_mov_b32 v87, 0
    v_mov_b32 v88, 0
    v_mov_b32 v89, 0
    v_mov_b32 v90, 0
    v_mov_b32 v91, 0
    v_mov_b32 v92, 0
    v_mov_b32 v93, 0
    v_mov_b32 v94, 0
    v_mov_b32 v95, 0
    v_mov_b32 v96, 0
    v_mov_b32 v97, 0
    v_mov_b32 v98, 0
    v_mov_b32 v99, 0
    v_mov_b32 v100, 0
    v_mov_b32 v101, 0
    v_mov_b32 v102, 0
    v_mov_b32 v103, 0
    v_mov_b32 v104, 0
    v_mov_b32 v105, 0
    v_mov_b32 v106, 0
    v_mov_b32 v107, 0
    v_mov_b32 v108, 0
    v_mov_b32 v109, 0
    v_mov_b32 v110, 0
    v_mov_b32 v111, 0
    v_mov_b32 v112, 0
    v_mov_b32 v113, 0
    v_mov_b32 v114, 0
    v_mov_b32 v115, 0
    v_mov_b32 v116, 0
    v_mov_b32 v117, 0
    v_mov_b32 v118, 0
    v_mov_b32 v119, 0
    v_mov_b32 v120, 0
    v_mov_b32 v121, 0
    v_mov_b32 v122, 0
    v_mov_b32 v123, 0
    v_mov_b32 v124, 0
    v_mov_b32 v125, 0
    v_mov_b32 v126, 0
    v_mov_b32 v127, 0
    v_mov_b32 v128, 0
    v_mov_b32 v129, 0
    v_mov_b32 v130, 0
    v_mov_b32 v131, 0
    v_mov_b32 v132, 0
    v_mov_b32 v133, 0
    v_mov_b32 v134, 0
    v_mov_b32 v135, 0
    v_mov_b32 v136, 0
    v_mov_b32 v137, 0
    v_mov_b32 v138, 0
    v_mov_b32 v139, 0
    v_mov_b32 v140, 0
    v_mov_b32 v141, 0
    v_mov_b32 v142, 0
    v_mov_b32 v143, 0
    v_mov_b32 v144, 0
    v_mov_b32 v145, 0
    v_mov_b32 v146, 0
    v_mov_b32 v147, 0
    v_mov_b32 v148, 0
    v_mov_b32 v149, 0
    v_mov_b32 v150, 0
    v_mov_b32 v151, 0
    v_mov_b32 v152, 0
    v_mov_b32 v153, 0
    v_mov_b32 v154, 0
    v_mov_b32 v155, 0
    v_mov_b32 v156, 0
    v_mov_b32 v157, 0
    v_mov_b32 v158, 0
    v_mov_b32 v159, 0
    v_mov_b32 v160, 0
    v_mov_b32 v161, 0
    v_mov_b32 v162, 0
    v_mov_b32 v163, 0
    v_mov_b32 v164, 0
    v_mov_b32 v165, 0
    v_mov_b32 v166, 0
    v_mov_b32 v167, 0
    v_mov_b32 v168, 0
    v_mov_b32 v169, 0
    v_mov_b32 v170, 0
    v_mov_b32 v171, 0
    v_mov_b32 v172, 0
    v_mov_b32 v173, 0
    v_mov_b32 v174, 0
    v_mov_b32 v175, 0
    v_mov_b32 v176, 0
    v_mov_b32 v177, 0
    v_mov_b32 v178, 0
    v_mov_b32 v179, 0
    v_mov_b32 v180, 0
    v_mov_b32 v181, 0
    v_mov_b32 v182, 0
    v_mov_b32 v183, 0
    v_mov_b32 v184, 0
    v_mov_b32 v185, 0
    v_mov_b32 v186, 0
    v_mov_b32 v187, 0
    v_mov_b32 v188, 0
    v_mov_b32 v189, 0
    v_mov_b32 v190, 0
    v_mov_b32 v191, 0
    s_add_u32 m0, s62, 0
    s_nop 0
    buffer_load_dwordx4 v8, s[40:43], s54 offen offset:0 lds
    buffer_load_dwordx4 v9, s[40:43], s54 offen offset:1024 lds
    s_add_u32 m0, s63, 0
    s_nop 0
    buffer_load_dwordx4 v12, s[44:47], s55 offen offset:0 lds
    buffer_load_dwordx4 v13, s[44:47], s55 offen offset:1024 lds
    buffer_load_dword v60, v61, s[76:79], 0 offen
    v_add_u32 v61, 524288, v61
    s_add_u32 s54, s54, 64
    s_add_u32 s55, s55, 122880
    s_add_u32 m0, s62, 16384
    s_nop 0
    buffer_load_dwordx4 v8, s[40:43], s54 offen offset:0 lds
    buffer_load_dwordx4 v9, s[40:43], s54 offen offset:1024 lds
    s_add_u32 m0, s63, 8192
    s_nop 0
    buffer_load_dwordx4 v12, s[44:47], s55 offen offset:0 lds
    buffer_load_dwordx4 v13, s[44:47], s55 offen offset:1024 lds
    buffer_load_dword v60, v61, s[76:79], 0 offen
    v_add_u32 v61, 524288, v61
    s_add_u32 s54, s54, 64
    s_add_u32 s55, s55, 122880
    s_add_u32 m0, s62, 32768
    s_nop 0
    buffer_load_dwordx4 v8, s[40:43], s54 offen offset:0 lds
    buffer_load_dwordx4 v9, s[40:43], s54 offen offset:1024 lds
    s_add_u32 m0, s63, 16384
    s_nop 0
    buffer_load_dwordx4 v12, s[44:47], s55 offen offset:0 lds
    buffer_load_dwordx4 v13, s[44:47], s55 offen offset:1024 lds
    buffer_load_dword v60, v61, s[76:79], 0 offen
    v_add_u32 v61, 524288, v61
    s_add_u32 s54, s54, 64
    s_add_u32 s55, s55, 122880
    s_mov_b32 s56, 20
    s_waitcnt vmcnt(11)
    s_barrier
    ds_read_b64_tr_b16 v[224:225], v18 offset:0
    ds_read_b64_tr_b16 v[226:227], v18 offset:1024
    ds_read_b128 v[192:195], v16 offset:0
    ds_read_b64_tr_b16 v[228:229], v19 offset:0
    ds_read_b64_tr_b16 v[230:231], v19 offset:1024
    ds_read_b128 v[196:199], v16 offset:2048
    ds_read_b128 v[200:203], v16 offset:4096
    ds_read_b128 v[204:207], v16 offset:6144
    s_waitcnt lgkmcnt(0)
gl_17:
    v_mfma_f32_32x32x16_bf16 v[64:79], v[224:227], v[192:195], v[64:79]
    ds_read_b64_tr_b16 v[232:233], v18 offset:4096
    ds_read_b64_tr_b16 v[234:235], v18 offset:5120
    v_mfma_f32_32x32x16_bf16 v[80:95], v[228:231], v[192:195], v[80:95]
    ds_read_b128 v[208:211], v17 offset:0
    v_mfma_f32_32x32x16_bf16 v[96:111], v[224:227], v[196:199], v[96:111]
    ds_read_b64_tr_b16 v[236:237], v19 offset:4096
    ds_read_b64_tr_b16 v[238:239], v19 offset:5120
    v_mfma_f32_32x32x16_bf16 v[112:127], v[228:231], v[196:199], v[112:127]
    ds_read_b128 v[212:215], v17 offset:2048
    v_mfma_f32_32x32x16_bf16 v[128:143], v[224:227], v[200:203], v[128:143]
    ds_read_b128 v[216:219], v17 offset:4096
    v_mfma_f32_32x32x16_bf16 v[144:159], v[228:231], v[200:203], v[144:159]
    ds_read_b128 v[220:223], v17 offset:6144
    v_mfma_f32_32x32x16_bf16 v[160:175], v[224:227], v[204:207], v[160:175]
    v_mfma_f32_32x32x16_bf16 v[176:191], v[228:231], v[204:207], v[176:191]
    s_waitcnt vmcnt(6)
    s_barrier
    s_cmp_le_u32 s56, 3
    s_cselect_b32 s42, 0, s42
    s_cselect_b32 s46, 0, s46
    s_add_u32 m0, s62, 49152
    s_nop 0
    buffer_load_dwordx4 v8, s[40:43], s54 offen offset:0 lds
    buffer_load_dwordx4 v9, s[40:43], s54 offen offset:1024 lds
    s_add_u32 m0, s63, 24576
    s_nop 0
    buffer_load_dwordx4 v12, s[44:47], s55 offen offset:0 lds
    buffer_load_dwordx4 v13, s[44:47], s55 offen offset:1024 lds
    buffer_load_dword v60, v61, s[76:79], 0 offen
    v_add_u32 v61, 524288, v61
    s_add_u32 s54, s54, 64
    s_add_u32 s55, s55, 122880
    s_waitcnt lgkmcnt(5)
    v_mfma_f32_32x32x16_bf16 v[64:79], v[232:235], v[208:211], v[64:79]
    ds_read_b64_tr_b16 v[224:225], v18 offset:8192
    ds_read_b64_tr_b16 v[226:227], v18 offset:9216
    s_waitcnt lgkmcnt(5)
    v_mfma_f32_32x32x16_bf16 v[80:95], v[236:239], v[208:211], v[80:95]
    ds_read_b128 v[192:195], v16 offset:16384
    s_waitcnt lgkmcnt(5)
    v_mfma_f32_32x32x16_bf16 v[96:111], v[232:235], v[212:215], v[96:111]
    ds_read_b64_tr_b16 v[228:229], v19 offset:8192
    ds_read_b64_tr_b16 v[230:231], v19 offset:9216
    v_mfma_f32_32x32x16_bf16 v[112:127], v[236:239], v[212:215], v[112:127]
    ds_read_b128 v[196:199], v16 offset:18432
    s_waitcnt lgkmcnt(7)
    v_mfma_f32_32x32x16_bf16 v[128:143], v[232:235], v[216:219], v[128:143]
    ds_read_b128 v[200:203], v16 offset:20480
    v_mfma_f32_32x32x16_bf16 v[144:159], v[236:239], v[216:219], v[144:159]
    ds_read_b128 v[204:207], v16 offset:22528
    s_waitcnt lgkmcnt(8)
    v_mfma_f32_32x32x16_bf16 v[160:175], v[232:235], v[220:223], v[160:175]
    v_mfma_f32_32x32x16_bf16 v[176:191], v[236:239], v[220:223], v[176:191]
    s_sub_u32 s56, s56, 1
    s_waitcnt lgkmcnt(5)
    v_mfma_f32_32x32x16_bf16 v[64:79], v[224:227], v[192:195], v[64:79]
    ds_read_b64_tr_b16 v[232:233], v18 offset:12288
    ds_read_b64_tr_b16 v[234:235], v18 offset:13312
    s_waitcnt lgkmcnt(5)
    v_mfma_f32_32x32x16_bf16 v[80:95], v[228:231], v[192:195], v[80:95]
    ds_read_b128 v[208:211], v17 offset:16384
    s_waitcnt lgkmcnt(5)
    v_mfma_f32_32x32x16_bf16 v[96:111], v[224:227], v[196:199], v[96:111]
    ds_read_b64_tr_b16 v[236:237], v19 offset:12288
    ds_read_b64_tr_b16 v[238:239], v19 offset:13312
    v_mfma_f32_32x32x16_bf16 v[112:127], v[228:231], v[196:199], v[112:127]
    ds_read_b128 v[212:215], v17 offset:18432
    s_waitcnt lgkmcnt(7)
    v_mfma_f32_32x32x16_bf16 v[128:143], v[224:227], v[200:203], v[128:143]
    ds_read_b128 v[216:219], v17 offset:20480
    v_mfma_f32_32x32x16_bf16 v[144:159], v[228:231], v[200:203], v[144:159]
    ds_read_b128 v[220:223], v17 offset:22528
    s_waitcnt lgkmcnt(8)
    v_mfma_f32_32x32x16_bf16 v[160:175], v[224:227], v[204:207], v[160:175]
    v_mfma_f32_32x32x16_bf16 v[176:191], v[228:231], v[204:207], v[176:191]
    s_waitcnt vmcnt(6)
    s_barrier
    s_cmp_le_u32 s56, 3
    s_cselect_b32 s42, 0, s42
    s_cselect_b32 s46, 0, s46
    s_add_u32 m0, s62, 0
    s_nop 0
    buffer_load_dwordx4 v8, s[40:43], s54 offen offset:0 lds
    buffer_load_dwordx4 v9, s[40:43], s54 offen offset:1024 lds
    s_add_u32 m0, s63, 0
    s_nop 0
    buffer_load_dwordx4 v12, s[44:47], s55 offen offset:0 lds
    buffer_load_dwordx4 v13, s[44:47], s55 offen offset:1024 lds
    buffer_load_dword v60, v61, s[76:79], 0 offen
    v_add_u32 v61, 524288, v61
    s_add_u32 s54, s54, 64
    s_add_u32 s55, s55, 122880
    s_waitcnt lgkmcnt(5)
    v_mfma_f32_32x32x16_bf16 v[64:79], v[232:235], v[208:211], v[64:79]
    ds_read_b64_tr_b16 v[224:225], v18 offset:16384
    ds_read_b64_tr_b16 v[226:227], v18 offset:17408
    s_waitcnt lgkmcnt(5)
    v_mfma_f32_32x32x16_bf16 v[80:95], v[236:239], v[208:211], v[80:95]
    ds_read_b128 v[192:195], v16 offset:32768
    s_waitcnt lgkmcnt(5)
    v_mfma_f32_32x32x16_bf16 v[96:111], v[232:235], v[212:215], v[96:111]
    ds_read_b64_tr_b16 v[228:229], v19 offset:16384
    ds_read_b64_tr_b16 v[230:231], v19 offset:17408
    v_mfma_f32_32x32x16_bf16 v[112:127], v[236:239], v[212:215], v[112:127]
    ds_read_b128 v[196:199], v16 offset:34816
    s_waitcnt lgkmcnt(7)
    v_mfma_f32_32x32x16_bf16 v[128:143], v[232:235], v[216:219], v[128:143]
    ds_read_b128 v[200:203], v16 offset:36864
    v_mfma_f32_32x32x16_bf16 v[144:159], v[236:239], v[216:219], v[144:159]
    ds_read_b128 v[204:207], v16 offset:38912
    s_waitcnt lgkmcnt(8)
    v_mfma_f32_32x32x16_bf16 v[160:175], v[232:235], v[220:223], v[160:175]
    v_mfma_f32_32x32x16_bf16 v[176:191], v[236:239], v[220:223], v[176:191]
    s_sub_u32 s56, s56, 1
    s_waitcnt lgkmcnt(5)
    v_mfma_f32_32x32x16_bf16 v[64:79], v[224:227], v[192:195], v[64:79]
    ds_read_b64_tr_b16 v[232:233], v18 offset:20480
    ds_read_b64_tr_b16 v[234:235], v18 offset:21504
    s_waitcnt lgkmcnt(5)
    v_mfma_f32_32x32x16_bf16 v[80:95], v[228:231], v[192:195], v[80:95]
    ds_read_b128 v[208:211], v17 offset:32768
    s_waitcnt lgkmcnt(5)
    v_mfma_f32_32x32x16_bf16 v[96:111], v[224:227], v[196:199], v[96:111]
    ds_read_b64_tr_b16 v[236:237], v19 offset:20480
    ds_read_b64_tr_b16 v[238:239], v19 offset:21504
    v_mfma_f32_32x32x16_bf16 v[112:127], v[228:231], v[196:199], v[112:127]
    ds_read_b128 v[212:215], v17 offset:34816
    s_waitcnt lgkmcnt(7)
    v_mfma_f32_32x32x16_bf16 v[128:143], v[224:227], v[200:203], v[128:143]
    ds_read_b128 v[216:219], v17 offset:36864
    v_mfma_f32_32x32x16_bf16 v[144:159], v[228:231], v[200:203], v[144:159]
    ds_read_b128 v[220:223], v17 offset:38912
    s_waitcnt lgkmcnt(8)
    v_mfma_f32_32x32x16_bf16 v[160:175], v[224:227], v[204:207], v[160:175]
    v_mfma_f32_32x32x16_bf16 v[176:191], v[228:231], v[204:207], v[176:191]
    s_waitcnt vmcnt(6)
    s_barrier
    s_cmp_le_u32 s56, 3
    s_cselect_b32 s42, 0, s42
    s_cselect_b32 s46, 0, s46
    s_add_u32 m0, s62, 16384
    s_nop 0
    buffer_load_dwordx4 v8, s[40:43], s54 offen offset:0 lds
    buffer_load_dwordx4 v9, s[40:43], s54 offen offset:1024 lds
    s_add_u32 m0, s63, 8192
    s_nop 0
    buffer_load_dwordx4 v12, s[44:47], s55 offen offset:0 lds
    buffer_load_dwordx4 v13, s[44:47], s55 offen offset:1024 lds
    buffer_load_dword v60, v61, s[76:79], 0 offen
    v_add_u32 v61, 524288, v61
    s_add_u32 s54, s54, 64
    s_add_u32 s55, s55, 122880
    s_waitcnt lgkmcnt(5)
    v_mfma_f32_32x32x16_bf16 v[64:79], v[232:235], v[208:211], v[64:79]
    ds_read_b64_tr_b16 v[224:225], v18 offset:24576
    ds_read_b64_tr_b16 v[226:227], v18 offset:25600
    s_waitcnt lgkmcnt(5)
    v_mfma_f32_32x32x16_bf16 v[80:95], v[236:239], v[208:211], v[80:95]
    ds_read_b128 v[192:195], v16 offset:49152
    s_waitcnt lgkmcnt(5)
    v_mfma_f32_32x32x16_bf16 v[96:111], v[232:235], v[212:215], v[96:111]
    ds_read_b64_tr_b16 v[228:229], v19 offset:24576
    ds_read_b64_tr_b16 v[230:231], v19 offset:25600
    v_mfma_f32_32x32x16_bf16 v[112:127], v[236:239], v[212:215], v[112:127]
    ds_read_b128 v[196:199], v16 offset:51200
    s_waitcnt lgkmcnt(7)
    v_mfma_f32_32x32x16_bf16 v[128:143], v[232:235], v[216:219], v[128:143]
    ds_read_b128 v[200:203], v16 offset:53248
    v_mfma_f32_32x32x16_bf16 v[144:159], v[236:239], v[216:219], v[144:159]
    ds_read_b128 v[204:207], v16 offset:55296
    s_waitcnt lgkmcnt(8)
    v_mfma_f32_32x32x16_bf16 v[160:175], v[232:235], v[220:223], v[160:175]
    v_mfma_f32_32x32x16_bf16 v[176:191], v[236:239], v[220:223], v[176:191]
    s_sub_u32 s56, s56, 1
    s_waitcnt lgkmcnt(5)
    v_mfma_f32_32x32x16_bf16 v[64:79], v[224:227], v[192:195], v[64:79]
    ds_read_b64_tr_b16 v[232:233], v18 offset:28672
    ds_read_b64_tr_b16 v[234:235], v18 offset:29696
    s_waitcnt lgkmcnt(5)
    v_mfma_f32_32x32x16_bf16 v[80:95], v[228:231], v[192:195], v[80:95]
    ds_read_b128 v[208:211], v17 offset:49152
    s_waitcnt lgkmcnt(5)
    v_mfma_f32_32x32x16_bf16 v[96:111], v[224:227], v[196:199], v[96:111]
    ds_read_b64_tr_b16 v[236:237], v19 offset:28672
    ds_read_b64_tr_b16 v[238:239], v19 offset:29696
    v_mfma_f32_32x32x16_bf16 v[112:127], v[228:231], v[196:199], v[112:127]
    ds_read_b128 v[212:215], v17 offset:51200
    s_waitcnt lgkmcnt(7)
    v_mfma_f32_32x32x16_bf16 v[128:143], v[224:227], v[200:203], v[128:143]
    ds_read_b128 v[216:219], v17 offset:53248
    v_mfma_f32_32x32x16_bf16 v[144:159], v[228:231], v[200:203], v[144:159]
    ds_read_b128 v[220:223], v17 offset:55296
    s_waitcnt lgkmcnt(8)
    v_mfma_f32_32x32x16_bf16 v[160:175], v[224:227], v[204:207], v[160:175]
    v_mfma_f32_32x32x16_bf16 v[176:191], v[228:231], v[204:207], v[176:191]
    s_waitcnt vmcnt(6)
    s_barrier
    s_cmp_le_u32 s56, 3
    s_cselect_b32 s42, 0, s42
    s_cselect_b32 s46, 0, s46
    s_add_u32 m0, s62, 32768
    s_nop 0
    buffer_load_dwordx4 v8, s[40:43], s54 offen offset:0 lds
    buffer_load_dwordx4 v9, s[40:43], s54 offen offset:1024 lds
    s_add_u32 m0, s63, 16384
    s_nop 0
    buffer_load_dwordx4 v12, s[44:47], s55 offen offset:0 lds
    buffer_load_dwordx4 v13, s[44:47], s55 offen offset:1024 lds
    buffer_load_dword v60, v61, s[76:79], 0 offen
    v_add_u32 v61, 524288, v61
    s_add_u32 s54, s54, 64
    s_add_u32 s55, s55, 122880
    s_waitcnt lgkmcnt(5)
    v_mfma_f32_32x32x16_bf16 v[64:79], v[232:235], v[208:211], v[64:79]
    ds_read_b64_tr_b16 v[224:225], v18 offset:0
    ds_read_b64_tr_b16 v[226:227], v18 offset:1024
    s_waitcnt lgkmcnt(5)
    v_mfma_f32_32x32x16_bf16 v[80:95], v[236:239], v[208:211], v[80:95]
    ds_read_b128 v[192:195], v16 offset:0
    s_waitcnt lgkmcnt(5)
    v_mfma_f32_32x32x16_bf16 v[96:111], v[232:235], v[212:215], v[96:111]
    ds_read_b64_tr_b16 v[228:229], v19 offset:0
    ds_read_b64_tr_b16 v[230:231], v19 offset:1024
    v_mfma_f32_32x32x16_bf16 v[112:127], v[236:239], v[212:215], v[112:127]
    ds_read_b128 v[196:199], v16 offset:2048
    s_waitcnt lgkmcnt(7)
    v_mfma_f32_32x32x16_bf16 v[128:143], v[232:235], v[216:219], v[128:143]
    ds_read_b128 v[200:203], v16 offset:4096
    v_mfma_f32_32x32x16_bf16 v[144:159], v[236:239], v[216:219], v[144:159]
    ds_read_b128 v[204:207], v16 offset:6144
    s_waitcnt lgkmcnt(8)
    v_mfma_f32_32x32x16_bf16 v[160:175], v[232:235], v[220:223], v[160:175]
    v_mfma_f32_32x32x16_bf16 v[176:191], v[236:239], v[220:223], v[176:191]
    s_sub_u32 s56, s56, 1
    s_cmp_eq_u32 s56, 0
    s_waitcnt lgkmcnt(0)
    s_nop 8
    s_cbranch_scc1 gd_18
    s_branch gl_17
gd_18:
    s_waitcnt vmcnt(0) lgkmcnt(0)
    s_barrier
    s_mov_b32 s48, s38
    s_mov_b32 s49, s39
    s_and_b32 s49, s49, 0xffff
    s_mov_b32 s50, 8388608
    s_mov_b32 s51, 0x00020000
    v_and_b32 v2, 31, v1
    s_mul_i32 s60, s58, 128
    s_add_u32 s60, s60, s52
    v_add_u32 v2, s60, v2
    v_lshlrev_b32 v2, 6, v2
    v_lshrrev_b32 v3, 5, v1
    v_lshlrev_b32 v3, 2, v3
    s_mul_i32 s60, s59, 64
    s_add_u32 s60, s60, s53
    v_add_u32 v3, s60, v3
    v_mov_b32 v20, 0
    v_mov_b32 v21, 0
    v_mov_b32 v22, 0
    v_mov_b32 v23, 0
    v_add_u32 v4, 0, v3
    v_mul_u32_u24 v5, 0xcccd, v4
    v_lshrrev_b32 v5, 20, v5
    v_mul_u32_u24 v6, 20, v5
    v_sub_u32 v6, v4, v6
    v_lshlrev_b32 v5, 17, v5
    v_lshl_add_u32 v5, v6, 1, v5
    v_add_u32 v5, v5, v2
    s_mov_b32 s66, 0
    v_cvt_pk_bf16_f32 v24, v64, v65
    v_cvt_pk_bf16_f32 v25, v66, v67
    buffer_store_dwordx2 v[24:25], v5, s[48:51], s66 offen offset:0
    s_mov_b32 s66, 2048
    v_cvt_pk_bf16_f32 v32, v96, v97
    v_cvt_pk_bf16_f32 v33, v98, v99
    buffer_store_dwordx2 v[32:33], v5, s[48:51], s66 offen offset:0
    s_mov_b32 s66, 4096
    v_cvt_pk_bf16_f32 v40, v128, v129
    v_cvt_pk_bf16_f32 v41, v130, v131
    buffer_store_dwordx2 v[40:41], v5, s[48:51], s66 offen offset:0
    s_mov_b32 s66, 6144
    v_cvt_pk_bf16_f32 v48, v160, v161
    v_cvt_pk_bf16_f32 v49, v162, v163
    buffer_store_dwordx2 v[48:49], v5, s[48:51], s66 offen offset:0
    v_cmp_eq_u32 vcc, 16, v6
    s_and_saveexec_b64 s[68:69], vcc
    s_mov_b32 s66, 0
    buffer_store_dwordx2 v[20:21], v5, s[48:51], s66 offen offset:8
    buffer_store_dwordx4 v[20:23], v5, s[48:51], s66 offen offset:16
    s_mov_b32 s66, 2048
    buffer_store_dwordx2 v[20:21], v5, s[48:51], s66 offen offset:8
    buffer_store_dwordx4 v[20:23], v5, s[48:51], s66 offen offset:16
    s_mov_b32 s66, 4096
    buffer_store_dwordx2 v[20:21], v5, s[48:51], s66 offen offset:8
    buffer_store_dwordx4 v[20:23], v5, s[48:51], s66 offen offset:16
    s_mov_b32 s66, 6144
    buffer_store_dwordx2 v[20:21], v5, s[48:51], s66 offen offset:8
    buffer_store_dwordx4 v[20:23], v5, s[48:51], s66 offen offset:16
    s_mov_b64 exec, s[68:69]
    v_add_u32 v4, 8, v3
    v_mul_u32_u24 v5, 0xcccd, v4
    v_lshrrev_b32 v5, 20, v5
    v_mul_u32_u24 v6, 20, v5
    v_sub_u32 v6, v4, v6
    v_lshlrev_b32 v5, 17, v5
    v_lshl_add_u32 v5, v6, 1, v5
    v_add_u32 v5, v5, v2
    s_mov_b32 s66, 0
    v_cvt_pk_bf16_f32 v24, v68, v69
    v_cvt_pk_bf16_f32 v25, v70, v71
    buffer_store_dwordx2 v[24:25], v5, s[48:51], s66 offen offset:0
    s_mov_b32 s66, 2048
    v_cvt_pk_bf16_f32 v32, v100, v101
    v_cvt_pk_bf16_f32 v33, v102, v103
    buffer_store_dwordx2 v[32:33], v5, s[48:51], s66 offen offset:0
    s_mov_b32 s66, 4096
    v_cvt_pk_bf16_f32 v40, v132, v133
    v_cvt_pk_bf16_f32 v41, v134, v135
    buffer_store_dwordx2 v[40:41], v5, s[48:51], s66 offen offset:0
    s_mov_b32 s66, 6144
    v_cvt_pk_bf16_f32 v48, v164, v165
    v_cvt_pk_bf16_f32 v49, v166, v167
    buffer_store_dwordx2 v[48:49], v5, s[48:51], s66 offen offset:0
    v_cmp_eq_u32 vcc, 16, v6
    s_and_saveexec_b64 s[68:69], vcc
    s_mov_b32 s66, 0
    buffer_store_dwordx2 v[20:21], v5, s[48:51], s66 offen offset:8
    buffer_store_dwordx4 v[20:23], v5, s[48:51], s66 offen offset:16
    s_mov_b32 s66, 2048
    buffer_store_dwordx2 v[20:21], v5, s[48:51], s66 offen offset:8
    buffer_store_dwordx4 v[20:23], v5, s[48:51], s66 offen offset:16
    s_mov_b32 s66, 4096
    buffer_store_dwordx2 v[20:21], v5, s[48:51], s66 offen offset:8
    buffer_store_dwordx4 v[20:23], v5, s[48:51], s66 offen offset:16
    s_mov_b32 s66, 6144
    buffer_store_dwordx2 v[20:21], v5, s[48:51], s66 offen offset:8
    buffer_store_dwordx4 v[20:23], v5, s[48:51], s66 offen offset:16
    s_mov_b64 exec, s[68:69]
    v_add_u32 v4, 16, v3
    v_mul_u32_u24 v5, 0xcccd, v4
    v_lshrrev_b32 v5, 20, v5
    v_mul_u32_u24 v6, 20, v5
    v_sub_u32 v6, v4, v6
    v_lshlrev_b32 v5, 17, v5
    v_lshl_add_u32 v5, v6, 1, v5
    v_add_u32 v5, v5, v2
    s_mov_b32 s66, 0
    v_cvt_pk_bf16_f32 v24, v72, v73
    v_cvt_pk_bf16_f32 v25, v74, v75
    buffer_store_dwordx2 v[24:25], v5, s[48:51], s66 offen offset:0
    s_mov_b32 s66, 2048
    v_cvt_pk_bf16_f32 v32, v104, v105
    v_cvt_pk_bf16_f32 v33, v106, v107
    buffer_store_dwordx2 v[32:33], v5, s[48:51], s66 offen offset:0
    s_mov_b32 s66, 4096
    v_cvt_pk_bf16_f32 v40, v136, v137
    v_cvt_pk_bf16_f32 v41, v138, v139
    buffer_store_dwordx2 v[40:41], v5, s[48:51], s66 offen offset:0
    s_mov_b32 s66, 6144
    v_cvt_pk_bf16_f32 v48, v168, v169
    v_cvt_pk_bf16_f32 v49, v170, v171
    buffer_store_dwordx2 v[48:49], v5, s[48:51], s66 offen offset:0
    v_cmp_eq_u32 vcc, 16, v6
    s_and_saveexec_b64 s[68:69], vcc
    s_mov_b32 s66, 0
    buffer_store_dwordx2 v[20:21], v5, s[48:51], s66 offen offset:8
    buffer_store_dwordx4 v[20:23], v5, s[48:51], s66 offen offset:16
    s_mov_b32 s66, 2048
    buffer_store_dwordx2 v[20:21], v5, s[48:51], s66 offen offset:8
    buffer_store_dwordx4 v[20:23], v5, s[48:51], s66 offen offset:16
    s_mov_b32 s66, 4096
    buffer_store_dwordx2 v[20:21], v5, s[48:51], s66 offen offset:8
    buffer_store_dwordx4 v[20:23], v5, s[48:51], s66 offen offset:16
    s_mov_b32 s66, 6144
    buffer_store_dwordx2 v[20:21], v5, s[48:51], s66 offen offset:8
    buffer_store_dwordx4 v[20:23], v5, s[48:51], s66 offen offset:16
    s_mov_b64 exec, s[68:69]
    v_add_u32 v4, 24, v3
    v_mul_u32_u24 v5, 0xcccd, v4
    v_lshrrev_b32 v5, 20, v5
    v_mul_u32_u24 v6, 20, v5
    v_sub_u32 v6, v4, v6
    v_lshlrev_b32 v5, 17, v5
    v_lshl_add_u32 v5, v6, 1, v5
    v_add_u32 v5, v5, v2
    s_mov_b32 s66, 0
    v_cvt_pk_bf16_f32 v24, v76, v77
    v_cvt_pk_bf16_f32 v25, v78, v79
    buffer_store_dwordx2 v[24:25], v5, s[48:51], s66 offen offset:0
    s_mov_b32 s66, 2048
    v_cvt_pk_bf16_f32 v32, v108, v109
    v_cvt_pk_bf16_f32 v33, v110, v111
    buffer_store_dwordx2 v[32:33], v5, s[48:51], s66 offen offset:0
    s_mov_b32 s66, 4096
    v_cvt_pk_bf16_f32 v40, v140, v141
    v_cvt_pk_bf16_f32 v41, v142, v143
    buffer_store_dwordx2 v[40:41], v5, s[48:51], s66 offen offset:0
    s_mov_b32 s66, 6144
    v_cvt_pk_bf16_f32 v48, v172, v173
    v_cvt_pk_bf16_f32 v49, v174, v175
    buffer_store_dwordx2 v[48:49], v5, s[48:51], s66 offen offset:0
    v_cmp_eq_u32 vcc, 16, v6
    s_and_saveexec_b64 s[68:69], vcc
    s_mov_b32 s66, 0
    buffer_store_dwordx2 v[20:21], v5, s[48:51], s66 offen offset:8
    buffer_store_dwordx4 v[20:23], v5, s[48:51], s66 offen offset:16
    s_mov_b32 s66, 2048
    buffer_store_dwordx2 v[20:21], v5, s[48:51], s66 offen offset:8
    buffer_store_dwordx4 v[20:23], v5, s[48:51], s66 offen offset:16
    s_mov_b32 s66, 4096
    buffer_store_dwordx2 v[20:21], v5, s[48:51], s66 offen offset:8
    buffer_store_dwordx4 v[20:23], v5, s[48:51], s66 offen offset:16
    s_mov_b32 s66, 6144
    buffer_store_dwordx2 v[20:21], v5, s[48:51], s66 offen offset:8
    buffer_store_dwordx4 v[20:23], v5, s[48:51], s66 offen offset:16
    s_mov_b64 exec, s[68:69]
    v_add_u32 v4, 32, v3
    v_mul_u32_u24 v5, 0xcccd, v4
    v_lshrrev_b32 v5, 20, v5
    v_mul_u32_u24 v6, 20, v5
    v_sub_u32 v6, v4, v6
    v_lshlrev_b32 v5, 17, v5
    v_lshl_add_u32 v5, v6, 1, v5
    v_add_u32 v5, v5, v2
    s_mov_b32 s66, 0
    v_cvt_pk_bf16_f32 v24, v80, v81
    v_cvt_pk_bf16_f32 v25, v82, v83
    buffer_store_dwordx2 v[24:25], v5, s[48:51], s66 offen offset:0
    s_mov_b32 s66, 2048
    v_cvt_pk_bf16_f32 v32, v112, v113
    v_cvt_pk_bf16_f32 v33, v114, v115
    buffer_store_dwordx2 v[32:33], v5, s[48:51], s66 offen offset:0
    s_mov_b32 s66, 4096
    v_cvt_pk_bf16_f32 v40, v144, v145
    v_cvt_pk_bf16_f32 v41, v146, v147
    buffer_store_dwordx2 v[40:41], v5, s[48:51], s66 offen offset:0
    s_mov_b32 s66, 6144
    v_cvt_pk_bf16_f32 v48, v176, v177
    v_cvt_pk_bf16_f32 v49, v178, v179
    buffer_store_dwordx2 v[48:49], v5, s[48:51], s66 offen offset:0
    v_cmp_eq_u32 vcc, 16, v6
    s_and_saveexec_b64 s[68:69], vcc
    s_mov_b32 s66, 0
    buffer_store_dwordx2 v[20:21], v5, s[48:51], s66 offen offset:8
    buffer_store_dwordx4 v[20:23], v5, s[48:51], s66 offen offset:16
    s_mov_b32 s66, 2048
    buffer_store_dwordx2 v[20:21], v5, s[48:51], s66 offen offset:8
    buffer_store_dwordx4 v[20:23], v5, s[48:51], s66 offen offset:16
    s_mov_b32 s66, 4096
    buffer_store_dwordx2 v[20:21], v5, s[48:51], s66 offen offset:8
    buffer_store_dwordx4 v[20:23], v5, s[48:51], s66 offen offset:16
    s_mov_b32 s66, 6144
    buffer_store_dwordx2 v[20:21], v5, s[48:51], s66 offen offset:8
    buffer_store_dwordx4 v[20:23], v5, s[48:51], s66 offen offset:16
    s_mov_b64 exec, s[68:69]
    v_add_u32 v4, 40, v3
    v_mul_u32_u24 v5, 0xcccd, v4
    v_lshrrev_b32 v5, 20, v5
    v_mul_u32_u24 v6, 20, v5
    v_sub_u32 v6, v4, v6
    v_lshlrev_b32 v5, 17, v5
    v_lshl_add_u32 v5, v6, 1, v5
    v_add_u32 v5, v5, v2
    s_mov_b32 s66, 0
    v_cvt_pk_bf16_f32 v24, v84, v85
    v_cvt_pk_bf16_f32 v25, v86, v87
    buffer_store_dwordx2 v[24:25], v5, s[48:51], s66 offen offset:0
    s_mov_b32 s66, 2048
    v_cvt_pk_bf16_f32 v32, v116, v117
    v_cvt_pk_bf16_f32 v33, v118, v119
    buffer_store_dwordx2 v[32:33], v5, s[48:51], s66 offen offset:0
    s_mov_b32 s66, 4096
    v_cvt_pk_bf16_f32 v40, v148, v149
    v_cvt_pk_bf16_f32 v41, v150, v151
    buffer_store_dwordx2 v[40:41], v5, s[48:51], s66 offen offset:0
    s_mov_b32 s66, 6144
    v_cvt_pk_bf16_f32 v48, v180, v181
    v_cvt_pk_bf16_f32 v49, v182, v183
    buffer_store_dwordx2 v[48:49], v5, s[48:51], s66 offen offset:0
    v_cmp_eq_u32 vcc, 16, v6
    s_and_saveexec_b64 s[68:69], vcc
    s_mov_b32 s66, 0
    buffer_store_dwordx2 v[20:21], v5, s[48:51], s66 offen offset:8
    buffer_store_dwordx4 v[20:23], v5, s[48:51], s66 offen offset:16
    s_mov_b32 s66, 2048
    buffer_store_dwordx2 v[20:21], v5, s[48:51], s66 offen offset:8
    buffer_store_dwordx4 v[20:23], v5, s[48:51], s66 offen offset:16
    s_mov_b32 s66, 4096
    buffer_store_dwordx2 v[20:21], v5, s[48:51], s66 offen offset:8
    buffer_store_dwordx4 v[20:23], v5, s[48:51], s66 offen offset:16
    s_mov_b32 s66, 6144
    buffer_store_dwordx2 v[20:21], v5, s[48:51], s66 offen offset:8
    buffer_store_dwordx4 v[20:23], v5, s[48:51], s66 offen offset:16
    s_mov_b64 exec, s[68:69]
    v_add_u32 v4, 48, v3
    v_mul_u32_u24 v5, 0xcccd, v4
    v_lshrrev_b32 v5, 20, v5
    v_mul_u32_u24 v6, 20, v5
    v_sub_u32 v6, v4, v6
    v_lshlrev_b32 v5, 17, v5
    v_lshl_add_u32 v5, v6, 1, v5
    v_add_u32 v5, v5, v2
    s_mov_b32 s66, 0
    v_cvt_pk_bf16_f32 v24, v88, v89
    v_cvt_pk_bf16_f32 v25, v90, v91
    buffer_store_dwordx2 v[24:25], v5, s[48:51], s66 offen offset:0
    s_mov_b32 s66, 2048
    v_cvt_pk_bf16_f32 v32, v120, v121
    v_cvt_pk_bf16_f32 v33, v122, v123
    buffer_store_dwordx2 v[32:33], v5, s[48:51], s66 offen offset:0
    s_mov_b32 s66, 4096
    v_cvt_pk_bf16_f32 v40, v152, v153
    v_cvt_pk_bf16_f32 v41, v154, v155
    buffer_store_dwordx2 v[40:41], v5, s[48:51], s66 offen offset:0
    s_mov_b32 s66, 6144
    v_cvt_pk_bf16_f32 v48, v184, v185
    v_cvt_pk_bf16_f32 v49, v186, v187
    buffer_store_dwordx2 v[48:49], v5, s[48:51], s66 offen offset:0
    v_cmp_eq_u32 vcc, 16, v6
    s_and_saveexec_b64 s[68:69], vcc
    s_mov_b32 s66, 0
    buffer_store_dwordx2 v[20:21], v5, s[48:51], s66 offen offset:8
    buffer_store_dwordx4 v[20:23], v5, s[48:51], s66 offen offset:16
    s_mov_b32 s66, 2048
    buffer_store_dwordx2 v[20:21], v5, s[48:51], s66 offen offset:8
    buffer_store_dwordx4 v[20:23], v5, s[48:51], s66 offen offset:16
    s_mov_b32 s66, 4096
    buffer_store_dwordx2 v[20:21], v5, s[48:51], s66 offen offset:8
    buffer_store_dwordx4 v[20:23], v5, s[48:51], s66 offen offset:16
    s_mov_b32 s66, 6144
    buffer_store_dwordx2 v[20:21], v5, s[48:51], s66 offen offset:8
    buffer_store_dwordx4 v[20:23], v5, s[48:51], s66 offen offset:16
    s_mov_b64 exec, s[68:69]
    v_add_u32 v4, 56, v3
    v_mul_u32_u24 v5, 0xcccd, v4
    v_lshrrev_b32 v5, 20, v5
    v_mul_u32_u24 v6, 20, v5
    v_sub_u32 v6, v4, v6
    v_lshlrev_b32 v5, 17, v5
    v_lshl_add_u32 v5, v6, 1, v5
    v_add_u32 v5, v5, v2
    s_mov_b32 s66, 0
    v_cvt_pk_bf16_f32 v24, v92, v93
    v_cvt_pk_bf16_f32 v25, v94, v95
    buffer_store_dwordx2 v[24:25], v5, s[48:51], s66 offen offset:0
    s_mov_b32 s66, 2048
    v_cvt_pk_bf16_f32 v32, v124, v125
    v_cvt_pk_bf16_f32 v33, v126, v127
    buffer_store_dwordx2 v[32:33], v5, s[48:51], s66 offen offset:0
    s_mov_b32 s66, 4096
    v_cvt_pk_bf16_f32 v40, v156, v157
    v_cvt_pk_bf16_f32 v41, v158, v159
    buffer_store_dwordx2 v[40:41], v5, s[48:51], s66 offen offset:0
    s_mov_b32 s66, 6144
    v_cvt_pk_bf16_f32 v48, v188, v189
    v_cvt_pk_bf16_f32 v49, v190, v191
    buffer_store_dwordx2 v[48:49], v5, s[48:51], s66 offen offset:0
    v_cmp_eq_u32 vcc, 16, v6
    s_and_saveexec_b64 s[68:69], vcc
    s_mov_b32 s66, 0
    buffer_store_dwordx2 v[20:21], v5, s[48:51], s66 offen offset:8
    buffer_store_dwordx4 v[20:23], v5, s[48:51], s66 offen offset:16
    s_mov_b32 s66, 2048
    buffer_store_dwordx2 v[20:21], v5, s[48:51], s66 offen offset:8
    buffer_store_dwordx4 v[20:23], v5, s[48:51], s66 offen offset:16
    s_mov_b32 s66, 4096
    buffer_store_dwordx2 v[20:21], v5, s[48:51], s66 offen offset:8
    buffer_store_dwordx4 v[20:23], v5, s[48:51], s66 offen offset:16
    s_mov_b32 s66, 6144
    buffer_store_dwordx2 v[20:21], v5, s[48:51], s66 offen offset:8
    buffer_store_dwordx4 v[20:23], v5, s[48:51], s66 offen offset:16
    s_mov_b64 exec, s[68:69]
    s_endpgm
job_7:
    s_mov_b32 s40, s16
    s_mov_b32 s41, s17
    s_and_b32 s41, s41, 0xffff
    s_mov_b32 s42, 2621440
    s_mov_b32 s43, 0x00020000
    s_mov_b32 s44, s18
    s_mov_b32 s45, s19
    s_and_b32 s45, s45, 0xffff
    s_mov_b32 s46, 2457600
    s_mov_b32 s47, 0x00020000
    v_and_b32 v1, 63, v0
    s_and_b32 s70, s57, 3
    s_lshr_b32 s58, s70, 1
    s_and_b32 s59, s70, 1
    s_mul_i32 s72, s71, 32768
    s_add_u32 s72, s72, 65536
    v_lshrrev_b32 v2, 2, v1
    v_bfe_u32 v3, v1, 4, 2
    v_and_b32 v4, 3, v1
    v_xor_b32 v4, v4, v3
    s_mul_i32 s60, s57, 32
    s_add_u32 s60, s60, s52
    v_add_u32 v2, s60, v2
    s_mov_b32 s61, 1280
    v_mul_lo_u32 v2, v2, s61
    v_lshl_add_u32 v2, v4, 4, v2
    v_add_u32 v8, 0, v2
    v_add_u32 v9, 19456, v2
    v_lshrrev_b32 v2, 4, v1
    v_and_b32 v3, 15, v1
    v_lshrrev_b32 v4, 2, v3
    v_bfe_u32 v5, v1, 4, 2
    v_xor_b32 v4, v4, v5
    v_and_b32 v3, 3, v3
    v_lshlrev_b32 v3, 4, v3
    v_lshl_add_u32 v3, v4, 6, v3
    s_mul_i32 s60, s70, 8
    v_add_u32 v2, s60, v2
    s_mov_b32 s61, 3840
    v_mul_lo_u32 v2, v2, s61
    v_add_u32 v2, v2, v3
    s_lshl_b32 s60, s53, 1
    v_add_u32 v2, s60, v2
    v_add_u32 v12, 0, v2
    v_add_u32 v13, 14336, v2
    v_and_b32 v2, 31, v1
    v_lshrrev_b32 v3, 5, v1
    v_bfe_u32 v4, v1, 2, 2
    v_xor_b32 v4, v4, v3
    s_mul_i32 s60, s58, 128
    v_add_u32 v2, s60, v2
    v_lshlrev_b32 v2, 6, v2
    v_lshl_add_u32 v16, v4, 4, v2
    v_xor_b32 v17, 32, v16
    v_bfe_u32 v2, v1, 2, 2
    v_lshrrev_b32 v3, 5, v1
    v_lshl_add_u32 v3, v3, 3, v2
    v_mul_u32_u24 v3, 256, v3
    v_mov_b32 v4, v2
    s_mul_i32 s60, s59, 2
    v_xor_b32 v4, s60, v4
    v_lshl_add_u32 v3, v4, 6, v3
    v_bfe_u32 v4, v1, 4, 1
    v_and_b32 v5, 3, v1
    v_lshlrev_b32 v5, 3, v5
    v_lshl_add_u32 v5, v4, 5, v5
    v_add_u32 v3, v3, v5
    v_add_u32 v18, s72, v3
    v_xor_b32 v19, 64, v18
    s_mul_i32 s62, s57, 2048
    s_mul_i32 s63, s70, 2048
    s_add_u32 s63, s63, s72
    s_mov_b32 s54, 0
    s_mov_b32 s55, 0
    v_mov_b32 v64, 0
    v_mov_b32 v65, 0
    v_mov_b32 v66, 0
    v_mov_b32 v67, 0
    v_mov_b32 v68, 0
    v_mov_b32 v69, 0
    v_mov_b32 v70, 0
    v_mov_b32 v71, 0
    v_mov_b32 v72, 0
    v_mov_b32 v73, 0
    v_mov_b32 v74, 0
    v_mov_b32 v75, 0
    v_mov_b32 v76, 0
    v_mov_b32 v77, 0
    v_mov_b32 v78, 0
    v_mov_b32 v79, 0
    v_mov_b32 v80, 0
    v_mov_b32 v81, 0
    v_mov_b32 v82, 0
    v_mov_b32 v83, 0
    v_mov_b32 v84, 0
    v_mov_b32 v85, 0
    v_mov_b32 v86, 0
    v_mov_b32 v87, 0
    v_mov_b32 v88, 0
    v_mov_b32 v89, 0
    v_mov_b32 v90, 0
    v_mov_b32 v91, 0
    v_mov_b32 v92, 0
    v_mov_b32 v93, 0
    v_mov_b32 v94, 0
    v_mov_b32 v95, 0
    v_mov_b32 v96, 0
    v_mov_b32 v97, 0
    v_mov_b32 v98, 0
    v_mov_b32 v99, 0
    v_mov_b32 v100, 0
    v_mov_b32 v101, 0
    v_mov_b32 v102, 0
    v_mov_b32 v103, 0
    v_mov_b32 v104, 0
    v_mov_b32 v105, 0
    v_mov_b32 v106, 0
    v_mov_b32 v107, 0
    v_mov_b32 v108, 0
    v_mov_b32 v109, 0
    v_mov_b32 v110, 0
    v_mov_b32 v111, 0
    v_mov_b32 v112, 0
    v_mov_b32 v113, 0
    v_mov_b32 v114, 0
    v_mov_b32 v115, 0
    v_mov_b32 v116, 0
    v_mov_b32 v117, 0
    v_mov_b32 v118, 0
    v_mov_b32 v119, 0
    v_mov_b32 v120, 0
    v_mov_b32 v121, 0
    v_mov_b32 v122, 0
    v_mov_b32 v123, 0
    v_mov_b32 v124, 0
    v_mov_b32 v125, 0
    v_mov_b32 v126, 0
    v_mov_b32 v127, 0
    v_mov_b32 v128, 0
    v_mov_b32 v129, 0
    v_mov_b32 v130, 0
    v_mov_b32 v131, 0
    v_mov_b32 v132, 0
    v_mov_b32 v133, 0
    v_mov_b32 v134, 0
    v_mov_b32 v135, 0
    v_mov_b32 v136, 0
    v_mov_b32 v137, 0
    v_mov_b32 v138, 0
    v_mov_b32 v139, 0
    v_mov_b32 v140, 0
    v_mov_b32 v141, 0
    v_mov_b32 v142, 0
    v_mov_b32 v143, 0
    v_mov_b32 v144, 0
    v_mov_b32 v145, 0
    v_mov_b32 v146, 0
    v_mov_b32 v147, 0
    v_mov_b32 v148, 0
    v_mov_b32 v149, 0
    v_mov_b32 v150, 0
    v_mov_b32 v151, 0
    v_mov_b32 v152, 0
    v_mov_b32 v153, 0
    v_mov_b32 v154, 0
    v_mov_b32 v155, 0
    v_mov_b32 v156, 0
    v_mov_b32 v157, 0
    v_mov_b32 v158, 0
    v_mov_b32 v159, 0
    v_mov_b32 v160, 0
    v_mov_b32 v161, 0
    v_mov_b32 v162, 0
    v_mov_b32 v163, 0
    v_mov_b32 v164, 0
    v_mov_b32 v165, 0
    v_mov_b32 v166, 0
    v_mov_b32 v167, 0
    v_mov_b32 v168, 0
    v_mov_b32 v169, 0
    v_mov_b32 v170, 0
    v_mov_b32 v171, 0
    v_mov_b32 v172, 0
    v_mov_b32 v173, 0
    v_mov_b32 v174, 0
    v_mov_b32 v175, 0
    v_mov_b32 v176, 0
    v_mov_b32 v177, 0
    v_mov_b32 v178, 0
    v_mov_b32 v179, 0
    v_mov_b32 v180, 0
    v_mov_b32 v181, 0
    v_mov_b32 v182, 0
    v_mov_b32 v183, 0
    v_mov_b32 v184, 0
    v_mov_b32 v185, 0
    v_mov_b32 v186, 0
    v_mov_b32 v187, 0
    v_mov_b32 v188, 0
    v_mov_b32 v189, 0
    v_mov_b32 v190, 0
    v_mov_b32 v191, 0
    s_add_u32 m0, s62, 0
    s_nop 0
    buffer_load_dwordx4 v8, s[40:43], s54 offen offset:0 lds
    buffer_load_dwordx4 v9, s[40:43], s54 offen offset:1024 lds
    s_add_u32 m0, s63, 0
    s_nop 0
    buffer_load_dwordx4 v12, s[44:47], s55 offen offset:0 lds
    buffer_load_dwordx4 v13, s[44:47], s55 offen offset:1024 lds
    buffer_load_dword v60, v61, s[76:79], 0 offen
    v_add_u32 v61, 524288, v61
    s_add_u32 s54, s54, 64
    s_add_u32 s55, s55, 122880
    s_add_u32 m0, s62, 16384
    s_nop 0
    buffer_load_dwordx4 v8, s[40:43], s54 offen offset:0 lds
    buffer_load_dwordx4 v9, s[40:43], s54 offen offset:1024 lds
    s_add_u32 m0, s63, 8192
    s_nop 0
    buffer_load_dwordx4 v12, s[44:47], s55 offen offset:0 lds
    buffer_load_dwordx4 v13, s[44:47], s55 offen offset:1024 lds
    buffer_load_dword v60, v61, s[76:79], 0 offen
    v_add_u32 v61, 524288, v61
    s_add_u32 s54, s54, 64
    s_add_u32 s55, s55, 122880
    s_add_u32 m0, s62, 32768
    s_nop 0
    buffer_load_dwordx4 v8, s[40:43], s54 offen offset:0 lds
    buffer_load_dwordx4 v9, s[40:43], s54 offen offset:1024 lds
    s_add_u32 m0, s63, 16384
    s_nop 0
    buffer_load_dwordx4 v12, s[44:47], s55 offen offset:0 lds
    buffer_load_dwordx4 v13, s[44:47], s55 offen offset:1024 lds
    buffer_load_dword v60, v61, s[76:79], 0 offen
    v_add_u32 v61, 524288, v61
    s_add_u32 s54, s54, 64
    s_add_u32 s55, s55, 122880
    s_mov_b32 s56, 20
    s_waitcnt vmcnt(11)
    s_barrier
    ds_read_b64_tr_b16 v[224:225], v18 offset:0
    ds_read_b64_tr_b16 v[226:227], v18 offset:1024
    ds_read_b128 v[192:195], v16 offset:0
    ds_read_b64_tr_b16 v[228:229], v19 offset:0
    ds_read_b64_tr_b16 v[230:231], v19 offset:1024
    ds_read_b128 v[196:199], v16 offset:2048
    ds_read_b128 v[200:203], v16 offset:4096
    ds_read_b128 v[204:207], v16 offset:6144
    s_waitcnt lgkmcnt(0)
gl_19:
    v_mfma_f32_32x32x16_bf16 v[64:79], v[192:195], v[224:227], v[64:79]
    ds_read_b64_tr_b16 v[232:233], v18 offset:4096
    ds_read_b64_tr_b16 v[234:235], v18 offset:5120
    v_mfma_f32_32x32x16_bf16 v[80:95], v[192:195], v[228:231], v[80:95]
    ds_read_b128 v[208:211], v17 offset:0
    v_mfma_f32_32x32x16_bf16 v[96:111], v[196:199], v[224:227], v[96:111]
    ds_read_b64_tr_b16 v[236:237], v19 offset:4096
    ds_read_b64_tr_b16 v[238:239], v19 offset:5120
    v_mfma_f32_32x32x16_bf16 v[112:127], v[196:199], v[228:231], v[112:127]
    ds_read_b128 v[212:215], v17 offset:2048
    v_mfma_f32_32x32x16_bf16 v[128:143], v[200:203], v[224:227], v[128:143]
    ds_read_b128 v[216:219], v17 offset:4096
    v_mfma_f32_32x32x16_bf16 v[144:159], v[200:203], v[228:231], v[144:159]
    ds_read_b128 v[220:223], v17 offset:6144
    v_mfma_f32_32x32x16_bf16 v[160:175], v[204:207], v[224:227], v[160:175]
    v_mfma_f32_32x32x16_bf16 v[176:191], v[204:207], v[228:231], v[176:191]
    s_waitcnt vmcnt(6)
    s_barrier
    s_cmp_le_u32 s56, 3
    s_cselect_b32 s42, 0, s42
    s_cselect_b32 s46, 0, s46
    s_add_u32 m0, s62, 49152
    s_nop 0
    buffer_load_dwordx4 v8, s[40:43], s54 offen offset:0 lds
    buffer_load_dwordx4 v9, s[40:43], s54 offen offset:1024 lds
    s_add_u32 m0, s63, 24576
    s_nop 0
    buffer_load_dwordx4 v12, s[44:47], s55 offen offset:0 lds
    buffer_load_dwordx4 v13, s[44:47], s55 offen offset:1024 lds
    buffer_load_dword v60, v61, s[76:79], 0 offen
    v_add_u32 v61, 524288, v61
    s_add_u32 s54, s54, 64
    s_add_u32 s55, s55, 122880
    s_waitcnt lgkmcnt(5)
    v_mfma_f32_32x32x16_bf16 v[64:79], v[208:211], v[232:235], v[64:79]
    ds_read_b64_tr_b16 v[224:225], v18 offset:8192
    ds_read_b64_tr_b16 v[226:227], v18 offset:9216
    s_waitcnt lgkmcnt(5)
    v_mfma_f32_32x32x16_bf16 v[80:95], v[208:211], v[236:239], v[80:95]
    ds_read_b128 v[192:195], v16 offset:16384
    s_waitcnt lgkmcnt(5)
    v_mfma_f32_32x32x16_bf16 v[96:111], v[212:215], v[232:235], v[96:111]
    ds_read_b64_tr_b16 v[228:229], v19 offset:8192
    ds_read_b64_tr_b16 v[230:231], v19 offset:9216
    v_mfma_f32_32x32x16_bf16 v[112:127], v[212:215], v[236:239], v[112:127]
    ds_read_b128 v[196:199], v16 offset:18432
    s_waitcnt lgkmcnt(7)
    v_mfma_f32_32x32x16_bf16 v[128:143], v[216:219], v[232:235], v[128:143]
    ds_read_b128 v[200:203], v16 offset:20480
    v_mfma_f32_32x32x16_bf16 v[144:159], v[216:219], v[236:239], v[144:159]
    ds_read_b128 v[204:207], v16 offset:22528
    s_waitcnt lgkmcnt(8)
    v_mfma_f32_32x32x16_bf16 v[160:175], v[220:223], v[232:235], v[160:175]
    v_mfma_f32_32x32x16_bf16 v[176:191], v[220:223], v[236:239], v[176:191]
    s_sub_u32 s56, s56, 1
    s_waitcnt lgkmcnt(5)
    v_mfma_f32_32x32x16_bf16 v[64:79], v[192:195], v[224:227], v[64:79]
    ds_read_b64_tr_b16 v[232:233], v18 offset:12288
    ds_read_b64_tr_b16 v[234:235], v18 offset:13312
    s_waitcnt lgkmcnt(5)
    v_mfma_f32_32x32x16_bf16 v[80:95], v[192:195], v[228:231], v[80:95]
    ds_read_b128 v[208:211], v17 offset:16384
    s_waitcnt lgkmcnt(5)
    v_mfma_f32_32x32x16_bf16 v[96:111], v[196:199], v[224:227], v[96:111]
    ds_read_b64_tr_b16 v[236:237], v19 offset:12288
    ds_read_b64_tr_b16 v[238:239], v19 offset:13312
    v_mfma_f32_32x32x16_bf16 v[112:127], v[196:199], v[228:231], v[112:127]
    ds_read_b128 v[212:215], v17 offset:18432
    s_waitcnt lgkmcnt(7)
    v_mfma_f32_32x32x16_bf16 v[128:143], v[200:203], v[224:227], v[128:143]
    ds_read_b128 v[216:219], v17 offset:20480
    v_mfma_f32_32x32x16_bf16 v[144:159], v[200:203], v[228:231], v[144:159]
    ds_read_b128 v[220:223], v17 offset:22528
    s_waitcnt lgkmcnt(8)
    v_mfma_f32_32x32x16_bf16 v[160:175], v[204:207], v[224:227], v[160:175]
    v_mfma_f32_32x32x16_bf16 v[176:191], v[204:207], v[228:231], v[176:191]
    s_waitcnt vmcnt(6)
    s_barrier
    s_cmp_le_u32 s56, 3
    s_cselect_b32 s42, 0, s42
    s_cselect_b32 s46, 0, s46
    s_add_u32 m0, s62, 0
    s_nop 0
    buffer_load_dwordx4 v8, s[40:43], s54 offen offset:0 lds
    buffer_load_dwordx4 v9, s[40:43], s54 offen offset:1024 lds
    s_add_u32 m0, s63, 0
    s_nop 0
    buffer_load_dwordx4 v12, s[44:47], s55 offen offset:0 lds
    buffer_load_dwordx4 v13, s[44:47], s55 offen offset:1024 lds
    buffer_load_dword v60, v61, s[76:79], 0 offen
    v_add_u32 v61, 524288, v61
    s_add_u32 s54, s54, 64
    s_add_u32 s55, s55, 122880
    s_waitcnt lgkmcnt(5)
    v_mfma_f32_32x32x16_bf16 v[64:79], v[208:211], v[232:235], v[64:79]
    ds_read_b64_tr_b16 v[224:225], v18 offset:16384
    ds_read_b64_tr_b16 v[226:227], v18 offset:17408
    s_waitcnt lgkmcnt(5)
    v_mfma_f32_32x32x16_bf16 v[80:95], v[208:211], v[236:239], v[80:95]
    ds_read_b128 v[192:195], v16 offset:32768
    s_waitcnt lgkmcnt(5)
    v_mfma_f32_32x32x16_bf16 v[96:111], v[212:215], v[232:235], v[96:111]
    ds_read_b64_tr_b16 v[228:229], v19 offset:16384
    ds_read_b64_tr_b16 v[230:231], v19 offset:17408
    v_mfma_f32_32x32x16_bf16 v[112:127], v[212:215], v[236:239], v[112:127]
    ds_read_b128 v[196:199], v16 offset:34816
    s_waitcnt lgkmcnt(7)
    v_mfma_f32_32x32x16_bf16 v[128:143], v[216:219], v[232:235], v[128:143]
    ds_read_b128 v[200:203], v16 offset:36864
    v_mfma_f32_32x32x16_bf16 v[144:159], v[216:219], v[236:239], v[144:159]
    ds_read_b128 v[204:207], v16 offset:38912
    s_waitcnt lgkmcnt(8)
    v_mfma_f32_32x32x16_bf16 v[160:175], v[220:223], v[232:235], v[160:175]
    v_mfma_f32_32x32x16_bf16 v[176:191], v[220:223], v[236:239], v[176:191]
    s_sub_u32 s56, s56, 1
    s_waitcnt lgkmcnt(5)
    v_mfma_f32_32x32x16_bf16 v[64:79], v[192:195], v[224:227], v[64:79]
    ds_read_b64_tr_b16 v[232:233], v18 offset:20480
    ds_read_b64_tr_b16 v[234:235], v18 offset:21504
    s_waitcnt lgkmcnt(5)
    v_mfma_f32_32x32x16_bf16 v[80:95], v[192:195], v[228:231], v[80:95]
    ds_read_b128 v[208:211], v17 offset:32768
    s_waitcnt lgkmcnt(5)
    v_mfma_f32_32x32x16_bf16 v[96:111], v[196:199], v[224:227], v[96:111]
    ds_read_b64_tr_b16 v[236:237], v19 offset:20480
    ds_read_b64_tr_b16 v[238:239], v19 offset:21504
    v_mfma_f32_32x32x16_bf16 v[112:127], v[196:199], v[228:231], v[112:127]
    ds_read_b128 v[212:215], v17 offset:34816
    s_waitcnt lgkmcnt(7)
    v_mfma_f32_32x32x16_bf16 v[128:143], v[200:203], v[224:227], v[128:143]
    ds_read_b128 v[216:219], v17 offset:36864
    v_mfma_f32_32x32x16_bf16 v[144:159], v[200:203], v[228:231], v[144:159]
    ds_read_b128 v[220:223], v17 offset:38912
    s_waitcnt lgkmcnt(8)
    v_mfma_f32_32x32x16_bf16 v[160:175], v[204:207], v[224:227], v[160:175]
    v_mfma_f32_32x32x16_bf16 v[176:191], v[204:207], v[228:231], v[176:191]
    s_waitcnt vmcnt(6)
    s_barrier
    s_cmp_le_u32 s56, 3
    s_cselect_b32 s42, 0, s42
    s_cselect_b32 s46, 0, s46
    s_add_u32 m0, s62, 16384
    s_nop 0
    buffer_load_dwordx4 v8, s[40:43], s54 offen offset:0 lds
    buffer_load_dwordx4 v9, s[40:43], s54 offen offset:1024 lds
    s_add_u32 m0, s63, 8192
    s_nop 0
    buffer_load_dwordx4 v12, s[44:47], s55 offen offset:0 lds
    buffer_load_dwordx4 v13, s[44:47], s55 offen offset:1024 lds
    buffer_load_dword v60, v61, s[76:79], 0 offen
    v_add_u32 v61, 524288, v61
    s_add_u32 s54, s54, 64
    s_add_u32 s55, s55, 122880
    s_waitcnt lgkmcnt(5)
    v_mfma_f32_32x32x16_bf16 v[64:79], v[208:211], v[232:235], v[64:79]
    ds_read_b64_tr_b16 v[224:225], v18 offset:24576
    ds_read_b64_tr_b16 v[226:227], v18 offset:25600
    s_waitcnt lgkmcnt(5)
    v_mfma_f32_32x32x16_bf16 v[80:95], v[208:211], v[236:239], v[80:95]
    ds_read_b128 v[192:195], v16 offset:49152
    s_waitcnt lgkmcnt(5)
    v_mfma_f32_32x32x16_bf16 v[96:111], v[212:215], v[232:235], v[96:111]
    ds_read_b64_tr_b16 v[228:229], v19 offset:24576
    ds_read_b64_tr_b16 v[230:231], v19 offset:25600
    v_mfma_f32_32x32x16_bf16 v[112:127], v[212:215], v[236:239], v[112:127]
    ds_read_b128 v[196:199], v16 offset:51200
    s_waitcnt lgkmcnt(7)
    v_mfma_f32_32x32x16_bf16 v[128:143], v[216:219], v[232:235], v[128:143]
    ds_read_b128 v[200:203], v16 offset:53248
    v_mfma_f32_32x32x16_bf16 v[144:159], v[216:219], v[236:239], v[144:159]
    ds_read_b128 v[204:207], v16 offset:55296
    s_waitcnt lgkmcnt(8)
    v_mfma_f32_32x32x16_bf16 v[160:175], v[220:223], v[232:235], v[160:175]
    v_mfma_f32_32x32x16_bf16 v[176:191], v[220:223], v[236:239], v[176:191]
    s_sub_u32 s56, s56, 1
    s_waitcnt lgkmcnt(5)
    v_mfma_f32_32x32x16_bf16 v[64:79], v[192:195], v[224:227], v[64:79]
    ds_read_b64_tr_b16 v[232:233], v18 offset:28672
    ds_read_b64_tr_b16 v[234:235], v18 offset:29696
    s_waitcnt lgkmcnt(5)
    v_mfma_f32_32x32x16_bf16 v[80:95], v[192:195], v[228:231], v[80:95]
    ds_read_b128 v[208:211], v17 offset:49152
    s_waitcnt lgkmcnt(5)
    v_mfma_f32_32x32x16_bf16 v[96:111], v[196:199], v[224:227], v[96:111]
    ds_read_b64_tr_b16 v[236:237], v19 offset:28672
    ds_read_b64_tr_b16 v[238:239], v19 offset:29696
    v_mfma_f32_32x32x16_bf16 v[112:127], v[196:199], v[228:231], v[112:127]
    ds_read_b128 v[212:215], v17 offset:51200
    s_waitcnt lgkmcnt(7)
    v_mfma_f32_32x32x16_bf16 v[128:143], v[200:203], v[224:227], v[128:143]
    ds_read_b128 v[216:219], v17 offset:53248
    v_mfma_f32_32x32x16_bf16 v[144:159], v[200:203], v[228:231], v[144:159]
    ds_read_b128 v[220:223], v17 offset:55296
    s_waitcnt lgkmcnt(8)
    v_mfma_f32_32x32x16_bf16 v[160:175], v[204:207], v[224:227], v[160:175]
    v_mfma_f32_32x32x16_bf16 v[176:191], v[204:207], v[228:231], v[176:191]
    s_waitcnt vmcnt(6)
    s_barrier
    s_cmp_le_u32 s56, 3
    s_cselect_b32 s42, 0, s42
    s_cselect_b32 s46, 0, s46
    s_add_u32 m0, s62, 32768
    s_nop 0
    buffer_load_dwordx4 v8, s[40:43], s54 offen offset:0 lds
    buffer_load_dwordx4 v9, s[40:43], s54 offen offset:1024 lds
    s_add_u32 m0, s63, 16384
    s_nop 0
    buffer_load_dwordx4 v12, s[44:47], s55 offen offset:0 lds
    buffer_load_dwordx4 v13, s[44:47], s55 offen offset:1024 lds
    buffer_load_dword v60, v61, s[76:79], 0 offen
    v_add_u32 v61, 524288, v61
    s_add_u32 s54, s54, 64
    s_add_u32 s55, s55, 122880
    s_waitcnt lgkmcnt(5)
    v_mfma_f32_32x32x16_bf16 v[64:79], v[208:211], v[232:235], v[64:79]
    ds_read_b64_tr_b16 v[224:225], v18 offset:0
    ds_read_b64_tr_b16 v[226:227], v18 offset:1024
    s_waitcnt lgkmcnt(5)
    v_mfma_f32_32x32x16_bf16 v[80:95], v[208:211], v[236:239], v[80:95]
    ds_read_b128 v[192:195], v16 offset:0
    s_waitcnt lgkmcnt(5)
    v_mfma_f32_32x32x16_bf16 v[96:111], v[212:215], v[232:235], v[96:111]
    ds_read_b64_tr_b16 v[228:229], v19 offset:0
    ds_read_b64_tr_b16 v[230:231], v19 offset:1024
    v_mfma_f32_32x32x16_bf16 v[112:127], v[212:215], v[236:239], v[112:127]
    ds_read_b128 v[196:199], v16 offset:2048
    s_waitcnt lgkmcnt(7)
    v_mfma_f32_32x32x16_bf16 v[128:143], v[216:219], v[232:235], v[128:143]
    ds_read_b128 v[200:203], v16 offset:4096
    v_mfma_f32_32x32x16_bf16 v[144:159], v[216:219], v[236:239], v[144:159]
    ds_read_b128 v[204:207], v16 offset:6144
    s_waitcnt lgkmcnt(8)
    v_mfma_f32_32x32x16_bf16 v[160:175], v[220:223], v[232:235], v[160:175]
    v_mfma_f32_32x32x16_bf16 v[176:191], v[220:223], v[236:239], v[176:191]
    s_sub_u32 s56, s56, 1
    s_cmp_eq_u32 s56, 0
    s_waitcnt lgkmcnt(0)
    s_nop 8
    s_cbranch_scc1 gd_20
    s_branch gl_19
gd_20:
    s_waitcnt vmcnt(0) lgkmcnt(0)
    s_add_u32 s48, s38, 8388608
    s_addc_u32 s49, s39, 0
    s_and_b32 s49, s49, 0xffff
    s_mov_b32 s50, 4194304
    s_mov_b32 s51, 0x00020000
    s_barrier
    s_mul_i32 s60, s57, 16384
    v_and_b32 v2, 31, v1
    v_lshlrev_b32 v2, 8, v2
    v_add_u32 v2, s60, v2
    v_and_b32 v3, 15, v1
    v_lshrrev_b32 v4, 5, v1
    v_xor_b32 v3, v3, v4
    v_xor_b32 v4, 0, v3
    v_lshl_add_u32 v8, v4, 4, v2
    v_xor_b32 v4, 2, v3
    v_lshl_add_u32 v9, v4, 4, v2
    v_xor_b32 v4, 4, v3
    v_lshl_add_u32 v10, v4, 4, v2
    v_xor_b32 v4, 6, v3
    v_lshl_add_u32 v11, v4, 4, v2
    v_xor_b32 v4, 8, v3
    v_lshl_add_u32 v12, v4, 4, v2
    v_xor_b32 v4, 10, v3
    v_lshl_add_u32 v13, v4, 4, v2
    v_xor_b32 v4, 12, v3
    v_lshl_add_u32 v14, v4, 4, v2
    v_xor_b32 v4, 14, v3
    v_lshl_add_u32 v15, v4, 4, v2
    v_cvt_pk_bf16_f32 v24, v64, v65
    v_cvt_pk_bf16_f32 v25, v66, v67
    ds_write_b64 v8, v[24:25] offset:0
    v_cvt_pk_bf16_f32 v32, v68, v69
    v_cvt_pk_bf16_f32 v33, v70, v71
    ds_write_b64 v8, v[32:33] offset:8
    v_cvt_pk_bf16_f32 v40, v72, v73
    v_cvt_pk_bf16_f32 v41, v74, v75
    ds_write_b64 v9, v[40:41] offset:0
    v_cvt_pk_bf16_f32 v48, v76, v77
    v_cvt_pk_bf16_f32 v49, v78, v79
    ds_write_b64 v9, v[48:49] offset:8
    s_waitcnt lgkmcnt(0)
    v_cvt_pk_bf16_f32 v24, v96, v97
    v_cvt_pk_bf16_f32 v25, v98, v99
    ds_write_b64 v10, v[24:25] offset:0
    v_cvt_pk_bf16_f32 v32, v100, v101
    v_cvt_pk_bf16_f32 v33, v102, v103
    ds_write_b64 v10, v[32:33] offset:8
    v_cvt_pk_bf16_f32 v40, v104, v105
    v_cvt_pk_bf16_f32 v41, v106, v107
    ds_write_b64 v11, v[40:41] offset:0
    v_cvt_pk_bf16_f32 v48, v108, v109
    v_cvt_pk_bf16_f32 v49, v110, v111
    ds_write_b64 v11, v[48:49] offset:8
    s_waitcnt lgkmcnt(0)
    v_cvt_pk_bf16_f32 v24, v128, v129
    v_cvt_pk_bf16_f32 v25, v130, v131
    ds_write_b64 v12, v[24:25] offset:0
    v_cvt_pk_bf16_f32 v32, v132, v133
    v_cvt_pk_bf16_f32 v33, v134, v135
    ds_write_b64 v12, v[32:33] offset:8
    v_cvt_pk_bf16_f32 v40, v136, v137
    v_cvt_pk_bf16_f32 v41, v138, v139
    ds_write_b64 v13, v[40:41] offset:0
    v_cvt_pk_bf16_f32 v48, v140, v141
    v_cvt_pk_bf16_f32 v49, v142, v143
    ds_write_b64 v13, v[48:49] offset:8
    s_waitcnt lgkmcnt(0)
    v_cvt_pk_bf16_f32 v24, v160, v161
    v_cvt_pk_bf16_f32 v25, v162, v163
    ds_write_b64 v14, v[24:25] offset:0
    v_cvt_pk_bf16_f32 v32, v164, v165
    v_cvt_pk_bf16_f32 v33, v166, v167
    ds_write_b64 v14, v[32:33] offset:8
    v_cvt_pk_bf16_f32 v40, v168, v169
    v_cvt_pk_bf16_f32 v41, v170, v171
    ds_write_b64 v15, v[40:41] offset:0
    v_cvt_pk_bf16_f32 v48, v172, v173
    v_cvt_pk_bf16_f32 v49, v174, v175
    ds_write_b64 v15, v[48:49] offset:8
    s_waitcnt lgkmcnt(0)
    v_cvt_pk_bf16_f32 v24, v80, v81
    v_cvt_pk_bf16_f32 v25, v82, v83
    ds_write_b64 v8, v[24:25] offset:8192
    v_cvt_pk_bf16_f32 v32, v84, v85
    v_cvt_pk_bf16_f32 v33, v86, v87
    ds_write_b64 v8, v[32:33] offset:8200
    v_cvt_pk_bf16_f32 v40, v88, v89
    v_cvt_pk_bf16_f32 v41, v90, v91
    ds_write_b64 v9, v[40:41] offset:8192
    v_cvt_pk_bf16_f32 v48, v92, v93
    v_cvt_pk_bf16_f32 v49, v94, v95
    ds_write_b64 v9, v[48:49] offset:8200
    s_waitcnt lgkmcnt(0)
    v_cvt_pk_bf16_f32 v24, v112, v113
    v_cvt_pk_bf16_f32 v25, v114, v115
    ds_write_b64 v10, v[24:25] offset:8192
    v_cvt_pk_bf16_f32 v32, v116, v117
    v_cvt_pk_bf16_f32 v33, v118, v119
    ds_write_b64 v10, v[32:33] offset:8200
    v_cvt_pk_bf16_f32 v40, v120, v121
    v_cvt_pk_bf16_f32 v41, v122, v123
    ds_write_b64 v11, v[40:41] offset:8192
    v_cvt_pk_bf16_f32 v48, v124, v125
    v_cvt_pk_bf16_f32 v49, v126, v127
    ds_write_b64 v11, v[48:49] offset:8200
    s_waitcnt lgkmcnt(0)
    v_cvt_pk_bf16_f32 v24, v144, v145
    v_cvt_pk_bf16_f32 v25, v146, v147
    ds_write_b64 v12, v[24:25] offset:8192
    v_cvt_pk_bf16_f32 v32, v148, v149
    v_cvt_pk_bf16_f32 v33, v150, v151
    ds_write_b64 v12, v[32:33] offset:8200
    v_cvt_pk_bf16_f32 v40, v152, v153
    v_cvt_pk_bf16_f32 v41, v154, v155
    ds_write_b64 v13, v[40:41] offset:8192
    v_cvt_pk_bf16_f32 v48, v156, v157
    v_cvt_pk_bf16_f32 v49, v158, v159
    ds_write_b64 v13, v[48:49] offset:8200
    s_waitcnt lgkmcnt(0)
    v_cvt_pk_bf16_f32 v24, v176, v177
    v_cvt_pk_bf16_f32 v25, v178, v179
    ds_write_b64 v14, v[24:25] offset:8192
    v_cvt_pk_bf16_f32 v32, v180, v181
    v_cvt_pk_bf16_f32 v33, v182, v183
    ds_write_b64 v14, v[32:33] offset:8200
    v_cvt_pk_bf16_f32 v40, v184, v185
    v_cvt_pk_bf16_f32 v41, v186, v187
    ds_write_b64 v15, v[40:41] offset:8192
    v_cvt_pk_bf16_f32 v48, v188, v189
    v_cvt_pk_bf16_f32 v49, v190, v191
    ds_write_b64 v15, v[48:49] offset:8200
    s_waitcnt lgkmcnt(0)
    v_lshrrev_b32 v2, 4, v1
    v_and_b32 v3, 15, v1
    v_lshlrev_b32 v5, 8, v2
    v_add_u32 v5, s60, v5
    v_add_u32 v4, 0, v2
    v_xor_b32 v4, v4, v3
    v_lshl_add_u32 v8, v4, 4, v5
    v_add_u32 v4, 4, v2
    v_xor_b32 v4, v4, v3
    v_lshl_add_u32 v9, v4, 4, v5
    v_add_u32 v4, 8, v2
    v_xor_b32 v4, v4, v3
    v_lshl_add_u32 v10, v4, 4, v5
    v_add_u32 v4, 12, v2
    v_xor_b32 v4, v4, v3
    v_lshl_add_u32 v11, v4, 4, v5
    s_mul_i32 s60, s58, 128
    s_add_u32 s60, s60, s52
    s_lshl_b32 s60, s60, 1
    v_lshl_add_u32 v3, v3, 4, s60
    s_mul_i32 s60, s59, 64
    s_add_u32 s60, s60, s53
    s_sub_u32 s60, s60, 1280
    v_add_u32 v2, s60, v2
    v_mov_b32 v20, 0x3f803f80
    v_mov_b32 v21, 0x3f803f80
    v_mov_b32 v22, 0x3f803f80
    v_mov_b32 v23, 0x3f803f80
    s_mov_b32 s66, 81920
    ds_read_b128 v[192:195], v8 offset:0
    ds_read_b128 v[196:199], v9 offset:1024
    ds_read_b128 v[200:203], v10 offset:2048
    ds_read_b128 v[204:207], v11 offset:3072
    ds_read_b128 v[208:211], v8 offset:4096
    ds_read_b128 v[212:215], v9 offset:5120
    ds_read_b128 v[216:219], v10 offset:6144
    ds_read_b128 v[220:223], v11 offset:7168
    v_add_u32 v4, 0, v2
    v_mul_u32_u24 v5, 0xcccd, v4
    v_lshrrev_b32 v5, 20, v5
    v_mul_u32_u24 v6, 20, v5
    v_sub_u32 v6, v4, v6
    v_lshl_add_u32 v4, v5, 5, v6
    v_lshl_add_u32 v12, v4, 12, v3
    s_waitcnt lgkmcnt(7)
    buffer_store_dwordx4 v[192:195], v12, s[48:51], 0 offen
    v_cmp_eq_u32 vcc, 0, v6
    s_and_saveexec_b64 s[68:69], vcc
    buffer_store_dwordx4 v[20:23], v12, s[48:51], s66 offen
    s_mov_b64 exec, s[68:69]
    ds_read_b128 v[192:195], v8 offset:8192
    v_add_u32 v4, 4, v2
    v_mul_u32_u24 v5, 0xcccd, v4
    v_lshrrev_b32 v5, 20, v5
    v_mul_u32_u24 v6, 20, v5
    v_sub_u32 v6, v4, v6
    v_lshl_add_u32 v4, v5, 5, v6
    v_lshl_add_u32 v13, v4, 12, v3
    s_waitcnt lgkmcnt(7)
    buffer_store_dwordx4 v[196:199], v13, s[48:51], 0 offen
    v_cmp_eq_u32 vcc, 0, v6
    s_and_saveexec_b64 s[68:69], vcc
    buffer_store_dwordx4 v[20:23], v13, s[48:51], s66 offen
    s_mov_b64 exec, s[68:69]
    ds_read_b128 v[196:199], v9 offset:9216
    v_add_u32 v4, 8, v2
    v_mul_u32_u24 v5, 0xcccd, v4
    v_lshrrev_b32 v5, 20, v5
    v_mul_u32_u24 v6, 20, v5
    v_sub_u32 v6, v4, v6
    v_lshl_add_u32 v4, v5, 5, v6
    v_lshl_add_u32 v14, v4, 12, v3
    s_waitcnt lgkmcnt(7)
    buffer_store_dwordx4 v[200:203], v14, s[48:51], 0 offen
    v_cmp_eq_u32 vcc, 0, v6
    s_and_saveexec_b64 s[68:69], vcc
    buffer_store_dwordx4 v[20:23], v14, s[48:51], s66 offen
    s_mov_b64 exec, s[68:69]
    ds_read_b128 v[200:203], v10 offset:10240
    v_add_u32 v4, 12, v2
    v_mul_u32_u24 v5, 0xcccd, v4
    v_lshrrev_b32 v5, 20, v5
    v_mul_u32_u24 v6, 20, v5
    v_sub_u32 v6, v4, v6
    v_lshl_add_u32 v4, v5, 5, v6
    v_lshl_add_u32 v15, v4, 12, v3
    s_waitcnt lgkmcnt(7)
    buffer_store_dwordx4 v[204:207], v15, s[48:51], 0 offen
    v_cmp_eq_u32 vcc, 0, v6
    s_and_saveexec_b64 s[68:69], vcc
    buffer_store_dwordx4 v[20:23], v15, s[48:51], s66 offen
    s_mov_b64 exec, s[68:69]
    ds_read_b128 v[204:207], v11 offset:11264
    v_add_u32 v4, 16, v2
    v_mul_u32_u24 v5, 0xcccd, v4
    v_lshrrev_b32 v5, 20, v5
    v_mul_u32_u24 v6, 20, v5
    v_sub_u32 v6, v4, v6
    v_lshl_add_u32 v4, v5, 5, v6
    v_lshl_add_u32 v12, v4, 12, v3
    s_waitcnt lgkmcnt(7)
    buffer_store_dwordx4 v[208:211], v12, s[48:51], 0 offen
    v_cmp_eq_u32 vcc, 0, v6
    s_and_saveexec_b64 s[68:69], vcc
    buffer_store_dwordx4 v[20:23], v12, s[48:51], s66 offen
    s_mov_b64 exec, s[68:69]
    ds_read_b128 v[208:211], v8 offset:12288
    v_add_u32 v4, 20, v2
    v_mul_u32_u24 v5, 0xcccd, v4
    v_lshrrev_b32 v5, 20, v5
    v_mul_u32_u24 v6, 20, v5
    v_sub_u32 v6, v4, v6
    v_lshl_add_u32 v4, v5, 5, v6
    v_lshl_add_u32 v13, v4, 12, v3
    s_waitcnt lgkmcnt(7)
    buffer_store_dwordx4 v[212:215], v13, s[48:51], 0 offen
    v_cmp_eq_u32 vcc, 0, v6
    s_and_saveexec_b64 s[68:69], vcc
    buffer_store_dwordx4 v[20:23], v13, s[48:51], s66 offen
    s_mov_b64 exec, s[68:69]
    ds_read_b128 v[212:215], v9 offset:13312
    v_add_u32 v4, 24, v2
    v_mul_u32_u24 v5, 0xcccd, v4
    v_lshrrev_b32 v5, 20, v5
    v_mul_u32_u24 v6, 20, v5
    v_sub_u32 v6, v4, v6
    v_lshl_add_u32 v4, v5, 5, v6
    v_lshl_add_u32 v14, v4, 12, v3
    s_waitcnt lgkmcnt(7)
    buffer_store_dwordx4 v[216:219], v14, s[48:51], 0 offen
    v_cmp_eq_u32 vcc, 0, v6
    s_and_saveexec_b64 s[68:69], vcc
    buffer_store_dwordx4 v[20:23], v14, s[48:51], s66 offen
    s_mov_b64 exec, s[68:69]
    ds_read_b128 v[216:219], v10 offset:14336
    v_add_u32 v4, 28, v2
    v_mul_u32_u24 v5, 0xcccd, v4
    v_lshrrev_b32 v5, 20, v5
    v_mul_u32_u24 v6, 20, v5
    v_sub_u32 v6, v4, v6
    v_lshl_add_u32 v4, v5, 5, v6
    v_lshl_add_u32 v15, v4, 12, v3
    s_waitcnt lgkmcnt(7)
    buffer_store_dwordx4 v[220:223], v15, s[48:51], 0 offen
    v_cmp_eq_u32 vcc, 0, v6
    s_and_saveexec_b64 s[68:69], vcc
    buffer_store_dwordx4 v[20:23], v15, s[48:51], s66 offen
    s_mov_b64 exec, s[68:69]
    ds_read_b128 v[220:223], v11 offset:15360
    v_add_u32 v4, 32, v2
    v_mul_u32_u24 v5, 0xcccd, v4
    v_lshrrev_b32 v5, 20, v5
    v_mul_u32_u24 v6, 20, v5
    v_sub_u32 v6, v4, v6
    v_lshl_add_u32 v4, v5, 5, v6
    v_lshl_add_u32 v12, v4, 12, v3
    s_waitcnt lgkmcnt(7)
    buffer_store_dwordx4 v[192:195], v12, s[48:51], 0 offen
    v_cmp_eq_u32 vcc, 0, v6
    s_and_saveexec_b64 s[68:69], vcc
    buffer_store_dwordx4 v[20:23], v12, s[48:51], s66 offen
    s_mov_b64 exec, s[68:69]
    v_add_u32 v4, 36, v2
    v_mul_u32_u24 v5, 0xcccd, v4
    v_lshrrev_b32 v5, 20, v5
    v_mul_u32_u24 v6, 20, v5
    v_sub_u32 v6, v4, v6
    v_lshl_add_u32 v4, v5, 5, v6
    v_lshl_add_u32 v13, v4, 12, v3
    s_waitcnt lgkmcnt(6)
    buffer_store_dwordx4 v[196:199], v13, s[48:51], 0 offen
    v_cmp_eq_u32 vcc, 0, v6
    s_and_saveexec_b64 s[68:69], vcc
    buffer_store_dwordx4 v[20:23], v13, s[48:51], s66 offen
    s_mov_b64 exec, s[68:69]
    v_add_u32 v4, 40, v2
    v_mul_u32_u24 v5, 0xcccd, v4
    v_lshrrev_b32 v5, 20, v5
    v_mul_u32_u24 v6, 20, v5
    v_sub_u32 v6, v4, v6
    v_lshl_add_u32 v4, v5, 5, v6
    v_lshl_add_u32 v14, v4, 12, v3
    s_waitcnt lgkmcnt(5)
    buffer_store_dwordx4 v[200:203], v14, s[48:51], 0 offen
    v_cmp_eq_u32 vcc, 0, v6
    s_and_saveexec_b64 s[68:69], vcc
    buffer_store_dwordx4 v[20:23], v14, s[48:51], s66 offen
    s_mov_b64 exec, s[68:69]
    v_add_u32 v4, 44, v2
    v_mul_u32_u24 v5, 0xcccd, v4
    v_lshrrev_b32 v5, 20, v5
    v_mul_u32_u24 v6, 20, v5
    v_sub_u32 v6, v4, v6
    v_lshl_add_u32 v4, v5, 5, v6
    v_lshl_add_u32 v15, v4, 12, v3
    s_waitcnt lgkmcnt(4)
    buffer_store_dwordx4 v[204:207], v15, s[48:51], 0 offen
    v_cmp_eq_u32 vcc, 0, v6
    s_and_saveexec_b64 s[68:69], vcc
    buffer_store_dwordx4 v[20:23], v15, s[48:51], s66 offen
    s_mov_b64 exec, s[68:69]
    v_add_u32 v4, 48, v2
    v_mul_u32_u24 v5, 0xcccd, v4
    v_lshrrev_b32 v5, 20, v5
    v_mul_u32_u24 v6, 20, v5
    v_sub_u32 v6, v4, v6
    v_lshl_add_u32 v4, v5, 5, v6
    v_lshl_add_u32 v12, v4, 12, v3
    s_waitcnt lgkmcnt(3)
    buffer_store_dwordx4 v[208:211], v12, s[48:51], 0 offen
    v_cmp_eq_u32 vcc, 0, v6
    s_and_saveexec_b64 s[68:69], vcc
    buffer_store_dwordx4 v[20:23], v12, s[48:51], s66 offen
    s_mov_b64 exec, s[68:69]
    v_add_u32 v4, 52, v2
    v_mul_u32_u24 v5, 0xcccd, v4
    v_lshrrev_b32 v5, 20, v5
    v_mul_u32_u24 v6, 20, v5
    v_sub_u32 v6, v4, v6
    v_lshl_add_u32 v4, v5, 5, v6
    v_lshl_add_u32 v13, v4, 12, v3
    s_waitcnt lgkmcnt(2)
    buffer_store_dwordx4 v[212:215], v13, s[48:51], 0 offen
    v_cmp_eq_u32 vcc, 0, v6
    s_and_saveexec_b64 s[68:69], vcc
    buffer_store_dwordx4 v[20:23], v13, s[48:51], s66 offen
    s_mov_b64 exec, s[68:69]
    v_add_u32 v4, 56, v2
    v_mul_u32_u24 v5, 0xcccd, v4
    v_lshrrev_b32 v5, 20, v5
    v_mul_u32_u24 v6, 20, v5
    v_sub_u32 v6, v4, v6
    v_lshl_add_u32 v4, v5, 5, v6
    v_lshl_add_u32 v14, v4, 12, v3
    s_waitcnt lgkmcnt(1)
    buffer_store_dwordx4 v[216:219], v14, s[48:51], 0 offen
    v_cmp_eq_u32 vcc, 0, v6
    s_and_saveexec_b64 s[68:69], vcc
    buffer_store_dwordx4 v[20:23], v14, s[48:51], s66 offen
    s_mov_b64 exec, s[68:69]
    v_add_u32 v4, 60, v2
    v_mul_u32_u24 v5, 0xcccd, v4
    v_lshrrev_b32 v5, 20, v5
    v_mul_u32_u24 v6, 20, v5
    v_sub_u32 v6, v4, v6
    v_lshl_add_u32 v4, v5, 5, v6
    v_lshl_add_u32 v15, v4, 12, v3
    s_waitcnt lgkmcnt(0)
    buffer_store_dwordx4 v[220:223], v15, s[48:51], 0 offen
    v_cmp_eq_u32 vcc, 0, v6
    s_and_saveexec_b64 s[68:69], vcc
    buffer_store_dwordx4 v[20:23], v15, s[48:51], s66 offen
    s_mov_b64 exec, s[68:69]
    s_endpgm
.globl attn_kernel
.p2align 8
.type attn_kernel,@function
attn_kernel:
    s_cmp_ge_u32 s2, 512
    s_cbranch_scc1 aend_21
    s_load_dwordx16 s[16:31], s[0:1], 0
    s_load_dwordx8 s[32:39], s[0:1], 64
    s_waitcnt lgkmcnt(0)
    s_cmp_ge_u32 s2, 256
    s_cbranch_scc1 aja_22
    s_mov_b32 s3, s2
    s_and_b32 s53, s3, 31
    s_lshr_b32 s4, s3, 5
    s_add_u32 s40, s38, 29360128
    s_addc_u32 s41, s39, 0
    s_and_b32 s41, s41, 0xffff
    s_mov_b32 s42, 16777216
    s_mov_b32 s43, 0x00020000
    s_add_u32 s44, s38, 46137344
    s_addc_u32 s45, s39, 0
    s_and_b32 s45, s45, 0xffff
    s_mov_b32 s46, 16777216
    s_mov_b32 s47, 0x00020000
    v_and_b32 v1, 63, v0
    v_lshrrev_b32 v2, 6, v0
    s_nop 0
    v_readfirstlane_b32 s57, v2
    v_lshrrev_b32 v2, 4, v1
    v_and_b32 v3, 15, v1
    s_lshl_b32 s60, s53, 11
    s_lshl_b32 s61, s57, 4
    s_add_u32 s60, s60, s61
    v_add_u32 v4, s60, v2
    v_lshlrev_b32 v4, 8, v4
    v_add_u32 v5, 0, v2
    v_xor_b32 v5, v5, v3
    v_lshl_add_u32 v8, v5, 4, v4
    v_add_u32 v5, 4, v2
    v_xor_b32 v5, v5, v3
    v_lshl_add_u32 v9, v5, 4, v4
    v_add_u32 v5, 8, v2
    v_xor_b32 v5, v5, v3
    v_lshl_add_u32 v10, v5, 4, v4
    v_add_u32 v5, 12, v2
    v_xor_b32 v5, v5, v3
    v_lshl_add_u32 v11, v5, 4, v4
    v_lshrrev_b32 v4, 3, v1
    v_and_b32 v3, 7, v1
    s_lshl_b32 s60, s53, 7
    s_lshl_b32 s61, s57, 5
    s_add_u32 s60, s60, s61
    v_add_u32 v4, s60, v4
    v_lshlrev_b32 v4, 12, v4
    v_add_u32 v5, 0, v2
    v_and_b32 v5, 7, v5
    v_xor_b32 v5, v5, v3
    v_lshl_add_u32 v5, v5, 4, v4
    v_add_u32 v12, 0, v5
    v_add_u32 v5, 4, v2
    v_and_b32 v5, 7, v5
    v_xor_b32 v5, v5, v3
    v_lshl_add_u32 v5, v5, 4, v4
    v_add_u32 v13, 31744, v5
    v_add_u32 v5, 8, v2
    v_and_b32 v5, 7, v5
    v_xor_b32 v5, v5, v3
    v_lshl_add_u32 v5, v5, 4, v4
    v_add_u32 v14, 63488, v5
    v_add_u32 v5, 12, v2
    v_and_b32 v5, 7, v5
    v_xor_b32 v5, v5, v3
    v_lshl_add_u32 v5, v5, 4, v4
    v_add_u32 v15, 95232, v5
    v_and_b32 v2, 31, v1
    v_lshrrev_b32 v3, 5, v1
    v_and_b32 v4, 15, v1
    v_xor_b32 v4, v4, v3
    v_lshlrev_b32 v4, 4, v4
    v_lshl_add_u32 v16, v2, 8, v4
    v_xor_b32 v17, 32, v16
    v_xor_b32 v18, 64, v16
    v_xor_b32 v19, 96, v16
    v_xor_b32 v20, 128, v16
    v_xor_b32 v21, 160, v16
    v_xor_b32 v22, 192, v16
    v_xor_b32 v23, 224, v16
    v_bfe_u32 v4, v1, 1, 3
    v_xor_b32 v4, v4, v3
    v_lshlrev_b32 v4, 4, v4
    v_lshl_add_u32 v24, v2, 7, v4
    v_add_u32 v24, 16384, v24
    v_xor_b32 v25, 32, v24
    v_xor_b32 v26, 64, v24
    v_xor_b32 v27, 96, v24
    s_lshl_b32 s62, s57, 12
    s_mov_b32 s67, 0
    s_sub_u32 s52, 15, s4
bq_23:
    s_barrier
    s_mov_b32 s54, 0
    s_mov_b32 s55, 0
    s_add_u32 m0, s62, 0
    s_nop 0
    buffer_load_dwordx4 v8, s[40:43], s54 offen offset:0 lds
    buffer_load_dwordx4 v9, s[40:43], s54 offen offset:1024 lds
    buffer_load_dwordx4 v10, s[40:43], s54 offen offset:2048 lds
    buffer_load_dwordx4 v11, s[40:43], s54 offen offset:3072 lds
    s_add_u32 s54, s54, 16384
    s_add_u32 m0, s62, 16384
    s_nop 0
    buffer_load_dwordx4 v12, s[44:47], s55 offen offset:0 lds
    buffer_load_dwordx4 v13, s[44:47], s55 offen offset:1024 lds
    buffer_load_dwordx4 v14, s[44:47], s55 offen offset:2048 lds
    buffer_load_dwordx4 v15, s[44:47], s55 offen offset:3072 lds
    s_add_u32 s55, s55, 128
    s_add_u32 m0, s62, 32768
    s_nop 0
    buffer_load_dwordx4 v8, s[40:43], s54 offen offset:0 lds
    buffer_load_dwordx4 v9, s[40:43], s54 offen offset:1024 lds
    buffer_load_dwordx4 v10, s[40:43], s54 offen offset:2048 lds
    buffer_load_dwordx4 v11, s[40:43], s54 offen offset:3072 lds
    s_add_u32 s54, s54, 16384
    s_add_u32 s48, s38, 12582912
    s_addc_u32 s49, s39, 0
    s_and_b32 s49, s49, 0xffff
    s_mov_b32 s50, 16777216
    s_mov_b32 s51, 0x00020000
    v_and_b32 v2, 31, v1
    s_lshl_b32 s60, s53, 11
    s_lshl_b32 s61, s52, 7
    s_add_u32 s60, s60, s61
    s_lshl_b32 s61, s57, 5
    s_add_u32 s60, s60, s61
    v_add_u32 v2, s60, v2
    v_lshlrev_b32 v2, 8, v2
    v_lshrrev_b32 v3, 5, v1
    v_lshl_add_u32 v2, v3, 4, v2
    buffer_load_dwordx4 v[32:35], v2, s[48:51], 0 offen offset:0
    buffer_load_dwordx4 v[36:39], v2, s[48:51], 0 offen offset:32
    buffer_load_dwordx4 v[40:43], v2, s[48:51], 0 offen offset:64
    buffer_load_dwordx4 v[44:47], v2, s[48:51], 0 offen offset:96
    buffer_load_dwordx4 v[48:51], v2, s[48:51], 0 offen offset:128
    buffer_load_dwordx4 v[52:55], v2, s[48:51], 0 offen offset:160
    buffer_load_dwordx4 v[56:59], v2, s[48:51], 0 offen offset:192
    buffer_load_dwordx4 v[60:63], v2, s[48:51], 0 offen offset:224
    v_mov_b32 v64, 0
    v_mov_b32 v65, 0
    v_mov_b32 v66, 0
    v_mov_b32 v67, 0
    v_mov_b32 v68, 0
    v_mov_b32 v69, 0
    v_mov_b32 v70, 0
    v_mov_b32 v71, 0
    v_mov_b32 v72, 0
    v_mov_b32 v73, 0
    v_mov_b32 v74, 0
    v_mov_b32 v75, 0
    v_mov_b32 v76, 0
    v_mov_b32 v77, 0
    v_mov_b32 v78, 0
    v_mov_b32 v79, 0
    v_mov_b32 v80, 0
    v_mov_b32 v81, 0
    v_mov_b32 v82, 0
    v_mov_b32 v83, 0
    v_mov_b32 v84, 0
    v_mov_b32 v85, 0
    v_mov_b32 v86, 0
    v_mov_b32 v87, 0
    v_mov_b32 v88, 0
    v_mov_b32 v89, 0
    v_mov_b32 v90, 0
    v_mov_b32 v91, 0
    v_mov_b32 v92, 0
    v_mov_b32 v93, 0
    v_mov_b32 v94, 0
    v_mov_b32 v95, 0
    v_mov_b32 v96, 0
    v_mov_b32 v97, 0
    v_mov_b32 v98, 0
    v_mov_b32 v99, 0
    v_mov_b32 v100, 0
    v_mov_b32 v101, 0
    v_mov_b32 v102, 0
    v_mov_b32 v103, 0
    v_mov_b32 v104, 0
    v_mov_b32 v105, 0
    v_mov_b32 v106, 0
    v_mov_b32 v107, 0
    v_mov_b32 v108, 0
    v_mov_b32 v109, 0
    v_mov_b32 v110, 0
    v_mov_b32 v111, 0
    v_mov_b32 v112, 0
    v_mov_b32 v113, 0
    v_mov_b32 v114, 0
    v_mov_b32 v115, 0
    v_mov_b32 v116, 0
    v_mov_b32 v117, 0
    v_mov_b32 v118, 0
    v_mov_b32 v119, 0
    v_mov_b32 v120, 0
    v_mov_b32 v121, 0
    v_mov_b32 v122, 0
    v_mov_b32 v123, 0
    v_mov_b32 v124, 0
    v_mov_b32 v125, 0
    v_mov_b32 v126, 0
    v_mov_b32 v127, 0
    v_mov_b32 v160, 0
    v_mov_b32 v161, 0
    v_mov_b32 v162, 0
    v_mov_b32 v163, 0
    v_mov_b32 v164, 0
    v_mov_b32 v165, 0
    v_mov_b32 v166, 0
    v_mov_b32 v167, 0
    v_mov_b32 v168, 0
    v_mov_b32 v169, 0
    v_mov_b32 v170, 0
    v_mov_b32 v171, 0
    v_mov_b32 v172, 0
    v_mov_b32 v173, 0
    v_mov_b32 v174, 0
    v_mov_b32 v175, 0
    v_mov_b32 v248, 0
    v_mov_b32 v249, 0
    v_mov_b32 v250, 0
    v_mov_b32 v251, 0
    s_waitcnt vmcnt(0)
    s_barrier
    s_mov_b32 s70, 1
    ds_read_b128 v[184:187], v16 offset:0
    ds_read_b128 v[188:191], v17 offset:0
    ds_read_b128 v[192:195], v18 offset:0
    ds_read_b128 v[196:199], v19 offset:0
    ds_read_b128 v[200:203], v20 offset:0
    ds_read_b128 v[204:207], v21 offset:0
    ds_read_b128 v[208:211], v22 offset:0
    ds_read_b128 v[212:215], v23 offset:0
    s_waitcnt lgkmcnt(7)
    v_mfma_f32_32x32x16_bf16 v[128:143], v[184:187], v[32:35], v[160:175]
    s_waitcnt lgkmcnt(6)
    v_mfma_f32_32x32x16_bf16 v[128:143], v[188:191], v[36:39], v[128:143]
    s_waitcnt lgkmcnt(5)
    v_mfma_f32_32x32x16_bf16 v[128:143], v[192:195], v[40:43], v[128:143]
    s_waitcnt lgkmcnt(4)
    v_mfma_f32_32x32x16_bf16 v[128:143], v[196:199], v[44:47], v[128:143]
    s_waitcnt lgkmcnt(3)
    v_mfma_f32_32x32x16_bf16 v[128:143], v[200:203], v[48:51], v[128:143]
    s_waitcnt lgkmcnt(2)
    v_mfma_f32_32x32x16_bf16 v[128:143], v[204:207], v[52:55], v[128:143]
    s_waitcnt lgkmcnt(1)
    v_mfma_f32_32x32x16_bf16 v[128:143], v[208:211], v[56:59], v[128:143]
    s_waitcnt lgkmcnt(0)
    v_mfma_f32_32x32x16_bf16 v[128:143], v[212:215], v[60:63], v[128:143]
    s_cmp_eq_u32 s52, 0
    s_nop 10
    s_cbranch_scc1 bdiag_24
    v_max3_f32 v252, v128, v129, v130
    v_max3_f32 v253, v131, v132, v133
    v_max3_f32 v252, v252, v134, v135
    v_max3_f32 v253, v253, v136, v137
    v_max3_f32 v252, v252, v138, v139
    v_max3_f32 v253, v253, v140, v141
    v_max3_f32 v252, v252, v142, v143
    v_max_f32 v252, v252, v253
    v_mov_b32 v253, v252
    v_mov_b32 v254, v252
    s_nop 1
    v_permlane32_swap_b32 v253, v254
    v_max_f32 v252, v253, v254
    v_sub_f32 v128, v128, v252
    v_sub_f32 v160, v160, v252
    v_sub_f32 v129, v129, v252
    v_sub_f32 v161, v161, v252
    v_sub_f32 v130, v130, v252
    v_sub_f32 v162, v162, v252
    v_sub_f32 v131, v131, v252
    v_sub_f32 v163, v163, v252
    v_sub_f32 v132, v132, v252
    v_sub_f32 v164, v164, v252
    v_sub_f32 v133, v133, v252
    v_sub_f32 v165, v165, v252
    v_sub_f32 v134, v134, v252
    v_sub_f32 v166, v166, v252
    v_sub_f32 v135, v135, v252
    v_sub_f32 v167, v167, v252
    v_sub_f32 v136, v136, v252
    v_sub_f32 v168, v168, v252
    v_sub_f32 v137, v137, v252
    v_sub_f32 v169, v169, v252
    v_sub_f32 v138, v138, v252
    v_sub_f32 v170, v170, v252
    v_sub_f32 v139, v139, v252
    v_sub_f32 v171, v171, v252
    v_sub_f32 v140, v140, v252
    v_sub_f32 v172, v172, v252
    v_sub_f32 v141, v141, v252
    v_sub_f32 v173, v173, v252
    v_sub_f32 v142, v142, v252
    v_sub_f32 v174, v174, v252
    v_sub_f32 v143, v143, v252
    v_sub_f32 v175, v175, v252
    s_nop 1
    s_mov_b32 s70, 0
    v_mov_b32 v252, 0
    ds_read_b128 v[184:187], v16 offset:8192
    ds_read_b128 v[188:191], v17 offset:8192
    ds_read_b128 v[192:195], v18 offset:8192
    ds_read_b128 v[196:199], v19 offset:8192
    ds_read_b128 v[200:203], v20 offset:8192
    ds_read_b128 v[204:207], v21 offset:8192
    ds_read_b128 v[208:211], v22 offset:8192
    ds_read_b128 v[212:215], v23 offset:8192
    s_waitcnt lgkmcnt(0)
    s_barrier
    s_add_u32 m0, s62, 0
    s_nop 0
    buffer_load_dwordx4 v8, s[40:43], s54 offen offset:0 lds
    buffer_load_dwordx4 v9, s[40:43], s54 offen offset:1024 lds
    buffer_load_dwordx4 v10, s[40:43], s54 offen offset:2048 lds
    buffer_load_dwordx4 v11, s[40:43], s54 offen offset:3072 lds
    s_add_u32 s54, s54, 16384
    s_add_u32 m0, s62, 49152
    s_nop 0
    buffer_load_dwordx4 v12, s[44:47], s55 offen offset:0 lds
    buffer_load_dwordx4 v13, s[44:47], s55 offen offset:1024 lds
    buffer_load_dwordx4 v14, s[44:47], s55 offen offset:2048 lds
    buffer_load_dwordx4 v15, s[44:47], s55 offen offset:3072 lds
    s_add_u32 s55, s55, 128
    s_mov_b32 s56, s52
bl_25:
    v_cmp_lt_f32 vcc, 16.0, v252
    s_cbranch_vccnz brare_26
bback_27:
    v_mfma_f32_32x32x16_bf16 v[144:159], v[184:187], v[32:35], v[160:175]
    ds_read_b128 v[216:219], v24 offset:0
    ds_read_b128 v[220:223], v24 offset:4096
    ds_read_b128 v[224:227], v24 offset:8192
    ds_read_b128 v[228:231], v24 offset:12288
    v_mfma_f32_32x32x16_bf16 v[144:159], v[188:191], v[36:39], v[144:159]
    ds_read_b128 v[232:235], v25 offset:0
    ds_read_b128 v[236:239], v25 offset:4096
    ds_read_b128 v[240:243], v25 offset:8192
    ds_read_b128 v[244:247], v25 offset:12288
    v_mfma_f32_32x32x16_bf16 v[144:159], v[192:195], v[40:43], v[144:159]
    v_exp_f32 v128, v128
    v_exp_f32 v129, v129
    v_exp_f32 v130, v130
    v_exp_f32 v131, v131
    v_mfma_f32_32x32x16_bf16 v[144:159], v[196:199], v[44:47], v[144:159]
    v_cvt_pk_bf16_f32 v176, v128, v129
    v_exp_f32 v132, v132
    v_exp_f32 v133, v133
    v_cvt_pk_bf16_f32 v177, v130, v131
    v_mfma_f32_32x32x16_bf16 v[144:159], v[200:203], v[48:51], v[144:159]
    v_exp_f32 v134, v134
    v_exp_f32 v135, v135
    v_cvt_pk_bf16_f32 v178, v132, v133
    v_exp_f32 v136, v136
    v_mfma_f32_32x32x16_bf16 v[144:159], v[204:207], v[52:55], v[144:159]
    v_exp_f32 v137, v137
    v_cvt_pk_bf16_f32 v179, v134, v135
    v_exp_f32 v138, v138
    v_exp_f32 v139, v139
    v_mfma_f32_32x32x16_bf16 v[144:159], v[208:211], v[56:59], v[144:159]
    v_cvt_pk_bf16_f32 v180, v136, v137
    v_exp_f32 v140, v140
    v_exp_f32 v141, v141
    v_cvt_pk_bf16_f32 v181, v138, v139
    v_mfma_f32_32x32x16_bf16 v[144:159], v[212:215], v[60:63], v[144:159]
    v_exp_f32 v142, v142
    v_exp_f32 v143, v143
    v_cvt_pk_bf16_f32 v182, v140, v141
    v_cvt_pk_bf16_f32 v183, v142, v143
    s_waitcnt lgkmcnt(7)
    v_mfma_f32_32x32x16_bf16 v[64:79], v[216:219], v[176:179], v[64:79]
    ds_read_b128 v[184:187], v16 offset:32768
    ds_read_b128 v[188:191], v17 offset:32768
    ds_read_b128 v[192:195], v18 offset:32768
    s_waitcnt lgkmcnt(9)
    v_mfma_f32_32x32x16_bf16 v[80:95], v[220:223], v[176:179], v[80:95]
    v_pk_add_f32 v[248:249], v[248:249], v[128:129]
    v_pk_add_f32 v[250:251], v[250:251], v[130:131]
    v_pk_add_f32 v[248:249], v[248:249], v[132:133]
    s_waitcnt lgkmcnt(8)
    v_mfma_f32_32x32x16_bf16 v[96:111], v[224:227], v[176:179], v[96:111]
    v_pk_add_f32 v[250:251], v[250:251], v[134:135]
    v_pk_add_f32 v[248:249], v[248:249], v[136:137]
    v_pk_add_f32 v[250:251], v[250:251], v[138:139]
    s_waitcnt lgkmcnt(7)
    v_mfma_f32_32x32x16_bf16 v[112:127], v[228:231], v[176:179], v[112:127]
    v_pk_add_f32 v[248:249], v[248:249], v[140:141]
    v_pk_add_f32 v[250:251], v[250:251], v[142:143]
    v_max3_f32 v252, v144, v145, v146
    s_waitcnt lgkmcnt(6)
    v_mfma_f32_32x32x16_bf16 v[64:79], v[232:235], v[180:183], v[64:79]
    v_max3_f32 v253, v147, v148, v149
    v_max3_f32 v252, v252, v150, v151
    v_max3_f32 v253, v253, v152, v153
    s_waitcnt lgkmcnt(5)
    v_mfma_f32_32x32x16_bf16 v[80:95], v[236:239], v[180:183], v[80:95]
    v_max3_f32 v252, v252, v154, v155
    v_max3_f32 v253, v253, v156, v157
    v_max3_f32 v252, v252, v158, v159
    s_waitcnt lgkmcnt(4)
    v_mfma_f32_32x32x16_bf16 v[96:111], v[240:243], v[180:183], v[96:111]
    v_max_f32 v252, v252, v253
    ds_read_b128 v[196:199], v19 offset:32768
    ds_read_b128 v[200:203], v20 offset:32768
    s_waitcnt lgkmcnt(5)
    v_mfma_f32_32x32x16_bf16 v[112:127], v[244:247], v[180:183], v[112:127]
    ds_read_b128 v[204:207], v21 offset:32768
    ds_read_b128 v[208:211], v22 offset:32768
    ds_read_b128 v[212:215], v23 offset:32768
    v_cmp_lt_f32 vcc, 16.0, v252
    s_cbranch_vccnz brare_28
bback_29:
    s_waitcnt lgkmcnt(7)
    v_mfma_f32_32x32x16_bf16 v[128:143], v[184:187], v[32:35], v[160:175]
    ds_read_b128 v[216:219], v26 offset:0
    ds_read_b128 v[220:223], v26 offset:4096
    ds_read_b128 v[224:227], v26 offset:8192
    ds_read_b128 v[228:231], v26 offset:12288
    s_waitcnt lgkmcnt(10)
    v_mfma_f32_32x32x16_bf16 v[128:143], v[188:191], v[36:39], v[128:143]
    ds_read_b128 v[232:235], v27 offset:0
    ds_read_b128 v[236:239], v27 offset:4096
    ds_read_b128 v[240:243], v27 offset:8192
    ds_read_b128 v[244:247], v27 offset:12288
    s_waitcnt lgkmcnt(13)
    v_mfma_f32_32x32x16_bf16 v[128:143], v[192:195], v[40:43], v[128:143]
    v_exp_f32 v144, v144
    v_exp_f32 v145, v145
    v_exp_f32 v146, v146
    v_exp_f32 v147, v147
    s_waitcnt lgkmcnt(12)
    v_mfma_f32_32x32x16_bf16 v[128:143], v[196:199], v[44:47], v[128:143]
    v_cvt_pk_bf16_f32 v176, v144, v145
    v_exp_f32 v148, v148
    v_exp_f32 v149, v149
    v_cvt_pk_bf16_f32 v177, v146, v147
    s_waitcnt lgkmcnt(11)
    v_mfma_f32_32x32x16_bf16 v[128:143], v[200:203], v[48:51], v[128:143]
    v_exp_f32 v150, v150
    v_exp_f32 v151, v151
    v_cvt_pk_bf16_f32 v178, v148, v149
    v_exp_f32 v152, v152
    s_waitcnt lgkmcnt(10)
    v_mfma_f32_32x32x16_bf16 v[128:143], v[204:207], v[52:55], v[128:143]
    v_exp_f32 v153, v153
    v_cvt_pk_bf16_f32 v179, v150, v151
    v_exp_f32 v154, v154
    v_exp_f32 v155, v155
    s_waitcnt lgkmcnt(9)
    v_mfma_f32_32x32x16_bf16 v[128:143], v[208:211], v[56:59], v[128:143]
    v_cvt_pk_bf16_f32 v180, v152, v153
    v_exp_f32 v156, v156
    v_exp_f32 v157, v157
    v_cvt_pk_bf16_f32 v181, v154, v155
    s_waitcnt lgkmcnt(8)
    v_mfma_f32_32x32x16_bf16 v[128:143], v[212:215], v[60:63], v[128:143]
    v_exp_f32 v158, v158
    v_exp_f32 v159, v159
    v_cvt_pk_bf16_f32 v182, v156, v157
    v_cvt_pk_bf16_f32 v183, v158, v159
    s_waitcnt lgkmcnt(7)
    v_mfma_f32_32x32x16_bf16 v[64:79], v[216:219], v[176:179], v[64:79]
    ds_read_b128 v[184:187], v16 offset:40960
    ds_read_b128 v[188:191], v17 offset:40960
    ds_read_b128 v[192:195], v18 offset:40960
    s_waitcnt lgkmcnt(9)
    v_mfma_f32_32x32x16_bf16 v[80:95], v[220:223], v[176:179], v[80:95]
    v_pk_add_f32 v[248:249], v[248:249], v[144:145]
    v_pk_add_f32 v[250:251], v[250:251], v[146:147]
    v_pk_add_f32 v[248:249], v[248:249], v[148:149]
    s_waitcnt lgkmcnt(8)
    v_mfma_f32_32x32x16_bf16 v[96:111], v[224:227], v[176:179], v[96:111]
    v_pk_add_f32 v[250:251], v[250:251], v[150:151]
    v_pk_add_f32 v[248:249], v[248:249], v[152:153]
    v_pk_add_f32 v[250:251], v[250:251], v[154:155]
    s_waitcnt lgkmcnt(7)
    v_mfma_f32_32x32x16_bf16 v[112:127], v[228:231], v[176:179], v[112:127]
    v_pk_add_f32 v[248:249], v[248:249], v[156:157]
    v_pk_add_f32 v[250:251], v[250:251], v[158:159]
    v_max3_f32 v252, v128, v129, v130
    s_waitcnt lgkmcnt(6)
    v_mfma_f32_32x32x16_bf16 v[64:79], v[232:235], v[180:183], v[64:79]
    v_max3_f32 v253, v131, v132, v133
    v_max3_f32 v252, v252, v134, v135
    v_max3_f32 v253, v253, v136, v137
    s_waitcnt lgkmcnt(5)
    v_mfma_f32_32x32x16_bf16 v[80:95], v[236:239], v[180:183], v[80:95]
    v_max3_f32 v252, v252, v138, v139
    v_max3_f32 v253, v253, v140, v141
    v_max3_f32 v252, v252, v142, v143
    s_waitcnt lgkmcnt(4)
    v_mfma_f32_32x32x16_bf16 v[96:111], v[240:243], v[180:183], v[96:111]
    v_max_f32 v252, v252, v253
    ds_read_b128 v[196:199], v19 offset:40960
    ds_read_b128 v[200:203], v20 offset:40960
    s_waitcnt lgkmcnt(5)
    v_mfma_f32_32x32x16_bf16 v[112:127], v[244:247], v[180:183], v[112:127]
    ds_read_b128 v[204:207], v21 offset:40960
    ds_read_b128 v[208:211], v22 offset:40960
    ds_read_b128 v[212:215], v23 offset:40960
    s_waitcnt vmcnt(0)
    s_waitcnt lgkmcnt(0)
    s_nop 6
    s_barrier
    s_add_u32 m0, s62, 32768
    s_nop 0
    buffer_load_dwordx4 v8, s[40:43], s54 offen offset:0 lds
    buffer_load_dwordx4 v9, s[40:43], s54 offen offset:1024 lds
    buffer_load_dwordx4 v10, s[40:43], s54 offen offset:2048 lds
    buffer_load_dwordx4 v11, s[40:43], s54 offen offset:3072 lds
    s_add_u32 s54, s54, 16384
    s_add_u32 m0, s62, 16384
    s_nop 0
    buffer_load_dwordx4 v12, s[44:47], s55 offen offset:0 lds
    buffer_load_dwordx4 v13, s[44:47], s55 offen offset:1024 lds
    buffer_load_dwordx4 v14, s[44:47], s55 offen offset:2048 lds
    buffer_load_dwordx4 v15, s[44:47], s55 offen offset:3072 lds
    s_add_u32 s55, s55, 128
    v_cmp_lt_f32 vcc, 16.0, v252
    s_cbranch_vccnz brare_30
bback_31:
    v_mfma_f32_32x32x16_bf16 v[144:159], v[184:187], v[32:35], v[160:175]
    ds_read_b128 v[216:219], v24 offset:32768
    ds_read_b128 v[220:223], v24 offset:36864
    ds_read_b128 v[224:227], v24 offset:40960
    ds_read_b128 v[228:231], v24 offset:45056
    v_mfma_f32_32x32x16_bf16 v[144:159], v[188:191], v[36:39], v[144:159]
    ds_read_b128 v[232:235], v25 offset:32768
    ds_read_b128 v[236:239], v25 offset:36864
    ds_read_b128 v[240:243], v25 offset:40960
    ds_read_b128 v[244:247], v25 offset:45056
    v_mfma_f32_32x32x16_bf16 v[144:159], v[192:195], v[40:43], v[144:159]
    v_exp_f32 v128, v128
    v_exp_f32 v129, v129
    v_exp_f32 v130, v130
    v_exp_f32 v131, v131
    v_mfma_f32_32x32x16_bf16 v[144:159], v[196:199], v[44:47], v[144:159]
    v_cvt_pk_bf16_f32 v176, v128, v129
    v_exp_f32 v132, v132
    v_exp_f32 v133, v133
    v_cvt_pk_bf16_f32 v177, v130, v131
    v_mfma_f32_32x32x16_bf16 v[144:159], v[200:203], v[48:51], v[144:159]
    v_exp_f32 v134, v134
    v_exp_f32 v135, v135
    v_cvt_pk_bf16_f32 v178, v132, v133
    v_exp_f32 v136, v136
    v_mfma_f32_32x32x16_bf16 v[144:159], v[204:207], v[52:55], v[144:159]
    v_exp_f32 v137, v137
    v_cvt_pk_bf16_f32 v179, v134, v135
    v_exp_f32 v138, v138
    v_exp_f32 v139, v139
    v_mfma_f32_32x32x16_bf16 v[144:159], v[208:211], v[56:59], v[144:159]
    v_cvt_pk_bf16_f32 v180, v136, v137
    v_exp_f32 v140, v140
    v_exp_f32 v141, v141
    v_cvt_pk_bf16_f32 v181, v138, v139
    v_mfma_f32_32x32x16_bf16 v[144:159], v[212:215], v[60:63], v[144:159]
    v_exp_f32 v142, v142
    v_exp_f32 v143, v143
    v_cvt_pk_bf16_f32 v182, v140, v141
    v_cvt_pk_bf16_f32 v183, v142, v143
    s_waitcnt lgkmcnt(7)
    v_mfma_f32_32x32x16_bf16 v[64:79], v[216:219], v[176:179], v[64:79]
    ds_read_b128 v[184:187], v16 offset:0
    ds_read_b128 v[188:191], v17 offset:0
    ds_read_b128 v[192:195], v18 offset:0
    s_waitcnt lgkmcnt(9)
    v_mfma_f32_32x32x16_bf16 v[80:95], v[220:223], v[176:179], v[80:95]
    v_pk_add_f32 v[248:249], v[248:249], v[128:129]
    v_pk_add_f32 v[250:251], v[250:251], v[130:131]
    v_pk_add_f32 v[248:249], v[248:249], v[132:133]
    s_waitcnt lgkmcnt(8)
    v_mfma_f32_32x32x16_bf16 v[96:111], v[224:227], v[176:179], v[96:111]
    v_pk_add_f32 v[250:251], v[250:251], v[134:135]
    v_pk_add_f32 v[248:249], v[248:249], v[136:137]
    v_pk_add_f32 v[250:251], v[250:251], v[138:139]
    s_waitcnt lgkmcnt(7)
    v_mfma_f32_32x32x16_bf16 v[112:127], v[228:231], v[176:179], v[112:127]
    v_pk_add_f32 v[248:249], v[248:249], v[140:141]
    v_pk_add_f32 v[250:251], v[250:251], v[142:143]
    v_max3_f32 v252, v144, v145, v146
    s_waitcnt lgkmcnt(6)
    v_mfma_f32_32x32x16_bf16 v[64:79], v[232:235], v[180:183], v[64:79]
    v_max3_f32 v253, v147, v148, v149
    v_max3_f32 v252, v252, v150, v151
    v_max3_f32 v253, v253, v152, v153
    s_waitcnt lgkmcnt(5)
    v_mfma_f32_32x32x16_bf16 v[80:95], v[236:239], v[180:183], v[80:95]
    v_max3_f32 v252, v252, v154, v155
    v_max3_f32 v253, v253, v156, v157
    v_max3_f32 v252, v252, v158, v159
    s_waitcnt lgkmcnt(4)
    v_mfma_f32_32x32x16_bf16 v[96:111], v[240:243], v[180:183], v[96:111]
    v_max_f32 v252, v252, v253
    ds_read_b128 v[196:199], v19 offset:0
    ds_read_b128 v[200:203], v20 offset:0
    s_waitcnt lgkmcnt(5)
    v_mfma_f32_32x32x16_bf16 v[112:127], v[244:247], v[180:183], v[112:127]
    ds_read_b128 v[204:207], v21 offset:0
    ds_read_b128 v[208:211], v22 offset:0
    ds_read_b128 v[212:215], v23 offset:0
    v_cmp_lt_f32 vcc, 16.0, v252
    s_cbranch_vccnz brare_32
bback_33:
    s_waitcnt lgkmcnt(7)
    v_mfma_f32_32x32x16_bf16 v[128:143], v[184:187], v[32:35], v[160:175]
    ds_read_b128 v[216:219], v26 offset:32768
    ds_read_b128 v[220:223], v26 offset:36864
    ds_read_b128 v[224:227], v26 offset:40960
    ds_read_b128 v[228:231], v26 offset:45056
    s_waitcnt lgkmcnt(10)
    v_mfma_f32_32x32x16_bf16 v[128:143], v[188:191], v[36:39], v[128:143]
    ds_read_b128 v[232:235], v27 offset:32768
    ds_read_b128 v[236:239], v27 offset:36864
    ds_read_b128 v[240:243], v27 offset:40960
    ds_read_b128 v[244:247], v27 offset:45056
    s_waitcnt lgkmcnt(13)
    v_mfma_f32_32x32x16_bf16 v[128:143], v[192:195], v[40:43], v[128:143]
    v_exp_f32 v144, v144
    v_exp_f32 v145, v145
    v_exp_f32 v146, v146
    v_exp_f32 v147, v147
    s_waitcnt lgkmcnt(12)
    v_mfma_f32_32x32x16_bf16 v[128:143], v[196:199], v[44:47], v[128:143]
    v_cvt_pk_bf16_f32 v176, v144, v145
    v_exp_f32 v148, v148
    v_exp_f32 v149, v149
    v_cvt_pk_bf16_f32 v177, v146, v147
    s_waitcnt lgkmcnt(11)
    v_mfma_f32_32x32x16_bf16 v[128:143], v[200:203], v[48:51], v[128:143]
    v_exp_f32 v150, v150
    v_exp_f32 v151, v151
    v_cvt_pk_bf16_f32 v178, v148, v149
    v_exp_f32 v152, v152
    s_waitcnt lgkmcnt(10)
    v_mfma_f32_32x32x16_bf16 v[128:143], v[204:207], v[52:55], v[128:143]
    v_exp_f32 v153, v153
    v_cvt_pk_bf16_f32 v179, v150, v151
    v_exp_f32 v154, v154
    v_exp_f32 v155, v155
    s_waitcnt lgkmcnt(9)
    v_mfma_f32_32x32x16_bf16 v[128:143], v[208:211], v[56:59], v[128:143]
    v_cvt_pk_bf16_f32 v180, v152, v153
    v_exp_f32 v156, v156
    v_exp_f32 v157, v157
    v_cvt_pk_bf16_f32 v181, v154, v155
    s_waitcnt lgkmcnt(8)
    v_mfma_f32_32x32x16_bf16 v[128:143], v[212:215], v[60:63], v[128:143]
    v_exp_f32 v158, v158
    v_exp_f32 v159, v159
    v_cvt_pk_bf16_f32 v182, v156, v157
    v_cvt_pk_bf16_f32 v183, v158, v159
    s_waitcnt lgkmcnt(7)
    v_mfma_f32_32x32x16_bf16 v[64:79], v[216:219], v[176:179], v[64:79]
    ds_read_b128 v[184:187], v16 offset:8192
    ds_read_b128 v[188:191], v17 offset:8192
    ds_read_b128 v[192:195], v18 offset:8192
    s_waitcnt lgkmcnt(9)
    v_mfma_f32_32x32x16_bf16 v[80:95], v[220:223], v[176:179], v[80:95]
    v_pk_add_f32 v[248:249], v[248:249], v[144:145]
    v_pk_add_f32 v[250:251], v[250:251], v[146:147]
    v_pk_add_f32 v[248:249], v[248:249], v[148:149]
    s_waitcnt lgkmcnt(8)
    v_mfma_f32_32x32x16_bf16 v[96:111], v[224:227], v[176:179], v[96:111]
    v_pk_add_f32 v[250:251], v[250:251], v[150:151]
    v_pk_add_f32 v[248:249], v[248:249], v[152:153]
    v_pk_add_f32 v[250:251], v[250:251], v[154:155]
    s_waitcnt lgkmcnt(7)
    v_mfma_f32_32x32x16_bf16 v[112:127], v[228:231], v[176:179], v[112:127]
    v_pk_add_f32 v[248:249], v[248:249], v[156:157]
    v_pk_add_f32 v[250:251], v[250:251], v[158:159]
    v_max3_f32 v252, v128, v129, v130
    s_waitcnt lgkmcnt(6)
    v_mfma_f32_32x32x16_bf16 v[64:79], v[232:235], v[180:183], v[64:79]
    v_max3_f32 v253, v131, v132, v133
    v_max3_f32 v252, v252, v134, v135
    v_max3_f32 v253, v253, v136, v137
    s_waitcnt lgkmcnt(5)
    v_mfma_f32_32x32x16_bf16 v[80:95], v[236:239], v[180:183], v[80:95]
    v_max3_f32 v252, v252, v138, v139
    v_max3_f32 v253, v253, v140, v141
    v_max3_f32 v252, v252, v142, v143
    s_waitcnt lgkmcnt(4)
    v_mfma_f32_32x32x16_bf16 v[96:111], v[240:243], v[180:183], v[96:111]
    v_max_f32 v252, v252, v253
    ds_read_b128 v[196:199], v19 offset:8192
    ds_read_b128 v[200:203], v20 offset:8192
    s_waitcnt lgkmcnt(5)
    v_mfma_f32_32x32x16_bf16 v[112:127], v[244:247], v[180:183], v[112:127]
    ds_read_b128 v[204:207], v21 offset:8192
    ds_read_b128 v[208:211], v22 offset:8192
    ds_read_b128 v[212:215], v23 offset:8192
    s_waitcnt vmcnt(0)
    s_waitcnt lgkmcnt(0)
    s_nop 6
    s_barrier
    s_cmp_eq_u32 s56, 1
    s_cbranch_scc1 bsk_34
    s_add_u32 m0, s62, 0
    s_nop 0
    buffer_load_dwordx4 v8, s[40:43], s54 offen offset:0 lds
    buffer_load_dwordx4 v9, s[40:43], s54 offen offset:1024 lds
    buffer_load_dwordx4 v10, s[40:43], s54 offen offset:2048 lds
    buffer_load_dwordx4 v11, s[40:43], s54 offen offset:3072 lds
    s_add_u32 s54, s54, 16384
bsk_34:
    s_add_u32 m0, s62, 49152
    s_nop 0
    buffer_load_dwordx4 v12, s[44:47], s55 offen offset:0 lds
    buffer_load_dwordx4 v13, s[44:47], s55 offen offset:1024 lds
    buffer_load_dwordx4 v14, s[44:47], s55 offen offset:2048 lds
    buffer_load_dwordx4 v15, s[44:47], s55 offen offset:3072 lds
    s_add_u32 s55, s55, 128
    s_sub_u32 s56, s56, 1
    s_cmp_lg_u32 s56, 0
    s_cbranch_scc1 bl_25
bdiag_24:
    s_cmp_lg_u32 s52, 0
    s_cbranch_scc1 bsk_36
    s_add_u32 m0, s62, 49152
    s_nop 0
    buffer_load_dwordx4 v12, s[44:47], s55 offen offset:0 lds
    buffer_load_dwordx4 v13, s[44:47], s55 offen offset:1024 lds
    buffer_load_dwordx4 v14, s[44:47], s55 offen offset:2048 lds
    buffer_load_dwordx4 v15, s[44:47], s55 offen offset:3072 lds
    s_add_u32 s55, s55, 128
bsk_36:
    s_cmp_lt_u32 s57, 0
    s_cbranch_scc1 bdn_37
    ds_read_b128 v[184:187], v16 offset:0
    ds_read_b128 v[188:191], v17 offset:0
    ds_read_b128 v[192:195], v18 offset:0
    ds_read_b128 v[196:199], v19 offset:0
    ds_read_b128 v[200:203], v20 offset:0
    ds_read_b128 v[204:207], v21 offset:0
    ds_read_b128 v[208:211], v22 offset:0
    ds_read_b128 v[212:215], v23 offset:0
    s_waitcnt lgkmcnt(7)
    v_mfma_f32_32x32x16_bf16 v[128:143], v[184:187], v[32:35], v[160:175]
    s_waitcnt lgkmcnt(6)
    v_mfma_f32_32x32x16_bf16 v[128:143], v[188:191], v[36:39], v[128:143]
    s_waitcnt lgkmcnt(5)
    v_mfma_f32_32x32x16_bf16 v[128:143], v[192:195], v[40:43], v[128:143]
    s_waitcnt lgkmcnt(4)
    v_mfma_f32_32x32x16_bf16 v[128:143], v[196:199], v[44:47], v[128:143]
    s_waitcnt lgkmcnt(3)
    v_mfma_f32_32x32x16_bf16 v[128:143], v[200:203], v[48:51], v[128:143]
    s_waitcnt lgkmcnt(2)
    v_mfma_f32_32x32x16_bf16 v[128:143], v[204:207], v[52:55], v[128:143]
    s_waitcnt lgkmcnt(1)
    v_mfma_f32_32x32x16_bf16 v[128:143], v[208:211], v[56:59], v[128:143]
    s_waitcnt lgkmcnt(0)
    v_mfma_f32_32x32x16_bf16 v[128:143], v[212:215], v[60:63], v[128:143]
    ds_read_b128 v[216:219], v24 offset:0
    ds_read_b128 v[220:223], v24 offset:4096
    ds_read_b128 v[224:227], v24 offset:8192
    ds_read_b128 v[228:231], v24 offset:12288
    ds_read_b128 v[232:235], v25 offset:0
    ds_read_b128 v[236:239], v25 offset:4096
    ds_read_b128 v[240:243], v25 offset:8192
    ds_read_b128 v[244:247], v25 offset:12288
    s_cmp_lg_u32 s57, 0
    s_waitcnt lgkmcnt(0)
    s_nop 1
    s_cbranch_scc1 bnm_38
    v_and_b32 v2, 31, v1
    v_lshrrev_b32 v3, 5, v1
    v_lshlrev_b32 v3, 2, v3
    v_sub_u32 v2, v2, v3
    v_mov_b32 v4, 0xff800000
    v_cmp_gt_i32 vcc, 0, v2
    s_nop 1
    v_cndmask_b32 v128, v128, v4, vcc
    v_cmp_gt_i32 vcc, 1, v2
    s_nop 1
    v_cndmask_b32 v129, v129, v4, vcc
    v_cmp_gt_i32 vcc, 2, v2
    s_nop 1
    v_cndmask_b32 v130, v130, v4, vcc
    v_cmp_gt_i32 vcc, 3, v2
    s_nop 1
    v_cndmask_b32 v131, v131, v4, vcc
    v_cmp_gt_i32 vcc, 8, v2
    s_nop 1
    v_cndmask_b32 v132, v132, v4, vcc
    v_cmp_gt_i32 vcc, 9, v2
    s_nop 1
    v_cndmask_b32 v133, v133, v4, vcc
    v_cmp_gt_i32 vcc, 10, v2
    s_nop 1
    v_cndmask_b32 v134, v134, v4, vcc
    v_cmp_gt_i32 vcc, 11, v2
    s_nop 1
    v_cndmask_b32 v135, v135, v4, vcc
    v_cmp_gt_i32 vcc, 16, v2
    s_nop 1
    v_cndmask_b32 v136, v136, v4, vcc
    v_cmp_gt_i32 vcc, 17, v2
    s_nop 1
    v_cndmask_b32 v137, v137, v4, vcc
    v_cmp_gt_i32 vcc, 18, v2
    s_nop 1
    v_cndmask_b32 v138, v138, v4, vcc
    v_cmp_gt_i32 vcc, 19, v2
    s_nop 1
    v_cndmask_b32 v139, v139, v4, vcc
    v_cmp_gt_i32 vcc, 24, v2
    s_nop 1
    v_cndmask_b32 v140, v140, v4, vcc
    v_cmp_gt_i32 vcc, 25, v2
    s_nop 1
    v_cndmask_b32 v141, v141, v4, vcc
    v_cmp_gt_i32 vcc, 26, v2
    s_nop 1
    v_cndmask_b32 v142, v142, v4, vcc
    v_cmp_gt_i32 vcc, 27, v2
    s_nop 1
    v_cndmask_b32 v143, v143, v4, vcc
    s_nop 1
bnm_38:
    s_cmp_eq_u32 s70, 1
    s_cbranch_scc1 bf_39
    v_max3_f32 v252, v128, v129, v130
    v_max3_f32 v253, v131, v132, v133
    v_max3_f32 v252, v252, v134, v135
    v_max3_f32 v253, v253, v136, v137
    v_max3_f32 v252, v252, v138, v139
    v_max3_f32 v253, v253, v140, v141
    v_max3_f32 v252, v252, v142, v143
    v_max_f32 v252, v252, v253
    v_cmp_lt_f32 vcc, 16.0, v252
    s_cbranch_vccnz brare_41
bback_42:
    s_branch bc_40
    s_nop 2
bf_39:
    v_max3_f32 v252, v128, v129, v130
    v_max3_f32 v253, v131, v132, v133
    v_max3_f32 v252, v252, v134, v135
    v_max3_f32 v253, v253, v136, v137
    v_max3_f32 v252, v252, v138, v139
    v_max3_f32 v253, v253, v140, v141
    v_max3_f32 v252, v252, v142, v143
    v_max_f32 v252, v252, v253
    v_mov_b32 v253, v252
    v_mov_b32 v254, v252
    s_nop 1
    v_permlane32_swap_b32 v253, v254
    v_max_f32 v252, v253, v254
    v_sub_f32 v128, v128, v252
    v_sub_f32 v160, v160, v252
    v_sub_f32 v129, v129, v252
    v_sub_f32 v161, v161, v252
    v_sub_f32 v130, v130, v252
    v_sub_f32 v162, v162, v252
    v_sub_f32 v131, v131, v252
    v_sub_f32 v163, v163, v252
    v_sub_f32 v132, v132, v252
    v_sub_f32 v164, v164, v252
    v_sub_f32 v133, v133, v252
    v_sub_f32 v165, v165, v252
    v_sub_f32 v134, v134, v252
    v_sub_f32 v166, v166, v252
    v_sub_f32 v135, v135, v252
    v_sub_f32 v167, v167, v252
    v_sub_f32 v136, v136, v252
    v_sub_f32 v168, v168, v252
    v_sub_f32 v137, v137, v252
    v_sub_f32 v169, v169, v252
    v_sub_f32 v138, v138, v252
    v_sub_f32 v170, v170, v252
    v_sub_f32 v139, v139, v252
    v_sub_f32 v171, v171, v252
    v_sub_f32 v140, v140, v252
    v_sub_f32 v172, v172, v252
    v_sub_f32 v141, v141, v252
    v_sub_f32 v173, v173, v252
    v_sub_f32 v142, v142, v252
    v_sub_f32 v174, v174, v252
    v_sub_f32 v143, v143, v252
    v_sub_f32 v175, v175, v252
    s_nop 1
    s_mov_b32 s70, 0
bc_40:
    v_exp_f32 v128, v128
    v_exp_f32 v129, v129
    v_exp_f32 v130, v130
    v_exp_f32 v131, v131
    v_cvt_pk_bf16_f32 v176, v128, v129
    v_exp_f32 v132, v132
    v_exp_f32 v133, v133
    v_cvt_pk_bf16_f32 v177, v130, v131
    v_exp_f32 v134, v134
    v_exp_f32 v135, v135
    v_cvt_pk_bf16_f32 v178, v132, v133
    v_exp_f32 v136, v136
    v_exp_f32 v137, v137
    v_cvt_pk_bf16_f32 v179, v134, v135
    v_exp_f32 v138, v138
    v_exp_f32 v139, v139
    v_cvt_pk_bf16_f32 v180, v136, v137
    v_exp_f32 v140, v140
    v_exp_f32 v141, v141
    v_cvt_pk_bf16_f32 v181, v138, v139
    v_exp_f32 v142, v142
    v_exp_f32 v143, v143
    v_cvt_pk_bf16_f32 v182, v140, v141
    v_cvt_pk_bf16_f32 v183, v142, v143
    v_mfma_f32_32x32x16_bf16 v[64:79], v[216:219], v[176:179], v[64:79]
    v_pk_add_f32 v[248:249], v[248:249], v[128:129]
    v_mfma_f32_32x32x16_bf16 v[80:95], v[220:223], v[176:179], v[80:95]
    v_pk_add_f32 v[250:251], v[250:251], v[130:131]
    v_mfma_f32_32x32x16_bf16 v[96:111], v[224:227], v[176:179], v[96:111]
    v_pk_add_f32 v[248:249], v[248:249], v[132:133]
    v_mfma_f32_32x32x16_bf16 v[112:127], v[228:231], v[176:179], v[112:127]
    v_pk_add_f32 v[250:251], v[250:251], v[134:135]
    v_mfma_f32_32x32x16_bf16 v[64:79], v[232:235], v[180:183], v[64:79]
    v_pk_add_f32 v[248:249], v[248:249], v[136:137]
    v_mfma_f32_32x32x16_bf16 v[80:95], v[236:239], v[180:183], v[80:95]
    v_pk_add_f32 v[250:251], v[250:251], v[138:139]
    v_mfma_f32_32x32x16_bf16 v[96:111], v[240:243], v[180:183], v[96:111]
    v_pk_add_f32 v[248:249], v[248:249], v[140:141]
    v_mfma_f32_32x32x16_bf16 v[112:127], v[244:247], v[180:183], v[112:127]
    v_pk_add_f32 v[250:251], v[250:251], v[142:143]
    s_nop 10
bdn_37:
    s_cmp_lt_u32 s57, 1
    s_cbranch_scc1 bdn_43
    ds_read_b128 v[184:187], v16 offset:8192
    ds_read_b128 v[188:191], v17 offset:8192
    ds_read_b128 v[192:195], v18 offset:8192
    ds_read_b128 v[196:199], v19 offset:8192
    ds_read_b128 v[200:203], v20 offset:8192
    ds_read_b128 v[204:207], v21 offset:8192
    ds_read_b128 v[208:211], v22 offset:8192
    ds_read_b128 v[212:215], v23 offset:8192
    s_waitcnt lgkmcnt(7)
    v_mfma_f32_32x32x16_bf16 v[128:143], v[184:187], v[32:35], v[160:175]
    s_waitcnt lgkmcnt(6)
    v_mfma_f32_32x32x16_bf16 v[128:143], v[188:191], v[36:39], v[128:143]
    s_waitcnt lgkmcnt(5)
    v_mfma_f32_32x32x16_bf16 v[128:143], v[192:195], v[40:43], v[128:143]
    s_waitcnt lgkmcnt(4)
    v_mfma_f32_32x32x16_bf16 v[128:143], v[196:199], v[44:47], v[128:143]
    s_waitcnt lgkmcnt(3)
    v_mfma_f32_32x32x16_bf16 v[128:143], v[200:203], v[48:51], v[128:143]
    s_waitcnt lgkmcnt(2)
    v_mfma_f32_32x32x16_bf16 v[128:143], v[204:207], v[52:55], v[128:143]
    s_waitcnt lgkmcnt(1)
    v_mfma_f32_32x32x16_bf16 v[128:143], v[208:211], v[56:59], v[128:143]
    s_waitcnt lgkmcnt(0)
    v_mfma_f32_32x32x16_bf16 v[128:143], v[212:215], v[60:63], v[128:143]
    ds_read_b128 v[216:219], v26 offset:0
    ds_read_b128 v[220:223], v26 offset:4096
    ds_read_b128 v[224:227], v26 offset:8192
    ds_read_b128 v[228:231], v26 offset:12288
    ds_read_b128 v[232:235], v27 offset:0
    ds_read_b128 v[236:239], v27 offset:4096
    ds_read_b128 v[240:243], v27 offset:8192
    ds_read_b128 v[244:247], v27 offset:12288
    s_cmp_lg_u32 s57, 1
    s_waitcnt lgkmcnt(0)
    s_nop 1
    s_cbranch_scc1 bnm_44
    v_and_b32 v2, 31, v1
    v_lshrrev_b32 v3, 5, v1
    v_lshlrev_b32 v3, 2, v3
    v_sub_u32 v2, v2, v3
    v_mov_b32 v4, 0xff800000
    v_cmp_gt_i32 vcc, 0, v2
    s_nop 1
    v_cndmask_b32 v128, v128, v4, vcc
    v_cmp_gt_i32 vcc, 1, v2
    s_nop 1
    v_cndmask_b32 v129, v129, v4, vcc
    v_cmp_gt_i32 vcc, 2, v2
    s_nop 1
    v_cndmask_b32 v130, v130, v4, vcc
    v_cmp_gt_i32 vcc, 3, v2
    s_nop 1
    v_cndmask_b32 v131, v131, v4, vcc
    v_cmp_gt_i32 vcc, 8, v2
    s_nop 1
    v_cndmask_b32 v132, v132, v4, vcc
    v_cmp_gt_i32 vcc, 9, v2
    s_nop 1
    v_cndmask_b32 v133, v133, v4, vcc
    v_cmp_gt_i32 vcc, 10, v2
    s_nop 1
    v_cndmask_b32 v134, v134, v4, vcc
    v_cmp_gt_i32 vcc, 11, v2
    s_nop 1
    v_cndmask_b32 v135, v135, v4, vcc
    v_cmp_gt_i32 vcc, 16, v2
    s_nop 1
    v_cndmask_b32 v136, v136, v4, vcc
    v_cmp_gt_i32 vcc, 17, v2
    s_nop 1
    v_cndmask_b32 v137, v137, v4, vcc
    v_cmp_gt_i32 vcc, 18, v2
    s_nop 1
    v_cndmask_b32 v138, v138, v4, vcc
    v_cmp_gt_i32 vcc, 19, v2
    s_nop 1
    v_cndmask_b32 v139, v139, v4, vcc
    v_cmp_gt_i32 vcc, 24, v2
    s_nop 1
    v_cndmask_b32 v140, v140, v4, vcc
    v_cmp_gt_i32 vcc, 25, v2
    s_nop 1
    v_cndmask_b32 v141, v141, v4, vcc
    v_cmp_gt_i32 vcc, 26, v2
    s_nop 1
    v_cndmask_b32 v142, v142, v4, vcc
    v_cmp_gt_i32 vcc, 27, v2
    s_nop 1
    v_cndmask_b32 v143, v143, v4, vcc
    s_nop 1
bnm_44:
    s_cmp_eq_u32 s70, 1
    s_cbranch_scc1 bf_45
    v_max3_f32 v252, v128, v129, v130
    v_max3_f32 v253, v131, v132, v133
    v_max3_f32 v252, v252, v134, v135
    v_max3_f32 v253, v253, v136, v137
    v_max3_f32 v252, v252, v138, v139
    v_max3_f32 v253, v253, v140, v141
    v_max3_f32 v252, v252, v142, v143
    v_max_f32 v252, v252, v253
    v_cmp_lt_f32 vcc, 16.0, v252
    s_cbranch_vccnz brare_47
bback_48:
    s_branch bc_46
    s_nop 2
bf_45:
    v_max3_f32 v252, v128, v129, v130
    v_max3_f32 v253, v131, v132, v133
    v_max3_f32 v252, v252, v134, v135
    v_max3_f32 v253, v253, v136, v137
    v_max3_f32 v252, v252, v138, v139
    v_max3_f32 v253, v253, v140, v141
    v_max3_f32 v252, v252, v142, v143
    v_max_f32 v252, v252, v253
    v_mov_b32 v253, v252
    v_mov_b32 v254, v252
    s_nop 1
    v_permlane32_swap_b32 v253, v254
    v_max_f32 v252, v253, v254
    v_sub_f32 v128, v128, v252
    v_sub_f32 v160, v160, v252
    v_sub_f32 v129, v129, v252
    v_sub_f32 v161, v161, v252
    v_sub_f32 v130, v130, v252
    v_sub_f32 v162, v162, v252
    v_sub_f32 v131, v131, v252
    v_sub_f32 v163, v163, v252
    v_sub_f32 v132, v132, v252
    v_sub_f32 v164, v164, v252
    v_sub_f32 v133, v133, v252
    v_sub_f32 v165, v165, v252
    v_sub_f32 v134, v134, v252
    v_sub_f32 v166, v166, v252
    v_sub_f32 v135, v135, v252
    v_sub_f32 v167, v167, v252
    v_sub_f32 v136, v136, v252
    v_sub_f32 v168, v168, v252
    v_sub_f32 v137, v137, v252
    v_sub_f32 v169, v169, v252
    v_sub_f32 v138, v138, v252
    v_sub_f32 v170, v170, v252
    v_sub_f32 v139, v139, v252
    v_sub_f32 v171, v171, v252
    v_sub_f32 v140, v140, v252
    v_sub_f32 v172, v172, v252
    v_sub_f32 v141, v141, v252
    v_sub_f32 v173, v173, v252
    v_sub_f32 v142, v142, v252
    v_sub_f32 v174, v174, v252
    v_sub_f32 v143, v143, v252
    v_sub_f32 v175, v175, v252
    s_nop 1
    s_mov_b32 s70, 0
bc_46:
    v_exp_f32 v128, v128
    v_exp_f32 v129, v129
    v_exp_f32 v130, v130
    v_exp_f32 v131, v131
    v_cvt_pk_bf16_f32 v176, v128, v129
    v_exp_f32 v132, v132
    v_exp_f32 v133, v133
    v_cvt_pk_bf16_f32 v177, v130, v131
    v_exp_f32 v134, v134
    v_exp_f32 v135, v135
    v_cvt_pk_bf16_f32 v178, v132, v133
    v_exp_f32 v136, v136
    v_exp_f32 v137, v137
    v_cvt_pk_bf16_f32 v179, v134, v135
    v_exp_f32 v138, v138
    v_exp_f32 v139, v139
    v_cvt_pk_bf16_f32 v180, v136, v137
    v_exp_f32 v140, v140
    v_exp_f32 v141, v141
    v_cvt_pk_bf16_f32 v181, v138, v139
    v_exp_f32 v142, v142
    v_exp_f32 v143, v143
    v_cvt_pk_bf16_f32 v182, v140, v141
    v_cvt_pk_bf16_f32 v183, v142, v143
    v_mfma_f32_32x32x16_bf16 v[64:79], v[216:219], v[176:179], v[64:79]
    v_pk_add_f32 v[248:249], v[248:249], v[128:129]
    v_mfma_f32_32x32x16_bf16 v[80:95], v[220:223], v[176:179], v[80:95]
    v_pk_add_f32 v[250:251], v[250:251], v[130:131]
    v_mfma_f32_32x32x16_bf16 v[96:111], v[224:227], v[176:179], v[96:111]
    v_pk_add_f32 v[248:249], v[248:249], v[132:133]
    v_mfma_f32_32x32x16_bf16 v[112:127], v[228:231], v[176:179], v[112:127]
    v_pk_add_f32 v[250:251], v[250:251], v[134:135]
    v_mfma_f32_32x32x16_bf16 v[64:79], v[232:235], v[180:183], v[64:79]
    v_pk_add_f32 v[248:249], v[248:249], v[136:137]
    v_mfma_f32_32x32x16_bf16 v[80:95], v[236:239], v[180:183], v[80:95]
    v_pk_add_f32 v[250:251], v[250:251], v[138:139]
    v_mfma_f32_32x32x16_bf16 v[96:111], v[240:243], v[180:183], v[96:111]
    v_pk_add_f32 v[248:249], v[248:249], v[140:141]
    v_mfma_f32_32x32x16_bf16 v[112:127], v[244:247], v[180:183], v[112:127]
    v_pk_add_f32 v[250:251], v[250:251], v[142:143]
    s_nop 10
bdn_43:
    s_waitcnt vmcnt(0)
    s_barrier
    s_cmp_lt_u32 s57, 2
    s_cbranch_scc1 bdn_49
    ds_read_b128 v[184:187], v16 offset:32768
    ds_read_b128 v[188:191], v17 offset:32768
    ds_read_b128 v[192:195], v18 offset:32768
    ds_read_b128 v[196:199], v19 offset:32768
    ds_read_b128 v[200:203], v20 offset:32768
    ds_read_b128 v[204:207], v21 offset:32768
    ds_read_b128 v[208:211], v22 offset:32768
    ds_read_b128 v[212:215], v23 offset:32768
    s_waitcnt lgkmcnt(7)
    v_mfma_f32_32x32x16_bf16 v[128:143], v[184:187], v[32:35], v[160:175]
    s_waitcnt lgkmcnt(6)
    v_mfma_f32_32x32x16_bf16 v[128:143], v[188:191], v[36:39], v[128:143]
    s_waitcnt lgkmcnt(5)
    v_mfma_f32_32x32x16_bf16 v[128:143], v[192:195], v[40:43], v[128:143]
    s_waitcnt lgkmcnt(4)
    v_mfma_f32_32x32x16_bf16 v[128:143], v[196:199], v[44:47], v[128:143]
    s_waitcnt lgkmcnt(3)
    v_mfma_f32_32x32x16_bf16 v[128:143], v[200:203], v[48:51], v[128:143]
    s_waitcnt lgkmcnt(2)
    v_mfma_f32_32x32x16_bf16 v[128:143], v[204:207], v[52:55], v[128:143]
    s_waitcnt lgkmcnt(1)
    v_mfma_f32_32x32x16_bf16 v[128:143], v[208:211], v[56:59], v[128:143]
    s_waitcnt lgkmcnt(0)
    v_mfma_f32_32x32x16_bf16 v[128:143], v[212:215], v[60:63], v[128:143]
    ds_read_b128 v[216:219], v24 offset:32768
    ds_read_b128 v[220:223], v24 offset:36864
    ds_read_b128 v[224:227], v24 offset:40960
    ds_read_b128 v[228:231], v24 offset:45056
    ds_read_b128 v[232:235], v25 offset:32768
    ds_read_b128 v[236:239], v25 offset:36864
    ds_read_b128 v[240:243], v25 offset:40960
    ds_read_b128 v[244:247], v25 offset:45056
    s_cmp_lg_u32 s57, 2
    s_waitcnt lgkmcnt(0)
    s_nop 1
    s_cbranch_scc1 bnm_50
    v_and_b32 v2, 31, v1
    v_lshrrev_b32 v3, 5, v1
    v_lshlrev_b32 v3, 2, v3
    v_sub_u32 v2, v2, v3
    v_mov_b32 v4, 0xff800000
    v_cmp_gt_i32 vcc, 0, v2
    s_nop 1
    v_cndmask_b32 v128, v128, v4, vcc
    v_cmp_gt_i32 vcc, 1, v2
    s_nop 1
    v_cndmask_b32 v129, v129, v4, vcc
    v_cmp_gt_i32 vcc, 2, v2
    s_nop 1
    v_cndmask_b32 v130, v130, v4, vcc
    v_cmp_gt_i32 vcc, 3, v2
    s_nop 1
    v_cndmask_b32 v131, v131, v4, vcc
    v_cmp_gt_i32 vcc, 8, v2
    s_nop 1
    v_cndmask_b32 v132, v132, v4, vcc
    v_cmp_gt_i32 vcc, 9, v2
    s_nop 1
    v_cndmask_b32 v133, v133, v4, vcc
    v_cmp_gt_i32 vcc, 10, v2
    s_nop 1
    v_cndmask_b32 v134, v134, v4, vcc
    v_cmp_gt_i32 vcc, 11, v2
    s_nop 1
    v_cndmask_b32 v135, v135, v4, vcc
    v_cmp_gt_i32 vcc, 16, v2
    s_nop 1
    v_cndmask_b32 v136, v136, v4, vcc
    v_cmp_gt_i32 vcc, 17, v2
    s_nop 1
    v_cndmask_b32 v137, v137, v4, vcc
    v_cmp_gt_i32 vcc, 18, v2
    s_nop 1
    v_cndmask_b32 v138, v138, v4, vcc
    v_cmp_gt_i32 vcc, 19, v2
    s_nop 1
    v_cndmask_b32 v139, v139, v4, vcc
    v_cmp_gt_i32 vcc, 24, v2
    s_nop 1
    v_cndmask_b32 v140, v140, v4, vcc
    v_cmp_gt_i32 vcc, 25, v2
    s_nop 1
    v_cndmask_b32 v141, v141, v4, vcc
    v_cmp_gt_i32 vcc, 26, v2
    s_nop 1
    v_cndmask_b32 v142, v142, v4, vcc
    v_cmp_gt_i32 vcc, 27, v2
    s_nop 1
    v_cndmask_b32 v143, v143, v4, vcc
    s_nop 1
bnm_50:
    s_cmp_eq_u32 s70, 1
    s_cbranch_scc1 bf_51
    v_max3_f32 v252, v128, v129, v130
    v_max3_f32 v253, v131, v132, v133
    v_max3_f32 v252, v252, v134, v135
    v_max3_f32 v253, v253, v136, v137
    v_max3_f32 v252, v252, v138, v139
    v_max3_f32 v253, v253, v140, v141
    v_max3_f32 v252, v252, v142, v143
    v_max_f32 v252, v252, v253
    v_cmp_lt_f32 vcc, 16.0, v252
    s_cbranch_vccnz brare_53
bback_54:
    s_branch bc_52
    s_nop 2
bf_51:
    v_max3_f32 v252, v128, v129, v130
    v_max3_f32 v253, v131, v132, v133
    v_max3_f32 v252, v252, v134, v135
    v_max3_f32 v253, v253, v136, v137
    v_max3_f32 v252, v252, v138, v139
    v_max3_f32 v253, v253, v140, v141
    v_max3_f32 v252, v252, v142, v143
    v_max_f32 v252, v252, v253
    v_mov_b32 v253, v252
    v_mov_b32 v254, v252
    s_nop 1
    v_permlane32_swap_b32 v253, v254
    v_max_f32 v252, v253, v254
    v_sub_f32 v128, v128, v252
    v_sub_f32 v160, v160, v252
    v_sub_f32 v129, v129, v252
    v_sub_f32 v161, v161, v252
    v_sub_f32 v130, v130, v252
    v_sub_f32 v162, v162, v252
    v_sub_f32 v131, v131, v252
    v_sub_f32 v163, v163, v252
    v_sub_f32 v132, v132, v252
    v_sub_f32 v164, v164, v252
    v_sub_f32 v133, v133, v252
    v_sub_f32 v165, v165, v252
    v_sub_f32 v134, v134, v252
    v_sub_f32 v166, v166, v252
    v_sub_f32 v135, v135, v252
    v_sub_f32 v167, v167, v252
    v_sub_f32 v136, v136, v252
    v_sub_f32 v168, v168, v252
    v_sub_f32 v137, v137, v252
    v_sub_f32 v169, v169, v252
    v_sub_f32 v138, v138, v252
    v_sub_f32 v170, v170, v252
    v_sub_f32 v139, v139, v252
    v_sub_f32 v171, v171, v252
    v_sub_f32 v140, v140, v252
    v_sub_f32 v172, v172, v252
    v_sub_f32 v141, v141, v252
    v_sub_f32 v173, v173, v252
    v_sub_f32 v142, v142, v252
    v_sub_f32 v174, v174, v252
    v_sub_f32 v143, v143, v252
    v_sub_f32 v175, v175, v252
    s_nop 1
    s_mov_b32 s70, 0
bc_52:
    v_exp_f32 v128, v128
    v_exp_f32 v129, v129
    v_exp_f32 v130, v130
    v_exp_f32 v131, v131
    v_cvt_pk_bf16_f32 v176, v128, v129
    v_exp_f32 v132, v132
    v_exp_f32 v133, v133
    v_cvt_pk_bf16_f32 v177, v130, v131
    v_exp_f32 v134, v134
    v_exp_f32 v135, v135
    v_cvt_pk_bf16_f32 v178, v132, v133
    v_exp_f32 v136, v136
    v_exp_f32 v137, v137
    v_cvt_pk_bf16_f32 v179, v134, v135
    v_exp_f32 v138, v138
    v_exp_f32 v139, v139
    v_cvt_pk_bf16_f32 v180, v136, v137
    v_exp_f32 v140, v140
    v_exp_f32 v141, v141
    v_cvt_pk_bf16_f32 v181, v138, v139
    v_exp_f32 v142, v142
    v_exp_f32 v143, v143
    v_cvt_pk_bf16_f32 v182, v140, v141
    v_cvt_pk_bf16_f32 v183, v142, v143
    v_mfma_f32_32x32x16_bf16 v[64:79], v[216:219], v[176:179], v[64:79]
    v_pk_add_f32 v[248:249], v[248:249], v[128:129]
    v_mfma_f32_32x32x16_bf16 v[80:95], v[220:223], v[176:179], v[80:95]
    v_pk_add_f32 v[250:251], v[250:251], v[130:131]
    v_mfma_f32_32x32x16_bf16 v[96:111], v[224:227], v[176:179], v[96:111]
    v_pk_add_f32 v[248:249], v[248:249], v[132:133]
    v_mfma_f32_32x32x16_bf16 v[112:127], v[228:231], v[176:179], v[112:127]
    v_pk_add_f32 v[250:251], v[250:251], v[134:135]
    v_mfma_f32_32x32x16_bf16 v[64:79], v[232:235], v[180:183], v[64:79]
    v_pk_add_f32 v[248:249], v[248:249], v[136:137]
    v_mfma_f32_32x32x16_bf16 v[80:95], v[236:239], v[180:183], v[80:95]
    v_pk_add_f32 v[250:251], v[250:251], v[138:139]
    v_mfma_f32_32x32x16_bf16 v[96:111], v[240:243], v[180:183], v[96:111]
    v_pk_add_f32 v[248:249], v[248:249], v[140:141]
    v_mfma_f32_32x32x16_bf16 v[112:127], v[244:247], v[180:183], v[112:127]
    v_pk_add_f32 v[250:251], v[250:251], v[142:143]
    s_nop 10
bdn_49:
    s_cmp_lt_u32 s57, 3
    s_cbranch_scc1 bdn_55
    ds_read_b128 v[184:187], v16 offset:40960
    ds_read_b128 v[188:191], v17 offset:40960
    ds_read_b128 v[192:195], v18 offset:40960
    ds_read_b128 v[196:199], v19 offset:40960
    ds_read_b128 v[200:203], v20 offset:40960
    ds_read_b128 v[204:207], v21 offset:40960
    ds_read_b128 v[208:211], v22 offset:40960
    ds_read_b128 v[212:215], v23 offset:40960
    s_waitcnt lgkmcnt(7)
    v_mfma_f32_32x32x16_bf16 v[128:143], v[184:187], v[32:35], v[160:175]
    s_waitcnt lgkmcnt(6)
    v_mfma_f32_32x32x16_bf16 v[128:143], v[188:191], v[36:39], v[128:143]
    s_waitcnt lgkmcnt(5)
    v_mfma_f32_32x32x16_bf16 v[128:143], v[192:195], v[40:43], v[128:143]
    s_waitcnt lgkmcnt(4)
    v_mfma_f32_32x32x16_bf16 v[128:143], v[196:199], v[44:47], v[128:143]
    s_waitcnt lgkmcnt(3)
    v_mfma_f32_32x32x16_bf16 v[128:143], v[200:203], v[48:51], v[128:143]
    s_waitcnt lgkmcnt(2)
    v_mfma_f32_32x32x16_bf16 v[128:143], v[204:207], v[52:55], v[128:143]
    s_waitcnt lgkmcnt(1)
    v_mfma_f32_32x32x16_bf16 v[128:143], v[208:211], v[56:59], v[128:143]
    s_waitcnt lgkmcnt(0)
    v_mfma_f32_32x32x16_bf16 v[128:143], v[212:215], v[60:63], v[128:143]
    ds_read_b128 v[216:219], v26 offset:32768
    ds_read_b128 v[220:223], v26 offset:36864
    ds_read_b128 v[224:227], v26 offset:40960
    ds_read_b128 v[228:231], v26 offset:45056
    ds_read_b128 v[232:235], v27 offset:32768
    ds_read_b128 v[236:239], v27 offset:36864
    ds_read_b128 v[240:243], v27 offset:40960
    ds_read_b128 v[244:247], v27 offset:45056
    s_cmp_lg_u32 s57, 3
    s_waitcnt lgkmcnt(0)
    s_nop 1
    s_cbranch_scc1 bnm_56
    v_and_b32 v2, 31, v1
    v_lshrrev_b32 v3, 5, v1
    v_lshlrev_b32 v3, 2, v3
    v_sub_u32 v2, v2, v3
    v_mov_b32 v4, 0xff800000
    v_cmp_gt_i32 vcc, 0, v2
    s_nop 1
    v_cndmask_b32 v128, v128, v4, vcc
    v_cmp_gt_i32 vcc, 1, v2
    s_nop 1
    v_cndmask_b32 v129, v129, v4, vcc
    v_cmp_gt_i32 vcc, 2, v2
    s_nop 1
    v_cndmask_b32 v130, v130, v4, vcc
    v_cmp_gt_i32 vcc, 3, v2
    s_nop 1
    v_cndmask_b32 v131, v131, v4, vcc
    v_cmp_gt_i32 vcc, 8, v2
    s_nop 1
    v_cndmask_b32 v132, v132, v4, vcc
    v_cmp_gt_i32 vcc, 9, v2
    s_nop 1
    v_cndmask_b32 v133, v133, v4, vcc
    v_cmp_gt_i32 vcc, 10, v2
    s_nop 1
    v_cndmask_b32 v134, v134, v4, vcc
    v_cmp_gt_i32 vcc, 11, v2
    s_nop 1
    v_cndmask_b32 v135, v135, v4, vcc
    v_cmp_gt_i32 vcc, 16, v2
    s_nop 1
    v_cndmask_b32 v136, v136, v4, vcc
    v_cmp_gt_i32 vcc, 17, v2
    s_nop 1
    v_cndmask_b32 v137, v137, v4, vcc
    v_cmp_gt_i32 vcc, 18, v2
    s_nop 1
    v_cndmask_b32 v138, v138, v4, vcc
    v_cmp_gt_i32 vcc, 19, v2
    s_nop 1
    v_cndmask_b32 v139, v139, v4, vcc
    v_cmp_gt_i32 vcc, 24, v2
    s_nop 1
    v_cndmask_b32 v140, v140, v4, vcc
    v_cmp_gt_i32 vcc, 25, v2
    s_nop 1
    v_cndmask_b32 v141, v141, v4, vcc
    v_cmp_gt_i32 vcc, 26, v2
    s_nop 1
    v_cndmask_b32 v142, v142, v4, vcc
    v_cmp_gt_i32 vcc, 27, v2
    s_nop 1
    v_cndmask_b32 v143, v143, v4, vcc
    s_nop 1
bnm_56:
    s_cmp_eq_u32 s70, 1
    s_cbranch_scc1 bf_57
    v_max3_f32 v252, v128, v129, v130
    v_max3_f32 v253, v131, v132, v133
    v_max3_f32 v252, v252, v134, v135
    v_max3_f32 v253, v253, v136, v137
    v_max3_f32 v252, v252, v138, v139
    v_max3_f32 v253, v253, v140, v141
    v_max3_f32 v252, v252, v142, v143
    v_max_f32 v252, v252, v253
    v_cmp_lt_f32 vcc, 16.0, v252
    s_cbranch_vccnz brare_59
bback_60:
    s_branch bc_58
    s_nop 2
bf_57:
    v_max3_f32 v252, v128, v129, v130
    v_max3_f32 v253, v131, v132, v133
    v_max3_f32 v252, v252, v134, v135
    v_max3_f32 v253, v253, v136, v137
    v_max3_f32 v252, v252, v138, v139
    v_max3_f32 v253, v253, v140, v141
    v_max3_f32 v252, v252, v142, v143
    v_max_f32 v252, v252, v253
    v_mov_b32 v253, v252
    v_mov_b32 v254, v252
    s_nop 1
    v_permlane32_swap_b32 v253, v254
    v_max_f32 v252, v253, v254
    v_sub_f32 v128, v128, v252
    v_sub_f32 v160, v160, v252
    v_sub_f32 v129, v129, v252
    v_sub_f32 v161, v161, v252
    v_sub_f32 v130, v130, v252
    v_sub_f32 v162, v162, v252
    v_sub_f32 v131, v131, v252
    v_sub_f32 v163, v163, v252
    v_sub_f32 v132, v132, v252
    v_sub_f32 v164, v164, v252
    v_sub_f32 v133, v133, v252
    v_sub_f32 v165, v165, v252
    v_sub_f32 v134, v134, v252
    v_sub_f32 v166, v166, v252
    v_sub_f32 v135, v135, v252
    v_sub_f32 v167, v167, v252
    v_sub_f32 v136, v136, v252
    v_sub_f32 v168, v168, v252
    v_sub_f32 v137, v137, v252
    v_sub_f32 v169, v169, v252
    v_sub_f32 v138, v138, v252
    v_sub_f32 v170, v170, v252
    v_sub_f32 v139, v139, v252
    v_sub_f32 v171, v171, v252
    v_sub_f32 v140, v140, v252
    v_sub_f32 v172, v172, v252
    v_sub_f32 v141, v141, v252
    v_sub_f32 v173, v173, v252
    v_sub_f32 v142, v142, v252
    v_sub_f32 v174, v174, v252
    v_sub_f32 v143, v143, v252
    v_sub_f32 v175, v175, v252
    s_nop 1
    s_mov_b32 s70, 0
bc_58:
    v_exp_f32 v128, v128
    v_exp_f32 v129, v129
    v_exp_f32 v130, v130
    v_exp_f32 v131, v131
    v_cvt_pk_bf16_f32 v176, v128, v129
    v_exp_f32 v132, v132
    v_exp_f32 v133, v133
    v_cvt_pk_bf16_f32 v177, v130, v131
    v_exp_f32 v134, v134
    v_exp_f32 v135, v135
    v_cvt_pk_bf16_f32 v178, v132, v133
    v_exp_f32 v136, v136
    v_exp_f32 v137, v137
    v_cvt_pk_bf16_f32 v179, v134, v135
    v_exp_f32 v138, v138
    v_exp_f32 v139, v139
    v_cvt_pk_bf16_f32 v180, v136, v137
    v_exp_f32 v140, v140
    v_exp_f32 v141, v141
    v_cvt_pk_bf16_f32 v181, v138, v139
    v_exp_f32 v142, v142
    v_exp_f32 v143, v143
    v_cvt_pk_bf16_f32 v182, v140, v141
    v_cvt_pk_bf16_f32 v183, v142, v143
    v_mfma_f32_32x32x16_bf16 v[64:79], v[216:219], v[176:179], v[64:79]
    v_pk_add_f32 v[248:249], v[248:249], v[128:129]
    v_mfma_f32_32x32x16_bf16 v[80:95], v[220:223], v[176:179], v[80:95]
    v_pk_add_f32 v[250:251], v[250:251], v[130:131]
    v_mfma_f32_32x32x16_bf16 v[96:111], v[224:227], v[176:179], v[96:111]
    v_pk_add_f32 v[248:249], v[248:249], v[132:133]
    v_mfma_f32_32x32x16_bf16 v[112:127], v[228:231], v[176:179], v[112:127]
    v_pk_add_f32 v[250:251], v[250:251], v[134:135]
    v_mfma_f32_32x32x16_bf16 v[64:79], v[232:235], v[180:183], v[64:79]
    v_pk_add_f32 v[248:249], v[248:249], v[136:137]
    v_mfma_f32_32x32x16_bf16 v[80:95], v[236:239], v[180:183], v[80:95]
    v_pk_add_f32 v[250:251], v[250:251], v[138:139]
    v_mfma_f32_32x32x16_bf16 v[96:111], v[240:243], v[180:183], v[96:111]
    v_pk_add_f32 v[248:249], v[248:249], v[140:141]
    v_mfma_f32_32x32x16_bf16 v[112:127], v[244:247], v[180:183], v[112:127]
    v_pk_add_f32 v[250:251], v[250:251], v[142:143]
    s_nop 10
bdn_55:
    v_add_f32 v248, v248, v249
    v_add_f32 v250, v250, v251
    v_add_f32 v248, v248, v250
    v_mov_b32 v253, v248
    v_mov_b32 v254, v248
    s_nop 1
    v_permlane32_swap_b32 v253, v254
    v_add_f32 v253, v253, v254
    v_rcp_f32 v253, v253
    s_add_u32 s48, s38, 67108864
    s_addc_u32 s49, s39, 0
    s_and_b32 s49, s49, 0xffff
    s_mov_b32 s50, 16777216
    s_mov_b32 s51, 0x00020000
    v_and_b32 v2, 31, v1
    s_lshl_b32 s60, s52, 7
    s_lshl_b32 s61, s57, 5
    s_add_u32 s60, s60, s61
    v_add_u32 v2, s60, v2
    v_lshlrev_b32 v2, 5, v2
    v_lshrrev_b32 v3, 5, v1
    v_lshl_add_u32 v2, v3, 3, v2
    s_lshl_b32 s61, s53, 19
    s_add_u32 s60, s61, 0
    v_mul_f32 v130, v64, v253
    v_mul_f32 v131, v65, v253
    v_mul_f32 v132, v66, v253
    v_mul_f32 v133, v67, v253
    v_cvt_pk_bf16_f32 v128, v130, v131
    v_cvt_pk_bf16_f32 v129, v132, v133
    buffer_store_dwordx2 v[128:129], v2, s[48:51], s60 offen offset:0
    v_mul_f32 v138, v68, v253
    v_mul_f32 v139, v69, v253
    v_mul_f32 v140, v70, v253
    v_mul_f32 v141, v71, v253
    v_cvt_pk_bf16_f32 v136, v138, v139
    v_cvt_pk_bf16_f32 v137, v140, v141
    buffer_store_dwordx2 v[136:137], v2, s[48:51], s60 offen offset:16
    s_add_u32 s60, s61, 65536
    v_mul_f32 v146, v72, v253
    v_mul_f32 v147, v73, v253
    v_mul_f32 v148, v74, v253
    v_mul_f32 v149, v75, v253
    v_cvt_pk_bf16_f32 v144, v146, v147
    v_cvt_pk_bf16_f32 v145, v148, v149
    buffer_store_dwordx2 v[144:145], v2, s[48:51], s60 offen offset:0
    v_mul_f32 v154, v76, v253
    v_mul_f32 v155, v77, v253
    v_mul_f32 v156, v78, v253
    v_mul_f32 v157, v79, v253
    v_cvt_pk_bf16_f32 v152, v154, v155
    v_cvt_pk_bf16_f32 v153, v156, v157
    buffer_store_dwordx2 v[152:153], v2, s[48:51], s60 offen offset:16
    s_add_u32 s60, s61, 131072
    v_mul_f32 v130, v80, v253
    v_mul_f32 v131, v81, v253
    v_mul_f32 v132, v82, v253
    v_mul_f32 v133, v83, v253
    v_cvt_pk_bf16_f32 v128, v130, v131
    v_cvt_pk_bf16_f32 v129, v132, v133
    buffer_store_dwordx2 v[128:129], v2, s[48:51], s60 offen offset:0
    v_mul_f32 v138, v84, v253
    v_mul_f32 v139, v85, v253
    v_mul_f32 v140, v86, v253
    v_mul_f32 v141, v87, v253
    v_cvt_pk_bf16_f32 v136, v138, v139
    v_cvt_pk_bf16_f32 v137, v140, v141
    buffer_store_dwordx2 v[136:137], v2, s[48:51], s60 offen offset:16
    s_add_u32 s60, s61, 196608
    v_mul_f32 v146, v88, v253
    v_mul_f32 v147, v89, v253
    v_mul_f32 v148, v90, v253
    v_mul_f32 v149, v91, v253
    v_cvt_pk_bf16_f32 v144, v146, v147
    v_cvt_pk_bf16_f32 v145, v148, v149
    buffer_store_dwordx2 v[144:145], v2, s[48:51], s60 offen offset:0
    v_mul_f32 v154, v92, v253
    v_mul_f32 v155, v93, v253
    v_mul_f32 v156, v94, v253
    v_mul_f32 v157, v95, v253
    v_cvt_pk_bf16_f32 v152, v154, v155
    v_cvt_pk_bf16_f32 v153, v156, v157
    buffer_store_dwordx2 v[152:153], v2, s[48:51], s60 offen offset:16
    s_add_u32 s60, s61, 262144
    v_mul_f32 v130, v96, v253
    v_mul_f32 v131, v97, v253
    v_mul_f32 v132, v98, v253
    v_mul_f32 v133, v99, v253
    v_cvt_pk_bf16_f32 v128, v130, v131
    v_cvt_pk_bf16_f32 v129, v132, v133
    buffer_store_dwordx2 v[128:129], v2, s[48:51], s60 offen offset:0
    v_mul_f32 v138, v100, v253
    v_mul_f32 v139, v101, v253
    v_mul_f32 v140, v102, v253
    v_mul_f32 v141, v103, v253
    v_cvt_pk_bf16_f32 v136, v138, v139
    v_cvt_pk_bf16_f32 v137, v140, v141
    buffer_store_dwordx2 v[136:137], v2, s[48:51], s60 offen offset:16
    s_add_u32 s60, s61, 327680
    v_mul_f32 v146, v104, v253
    v_mul_f32 v147, v105, v253
    v_mul_f32 v148, v106, v253
    v_mul_f32 v149, v107, v253
    v_cvt_pk_bf16_f32 v144, v146, v147
    v_cvt_pk_bf16_f32 v145, v148, v149
    buffer_store_dwordx2 v[144:145], v2, s[48:51], s60 offen offset:0
    v_mul_f32 v154, v108, v253
    v_mul_f32 v155, v109, v253
    v_mul_f32 v156, v110, v253
    v_mul_f32 v157, v111, v253
    v_cvt_pk_bf16_f32 v152, v154, v155
    v_cvt_pk_bf16_f32 v153, v156, v157
    buffer_store_dwordx2 v[152:153], v2, s[48:51], s60 offen offset:16
    s_add_u32 s60, s61, 393216
    v_mul_f32 v130, v112, v253
    v_mul_f32 v131, v113, v253
    v_mul_f32 v132, v114, v253
    v_mul_f32 v133, v115, v253
    v_cvt_pk_bf16_f32 v128, v130, v131
    v_cvt_pk_bf16_f32 v129, v132, v133
    buffer_store_dwordx2 v[128:129], v2, s[48:51], s60 offen offset:0
    v_mul_f32 v138, v116, v253
    v_mul_f32 v139, v117, v253
    v_mul_f32 v140, v118, v253
    v_mul_f32 v141, v119, v253
    v_cvt_pk_bf16_f32 v136, v138, v139
    v_cvt_pk_bf16_f32 v137, v140, v141
    buffer_store_dwordx2 v[136:137], v2, s[48:51], s60 offen offset:16
    s_add_u32 s60, s61, 458752
    v_mul_f32 v146, v120, v253
    v_mul_f32 v147, v121, v253
    v_mul_f32 v148, v122, v253
    v_mul_f32 v149, v123, v253
    v_cvt_pk_bf16_f32 v144, v146, v147
    v_cvt_pk_bf16_f32 v145, v148, v149
    buffer_store_dwordx2 v[144:145], v2, s[48:51], s60 offen offset:0
    v_mul_f32 v154, v124, v253
    v_mul_f32 v155, v125, v253
    v_mul_f32 v156, v126, v253
    v_mul_f32 v157, v127, v253
    v_cvt_pk_bf16_f32 v152, v154, v155
    v_cvt_pk_bf16_f32 v153, v156, v157
    buffer_store_dwordx2 v[152:153], v2, s[48:51], s60 offen offset:16
    s_add_u32 s67, s67, 1
    s_mov_b32 s52, s4
    s_cmp_eq_u32 s67, 1
    s_cbranch_scc1 bq_23
    s_mov_b32 s40, s32
    s_mov_b32 s41, s33
    s_and_b32 s41, s41, 0xffff
    s_mov_b32 s42, 5242880
    s_mov_b32 s43, 0x00020000
    s_mov_b32 s44, s20
    s_mov_b32 s45, s21
    s_and_b32 s45, s45, 0xffff
    s_mov_b32 s46, 819200
    s_mov_b32 s47, 0x00020000
    s_mul_i32 s60, s2, 20480
    s_mul_i32 s61, s2, 3200
    v_lshlrev_b32 v2, 7, v0
    v_cmp_gt_u32 vcc, 160, v0
    s_and_b64 exec, exec, vcc
    buffer_load_dword v255, v2, s[40:43], s60 offen
    v_cmp_gt_u32 vcc, 25, v0
    s_and_b64 exec, exec, vcc
    buffer_load_dword v255, v2, s[44:47], s61 offen
    s_endpgm
    s_nop 1
brare_26:
    s_nop 15
    v_max3_f32 v252, v128, v129, v130
    v_max3_f32 v253, v131, v132, v133
    v_max3_f32 v252, v252, v134, v135
    v_max3_f32 v253, v253, v136, v137
    v_max3_f32 v252, v252, v138, v139
    v_max3_f32 v253, v253, v140, v141
    v_max3_f32 v252, v252, v142, v143
    v_max_f32 v252, v252, v253
    v_mov_b32 v253, v252
    v_mov_b32 v254, v252
    s_nop 1
    v_permlane32_swap_b32 v253, v254
    v_max_f32 v252, v253, v254
    v_max_f32 v252, 0, v252
    v_sub_f32 v128, v128, v252
    v_sub_f32 v160, v160, v252
    v_sub_f32 v129, v129, v252
    v_sub_f32 v161, v161, v252
    v_sub_f32 v130, v130, v252
    v_sub_f32 v162, v162, v252
    v_sub_f32 v131, v131, v252
    v_sub_f32 v163, v163, v252
    v_sub_f32 v132, v132, v252
    v_sub_f32 v164, v164, v252
    v_sub_f32 v133, v133, v252
    v_sub_f32 v165, v165, v252
    v_sub_f32 v134, v134, v252
    v_sub_f32 v166, v166, v252
    v_sub_f32 v135, v135, v252
    v_sub_f32 v167, v167, v252
    v_sub_f32 v136, v136, v252
    v_sub_f32 v168, v168, v252
    v_sub_f32 v137, v137, v252
    v_sub_f32 v169, v169, v252
    v_sub_f32 v138, v138, v252
    v_sub_f32 v170, v170, v252
    v_sub_f32 v139, v139, v252
    v_sub_f32 v171, v171, v252
    v_sub_f32 v140, v140, v252
    v_sub_f32 v172, v172, v252
    v_sub_f32 v141, v141, v252
    v_sub_f32 v173, v173, v252
    v_sub_f32 v142, v142, v252
    v_sub_f32 v174, v174, v252
    v_sub_f32 v143, v143, v252
    v_sub_f32 v175, v175, v252
    v_sub_f32 v253, 0, v252
    v_exp_f32 v253, v253
    s_nop 0
    v_mul_f32 v64, v64, v253
    v_mul_f32 v65, v65, v253
    v_mul_f32 v66, v66, v253
    v_mul_f32 v67, v67, v253
    v_mul_f32 v68, v68, v253
    v_mul_f32 v69, v69, v253
    v_mul_f32 v70, v70, v253
    v_mul_f32 v71, v71, v253
    v_mul_f32 v72, v72, v253
    v_mul_f32 v73, v73, v253
    v_mul_f32 v74, v74, v253
    v_mul_f32 v75, v75, v253
    v_mul_f32 v76, v76, v253
    v_mul_f32 v77, v77, v253
    v_mul_f32 v78, v78, v253
    v_mul_f32 v79, v79, v253
    v_mul_f32 v80, v80, v253
    v_mul_f32 v81, v81, v253
    v_mul_f32 v82, v82, v253
    v_mul_f32 v83, v83, v253
    v_mul_f32 v84, v84, v253
    v_mul_f32 v85, v85, v253
    v_mul_f32 v86, v86, v253
    v_mul_f32 v87, v87, v253
    v_mul_f32 v88, v88, v253
    v_mul_f32 v89, v89, v253
    v_mul_f32 v90, v90, v253
    v_mul_f32 v91, v91, v253
    v_mul_f32 v92, v92, v253
    v_mul_f32 v93, v93, v253
    v_mul_f32 v94, v94, v253
    v_mul_f32 v95, v95, v253
    v_mul_f32 v96, v96, v253
    v_mul_f32 v97, v97, v253
    v_mul_f32 v98, v98, v253
    v_mul_f32 v99, v99, v253
    v_mul_f32 v100, v100, v253
    v_mul_f32 v101, v101, v253
    v_mul_f32 v102, v102, v253
    v_mul_f32 v103, v103, v253
    v_mul_f32 v104, v104, v253
    v_mul_f32 v105, v105, v253
    v_mul_f32 v106, v106, v253
    v_mul_f32 v107, v107, v253
    v_mul_f32 v108, v108, v253
    v_mul_f32 v109, v109, v253
    v_mul_f32 v110, v110, v253
    v_mul_f32 v111, v111, v253
    v_mul_f32 v112, v112, v253
    v_mul_f32 v113, v113, v253
    v_mul_f32 v114, v114, v253
    v_mul_f32 v115, v115, v253
    v_mul_f32 v116, v116, v253
    v_mul_f32 v117, v117, v253
    v_mul_f32 v118, v118, v253
    v_mul_f32 v119, v119, v253
    v_mul_f32 v120, v120, v253
    v_mul_f32 v121, v121, v253
    v_mul_f32 v122, v122, v253
    v_mul_f32 v123, v123, v253
    v_mul_f32 v124, v124, v253
    v_mul_f32 v125, v125, v253
    v_mul_f32 v126, v126, v253
    v_mul_f32 v127, v127, v253
    v_mul_f32 v248, v248, v253
    v_mul_f32 v249, v249, v253
    v_mul_f32 v250, v250, v253
    v_mul_f32 v251, v251, v253
    s_nop 1
    s_branch bback_27
brare_28:
    s_nop 15
    v_max3_f32 v252, v144, v145, v146
    v_max3_f32 v253, v147, v148, v149
    v_max3_f32 v252, v252, v150, v151
    v_max3_f32 v253, v253, v152, v153
    v_max3_f32 v252, v252, v154, v155
    v_max3_f32 v253, v253, v156, v157
    v_max3_f32 v252, v252, v158, v159
    v_max_f32 v252, v252, v253
    v_mov_b32 v253, v252
    v_mov_b32 v254, v252
    s_nop 1
    v_permlane32_swap_b32 v253, v254
    v_max_f32 v252, v253, v254
    v_max_f32 v252, 0, v252
    v_sub_f32 v144, v144, v252
    v_sub_f32 v160, v160, v252
    v_sub_f32 v145, v145, v252
    v_sub_f32 v161, v161, v252
    v_sub_f32 v146, v146, v252
    v_sub_f32 v162, v162, v252
    v_sub_f32 v147, v147, v252
    v_sub_f32 v163, v163, v252
    v_sub_f32 v148, v148, v252
    v_sub_f32 v164, v164, v252
    v_sub_f32 v149, v149, v252
    v_sub_f32 v165, v165, v252
    v_sub_f32 v150, v150, v252
    v_sub_f32 v166, v166, v252
    v_sub_f32 v151, v151, v252
    v_sub_f32 v167, v167, v252
    v_sub_f32 v152, v152, v252
    v_sub_f32 v168, v168, v252
    v_sub_f32 v153, v153, v252
    v_sub_f32 v169, v169, v252
    v_sub_f32 v154, v154, v252
    v_sub_f32 v170, v170, v252
    v_sub_f32 v155, v155, v252
    v_sub_f32 v171, v171, v252
    v_sub_f32 v156, v156, v252
    v_sub_f32 v172, v172, v252
    v_sub_f32 v157, v157, v252
    v_sub_f32 v173, v173, v252
    v_sub_f32 v158, v158, v252
    v_sub_f32 v174, v174, v252
    v_sub_f32 v159, v159, v252
    v_sub_f32 v175, v175, v252
    v_sub_f32 v253, 0, v252
    v_exp_f32 v253, v253
    s_nop 0
    v_mul_f32 v64, v64, v253
    v_mul_f32 v65, v65, v253
    v_mul_f32 v66, v66, v253
    v_mul_f32 v67, v67, v253
    v_mul_f32 v68, v68, v253
    v_mul_f32 v69, v69, v253
    v_mul_f32 v70, v70, v253
    v_mul_f32 v71, v71, v253
    v_mul_f32 v72, v72, v253
    v_mul_f32 v73, v73, v253
    v_mul_f32 v74, v74, v253
    v_mul_f32 v75, v75, v253
    v_mul_f32 v76, v76, v253
    v_mul_f32 v77, v77, v253
    v_mul_f32 v78, v78, v253
    v_mul_f32 v79, v79, v253
    v_mul_f32 v80, v80, v253
    v_mul_f32 v81, v81, v253
    v_mul_f32 v82, v82, v253
    v_mul_f32 v83, v83, v253
    v_mul_f32 v84, v84, v253
    v_mul_f32 v85, v85, v253
    v_mul_f32 v86, v86, v253
    v_mul_f32 v87, v87, v253
    v_mul_f32 v88, v88, v253
    v_mul_f32 v89, v89, v253
    v_mul_f32 v90, v90, v253
    v_mul_f32 v91, v91, v253
    v_mul_f32 v92, v92, v253
    v_mul_f32 v93, v93, v253
    v_mul_f32 v94, v94, v253
    v_mul_f32 v95, v95, v253
    v_mul_f32 v96, v96, v253
    v_mul_f32 v97, v97, v253
    v_mul_f32 v98, v98, v253
    v_mul_f32 v99, v99, v253
    v_mul_f32 v100, v100, v253
    v_mul_f32 v101, v101, v253
    v_mul_f32 v102, v102, v253
    v_mul_f32 v103, v103, v253
    v_mul_f32 v104, v104, v253
    v_mul_f32 v105, v105, v253
    v_mul_f32 v106, v106, v253
    v_mul_f32 v107, v107, v253
    v_mul_f32 v108, v108, v253
    v_mul_f32 v109, v109, v253
    v_mul_f32 v110, v110, v253
    v_mul_f32 v111, v111, v253
    v_mul_f32 v112, v112, v253
    v_mul_f32 v113, v113, v253
    v_mul_f32 v114, v114, v253
    v_mul_f32 v115, v115, v253
    v_mul_f32 v116, v116, v253
    v_mul_f32 v117, v117, v253
    v_mul_f32 v118, v118, v253
    v_mul_f32 v119, v119, v253
    v_mul_f32 v120, v120, v253
    v_mul_f32 v121, v121, v253
    v_mul_f32 v122, v122, v253
    v_mul_f32 v123, v123, v253
    v_mul_f32 v124, v124, v253
    v_mul_f32 v125, v125, v253
    v_mul_f32 v126, v126, v253
    v_mul_f32 v127, v127, v253
    v_mul_f32 v248, v248, v253
    v_mul_f32 v249, v249, v253
    v_mul_f32 v250, v250, v253
    v_mul_f32 v251, v251, v253
    s_nop 1
    s_branch bback_29
brare_30:
    s_nop 15
    v_max3_f32 v252, v128, v129, v130
    v_max3_f32 v253, v131, v132, v133
    v_max3_f32 v252, v252, v134, v135
    v_max3_f32 v253, v253, v136, v137
    v_max3_f32 v252, v252, v138, v139
    v_max3_f32 v253, v253, v140, v141
    v_max3_f32 v252, v252, v142, v143
    v_max_f32 v252, v252, v253
    v_mov_b32 v253, v252
    v_mov_b32 v254, v252
    s_nop 1
    v_permlane32_swap_b32 v253, v254
    v_max_f32 v252, v253, v254
    v_max_f32 v252, 0, v252
    v_sub_f32 v128, v128, v252
    v_sub_f32 v160, v160, v252
    v_sub_f32 v129, v129, v252
    v_sub_f32 v161, v161, v252
    v_sub_f32 v130, v130, v252
    v_sub_f32 v162, v162, v252
    v_sub_f32 v131, v131, v252
    v_sub_f32 v163, v163, v252
    v_sub_f32 v132, v132, v252
    v_sub_f32 v164, v164, v252
    v_sub_f32 v133, v133, v252
    v_sub_f32 v165, v165, v252
    v_sub_f32 v134, v134, v252
    v_sub_f32 v166, v166, v252
    v_sub_f32 v135, v135, v252
    v_sub_f32 v167, v167, v252
    v_sub_f32 v136, v136, v252
    v_sub_f32 v168, v168, v252
    v_sub_f32 v137, v137, v252
    v_sub_f32 v169, v169, v252
    v_sub_f32 v138, v138, v252
    v_sub_f32 v170, v170, v252
    v_sub_f32 v139, v139, v252
    v_sub_f32 v171, v171, v252
    v_sub_f32 v140, v140, v252
    v_sub_f32 v172, v172, v252
    v_sub_f32 v141, v141, v252
    v_sub_f32 v173, v173, v252
    v_sub_f32 v142, v142, v252
    v_sub_f32 v174, v174, v252
    v_sub_f32 v143, v143, v252
    v_sub_f32 v175, v175, v252
    v_sub_f32 v253, 0, v252
    v_exp_f32 v253, v253
    s_nop 0
    v_mul_f32 v64, v64, v253
    v_mul_f32 v65, v65, v253
    v_mul_f32 v66, v66, v253
    v_mul_f32 v67, v67, v253
    v_mul_f32 v68, v68, v253
    v_mul_f32 v69, v69, v253
    v_mul_f32 v70, v70, v253
    v_mul_f32 v71, v71, v253
    v_mul_f32 v72, v72, v253
    v_mul_f32 v73, v73, v253
    v_mul_f32 v74, v74, v253
    v_mul_f32 v75, v75, v253
    v_mul_f32 v76, v76, v253
    v_mul_f32 v77, v77, v253
    v_mul_f32 v78, v78, v253
    v_mul_f32 v79, v79, v253
    v_mul_f32 v80, v80, v253
    v_mul_f32 v81, v81, v253
    v_mul_f32 v82, v82, v253
    v_mul_f32 v83, v83, v253
    v_mul_f32 v84, v84, v253
    v_mul_f32 v85, v85, v253
    v_mul_f32 v86, v86, v253
    v_mul_f32 v87, v87, v253
    v_mul_f32 v88, v88, v253
    v_mul_f32 v89, v89, v253
    v_mul_f32 v90, v90, v253
    v_mul_f32 v91, v91, v253
    v_mul_f32 v92, v92, v253
    v_mul_f32 v93, v93, v253
    v_mul_f32 v94, v94, v253
    v_mul_f32 v95, v95, v253
    v_mul_f32 v96, v96, v253
    v_mul_f32 v97, v97, v253
    v_mul_f32 v98, v98, v253
    v_mul_f32 v99, v99, v253
    v_mul_f32 v100, v100, v253
    v_mul_f32 v101, v101, v253
    v_mul_f32 v102, v102, v253
    v_mul_f32 v103, v103, v253
    v_mul_f32 v104, v104, v253
    v_mul_f32 v105, v105, v253
    v_mul_f32 v106, v106, v253
    v_mul_f32 v107, v107, v253
    v_mul_f32 v108, v108, v253
    v_mul_f32 v109, v109, v253
    v_mul_f32 v110, v110, v253
    v_mul_f32 v111, v111, v253
    v_mul_f32 v112, v112, v253
    v_mul_f32 v113, v113, v253
    v_mul_f32 v114, v114, v253
    v_mul_f32 v115, v115, v253
    v_mul_f32 v116, v116, v253
    v_mul_f32 v117, v117, v253
    v_mul_f32 v118, v118, v253
    v_mul_f32 v119, v119, v253
    v_mul_f32 v120, v120, v253
    v_mul_f32 v121, v121, v253
    v_mul_f32 v122, v122, v253
    v_mul_f32 v123, v123, v253
    v_mul_f32 v124, v124, v253
    v_mul_f32 v125, v125, v253
    v_mul_f32 v126, v126, v253
    v_mul_f32 v127, v127, v253
    v_mul_f32 v248, v248, v253
    v_mul_f32 v249, v249, v253
    v_mul_f32 v250, v250, v253
    v_mul_f32 v251, v251, v253
    s_nop 1
    s_branch bback_31
brare_32:
    s_nop 15
    v_max3_f32 v252, v144, v145, v146
    v_max3_f32 v253, v147, v148, v149
    v_max3_f32 v252, v252, v150, v151
    v_max3_f32 v253, v253, v152, v153
    v_max3_f32 v252, v252, v154, v155
    v_max3_f32 v253, v253, v156, v157
    v_max3_f32 v252, v252, v158, v159
    v_max_f32 v252, v252, v253
    v_mov_b32 v253, v252
    v_mov_b32 v254, v252
    s_nop 1
    v_permlane32_swap_b32 v253, v254
    v_max_f32 v252, v253, v254
    v_max_f32 v252, 0, v252
    v_sub_f32 v144, v144, v252
    v_sub_f32 v160, v160, v252
    v_sub_f32 v145, v145, v252
    v_sub_f32 v161, v161, v252
    v_sub_f32 v146, v146, v252
    v_sub_f32 v162, v162, v252
    v_sub_f32 v147, v147, v252
    v_sub_f32 v163, v163, v252
    v_sub_f32 v148, v148, v252
    v_sub_f32 v164, v164, v252
    v_sub_f32 v149, v149, v252
    v_sub_f32 v165, v165, v252
    v_sub_f32 v150, v150, v252
    v_sub_f32 v166, v166, v252
    v_sub_f32 v151, v151, v252
    v_sub_f32 v167, v167, v252
    v_sub_f32 v152, v152, v252
    v_sub_f32 v168, v168, v252
    v_sub_f32 v153, v153, v252
    v_sub_f32 v169, v169, v252
    v_sub_f32 v154, v154, v252
    v_sub_f32 v170, v170, v252
    v_sub_f32 v155, v155, v252
    v_sub_f32 v171, v171, v252
    v_sub_f32 v156, v156, v252
    v_sub_f32 v172, v172, v252
    v_sub_f32 v157, v157, v252
    v_sub_f32 v173, v173, v252
    v_sub_f32 v158, v158, v252
    v_sub_f32 v174, v174, v252
    v_sub_f32 v159, v159, v252
    v_sub_f32 v175, v175, v252
    v_sub_f32 v253, 0, v252
    v_exp_f32 v253, v253
    s_nop 0
    v_mul_f32 v64, v64, v253
    v_mul_f32 v65, v65, v253
    v_mul_f32 v66, v66, v253
    v_mul_f32 v67, v67, v253
    v_mul_f32 v68, v68, v253
    v_mul_f32 v69, v69, v253
    v_mul_f32 v70, v70, v253
    v_mul_f32 v71, v71, v253
    v_mul_f32 v72, v72, v253
    v_mul_f32 v73, v73, v253
    v_mul_f32 v74, v74, v253
    v_mul_f32 v75, v75, v253
    v_mul_f32 v76, v76, v253
    v_mul_f32 v77, v77, v253
    v_mul_f32 v78, v78, v253
    v_mul_f32 v79, v79, v253
    v_mul_f32 v80, v80, v253
    v_mul_f32 v81, v81, v253
    v_mul_f32 v82, v82, v253
    v_mul_f32 v83, v83, v253
    v_mul_f32 v84, v84, v253
    v_mul_f32 v85, v85, v253
    v_mul_f32 v86, v86, v253
    v_mul_f32 v87, v87, v253
    v_mul_f32 v88, v88, v253
    v_mul_f32 v89, v89, v253
    v_mul_f32 v90, v90, v253
    v_mul_f32 v91, v91, v253
    v_mul_f32 v92, v92, v253
    v_mul_f32 v93, v93, v253
    v_mul_f32 v94, v94, v253
    v_mul_f32 v95, v95, v253
    v_mul_f32 v96, v96, v253
    v_mul_f32 v97, v97, v253
    v_mul_f32 v98, v98, v253
    v_mul_f32 v99, v99, v253
    v_mul_f32 v100, v100, v253
    v_mul_f32 v101, v101, v253
    v_mul_f32 v102, v102, v253
    v_mul_f32 v103, v103, v253
    v_mul_f32 v104, v104, v253
    v_mul_f32 v105, v105, v253
    v_mul_f32 v106, v106, v253
    v_mul_f32 v107, v107, v253
    v_mul_f32 v108, v108, v253
    v_mul_f32 v109, v109, v253
    v_mul_f32 v110, v110, v253
    v_mul_f32 v111, v111, v253
    v_mul_f32 v112, v112, v253
    v_mul_f32 v113, v113, v253
    v_mul_f32 v114, v114, v253
    v_mul_f32 v115, v115, v253
    v_mul_f32 v116, v116, v253
    v_mul_f32 v117, v117, v253
    v_mul_f32 v118, v118, v253
    v_mul_f32 v119, v119, v253
    v_mul_f32 v120, v120, v253
    v_mul_f32 v121, v121, v253
    v_mul_f32 v122, v122, v253
    v_mul_f32 v123, v123, v253
    v_mul_f32 v124, v124, v253
    v_mul_f32 v125, v125, v253
    v_mul_f32 v126, v126, v253
    v_mul_f32 v127, v127, v253
    v_mul_f32 v248, v248, v253
    v_mul_f32 v249, v249, v253
    v_mul_f32 v250, v250, v253
    v_mul_f32 v251, v251, v253
    s_nop 1
    s_branch bback_33
brare_41:
    s_nop 15
    v_max3_f32 v252, v128, v129, v130
    v_max3_f32 v253, v131, v132, v133
    v_max3_f32 v252, v252, v134, v135
    v_max3_f32 v253, v253, v136, v137
    v_max3_f32 v252, v252, v138, v139
    v_max3_f32 v253, v253, v140, v141
    v_max3_f32 v252, v252, v142, v143
    v_max_f32 v252, v252, v253
    v_mov_b32 v253, v252
    v_mov_b32 v254, v252
    s_nop 1
    v_permlane32_swap_b32 v253, v254
    v_max_f32 v252, v253, v254
    v_max_f32 v252, 0, v252
    v_sub_f32 v128, v128, v252
    v_sub_f32 v160, v160, v252
    v_sub_f32 v129, v129, v252
    v_sub_f32 v161, v161, v252
    v_sub_f32 v130, v130, v252
    v_sub_f32 v162, v162, v252
    v_sub_f32 v131, v131, v252
    v_sub_f32 v163, v163, v252
    v_sub_f32 v132, v132, v252
    v_sub_f32 v164, v164, v252
    v_sub_f32 v133, v133, v252
    v_sub_f32 v165, v165, v252
    v_sub_f32 v134, v134, v252
    v_sub_f32 v166, v166, v252
    v_sub_f32 v135, v135, v252
    v_sub_f32 v167, v167, v252
    v_sub_f32 v136, v136, v252
    v_sub_f32 v168, v168, v252
    v_sub_f32 v137, v137, v252
    v_sub_f32 v169, v169, v252
    v_sub_f32 v138, v138, v252
    v_sub_f32 v170, v170, v252
    v_sub_f32 v139, v139, v252
    v_sub_f32 v171, v171, v252
    v_sub_f32 v140, v140, v252
    v_sub_f32 v172, v172, v252
    v_sub_f32 v141, v141, v252
    v_sub_f32 v173, v173, v252
    v_sub_f32 v142, v142, v252
    v_sub_f32 v174, v174, v252
    v_sub_f32 v143, v143, v252
    v_sub_f32 v175, v175, v252
    v_sub_f32 v253, 0, v252
    v_exp_f32 v253, v253
    s_nop 0
    v_mul_f32 v64, v64, v253
    v_mul_f32 v65, v65, v253
    v_mul_f32 v66, v66, v253
    v_mul_f32 v67, v67, v253
    v_mul_f32 v68, v68, v253
    v_mul_f32 v69, v69, v253
    v_mul_f32 v70, v70, v253
    v_mul_f32 v71, v71, v253
    v_mul_f32 v72, v72, v253
    v_mul_f32 v73, v73, v253
    v_mul_f32 v74, v74, v253
    v_mul_f32 v75, v75, v253
    v_mul_f32 v76, v76, v253
    v_mul_f32 v77, v77, v253
    v_mul_f32 v78, v78, v253
    v_mul_f32 v79, v79, v253
    v_mul_f32 v80, v80, v253
    v_mul_f32 v81, v81, v253
    v_mul_f32 v82, v82, v253
    v_mul_f32 v83, v83, v253
    v_mul_f32 v84, v84, v253
    v_mul_f32 v85, v85, v253
    v_mul_f32 v86, v86, v253
    v_mul_f32 v87, v87, v253
    v_mul_f32 v88, v88, v253
    v_mul_f32 v89, v89, v253
    v_mul_f32 v90, v90, v253
    v_mul_f32 v91, v91, v253
    v_mul_f32 v92, v92, v253
    v_mul_f32 v93, v93, v253
    v_mul_f32 v94, v94, v253
    v_mul_f32 v95, v95, v253
    v_mul_f32 v96, v96, v253
    v_mul_f32 v97, v97, v253
    v_mul_f32 v98, v98, v253
    v_mul_f32 v99, v99, v253
    v_mul_f32 v100, v100, v253
    v_mul_f32 v101, v101, v253
    v_mul_f32 v102, v102, v253
    v_mul_f32 v103, v103, v253
    v_mul_f32 v104, v104, v253
    v_mul_f32 v105, v105, v253
    v_mul_f32 v106, v106, v253
    v_mul_f32 v107, v107, v253
    v_mul_f32 v108, v108, v253
    v_mul_f32 v109, v109, v253
    v_mul_f32 v110, v110, v253
    v_mul_f32 v111, v111, v253
    v_mul_f32 v112, v112, v253
    v_mul_f32 v113, v113, v253
    v_mul_f32 v114, v114, v253
    v_mul_f32 v115, v115, v253
    v_mul_f32 v116, v116, v253
    v_mul_f32 v117, v117, v253
    v_mul_f32 v118, v118, v253
    v_mul_f32 v119, v119, v253
    v_mul_f32 v120, v120, v253
    v_mul_f32 v121, v121, v253
    v_mul_f32 v122, v122, v253
    v_mul_f32 v123, v123, v253
    v_mul_f32 v124, v124, v253
    v_mul_f32 v125, v125, v253
    v_mul_f32 v126, v126, v253
    v_mul_f32 v127, v127, v253
    v_mul_f32 v248, v248, v253
    v_mul_f32 v249, v249, v253
    v_mul_f32 v250, v250, v253
    v_mul_f32 v251, v251, v253
    s_nop 1
    s_branch bback_42
brare_47:
    s_nop 15
    v_max3_f32 v252, v128, v129, v130
    v_max3_f32 v253, v131, v132, v133
    v_max3_f32 v252, v252, v134, v135
    v_max3_f32 v253, v253, v136, v137
    v_max3_f32 v252, v252, v138, v139
    v_max3_f32 v253, v253, v140, v141
    v_max3_f32 v252, v252, v142, v143
    v_max_f32 v252, v252, v253
    v_mov_b32 v253, v252
    v_mov_b32 v254, v252
    s_nop 1
    v_permlane32_swap_b32 v253, v254
    v_max_f32 v252, v253, v254
    v_max_f32 v252, 0, v252
    v_sub_f32 v128, v128, v252
    v_sub_f32 v160, v160, v252
    v_sub_f32 v129, v129, v252
    v_sub_f32 v161, v161, v252
    v_sub_f32 v130, v130, v252
    v_sub_f32 v162, v162, v252
    v_sub_f32 v131, v131, v252
    v_sub_f32 v163, v163, v252
    v_sub_f32 v132, v132, v252
    v_sub_f32 v164, v164, v252
    v_sub_f32 v133, v133, v252
    v_sub_f32 v165, v165, v252
    v_sub_f32 v134, v134, v252
    v_sub_f32 v166, v166, v252
    v_sub_f32 v135, v135, v252
    v_sub_f32 v167, v167, v252
    v_sub_f32 v136, v136, v252
    v_sub_f32 v168, v168, v252
    v_sub_f32 v137, v137, v252
    v_sub_f32 v169, v169, v252
    v_sub_f32 v138, v138, v252
    v_sub_f32 v170, v170, v252
    v_sub_f32 v139, v139, v252
    v_sub_f32 v171, v171, v252
    v_sub_f32 v140, v140, v252
    v_sub_f32 v172, v172, v252
    v_sub_f32 v141, v141, v252
    v_sub_f32 v173, v173, v252
    v_sub_f32 v142, v142, v252
    v_sub_f32 v174, v174, v252
    v_sub_f32 v143, v143, v252
    v_sub_f32 v175, v175, v252
    v_sub_f32 v253, 0, v252
    v_exp_f32 v253, v253
    s_nop 0
    v_mul_f32 v64, v64, v253
    v_mul_f32 v65, v65, v253
    v_mul_f32 v66, v66, v253
    v_mul_f32 v67, v67, v253
    v_mul_f32 v68, v68, v253
    v_mul_f32 v69, v69, v253
    v_mul_f32 v70, v70, v253
    v_mul_f32 v71, v71, v253
    v_mul_f32 v72, v72, v253
    v_mul_f32 v73, v73, v253
    v_mul_f32 v74, v74, v253
    v_mul_f32 v75, v75, v253
    v_mul_f32 v76, v76, v253
    v_mul_f32 v77, v77, v253
    v_mul_f32 v78, v78, v253
    v_mul_f32 v79, v79, v253
    v_mul_f32 v80, v80, v253
    v_mul_f32 v81, v81, v253
    v_mul_f32 v82, v82, v253
    v_mul_f32 v83, v83, v253
    v_mul_f32 v84, v84, v253
    v_mul_f32 v85, v85, v253
    v_mul_f32 v86, v86, v253
    v_mul_f32 v87, v87, v253
    v_mul_f32 v88, v88, v253
    v_mul_f32 v89, v89, v253
    v_mul_f32 v90, v90, v253
    v_mul_f32 v91, v91, v253
    v_mul_f32 v92, v92, v253
    v_mul_f32 v93, v93, v253
    v_mul_f32 v94, v94, v253
    v_mul_f32 v95, v95, v253
    v_mul_f32 v96, v96, v253
    v_mul_f32 v97, v97, v253
    v_mul_f32 v98, v98, v253
    v_mul_f32 v99, v99, v253
    v_mul_f32 v100, v100, v253
    v_mul_f32 v101, v101, v253
    v_mul_f32 v102, v102, v253
    v_mul_f32 v103, v103, v253
    v_mul_f32 v104, v104, v253
    v_mul_f32 v105, v105, v253
    v_mul_f32 v106, v106, v253
    v_mul_f32 v107, v107, v253
    v_mul_f32 v108, v108, v253
    v_mul_f32 v109, v109, v253
    v_mul_f32 v110, v110, v253
    v_mul_f32 v111, v111, v253
    v_mul_f32 v112, v112, v253
    v_mul_f32 v113, v113, v253
    v_mul_f32 v114, v114, v253
    v_mul_f32 v115, v115, v253
    v_mul_f32 v116, v116, v253
    v_mul_f32 v117, v117, v253
    v_mul_f32 v118, v118, v253
    v_mul_f32 v119, v119, v253
    v_mul_f32 v120, v120, v253
    v_mul_f32 v121, v121, v253
    v_mul_f32 v122, v122, v253
    v_mul_f32 v123, v123, v253
    v_mul_f32 v124, v124, v253
    v_mul_f32 v125, v125, v253
    v_mul_f32 v126, v126, v253
    v_mul_f32 v127, v127, v253
    v_mul_f32 v248, v248, v253
    v_mul_f32 v249, v249, v253
    v_mul_f32 v250, v250, v253
    v_mul_f32 v251, v251, v253
    s_nop 1
    s_branch bback_48
brare_53:
    s_nop 15
    v_max3_f32 v252, v128, v129, v130
    v_max3_f32 v253, v131, v132, v133
    v_max3_f32 v252, v252, v134, v135
    v_max3_f32 v253, v253, v136, v137
    v_max3_f32 v252, v252, v138, v139
    v_max3_f32 v253, v253, v140, v141
    v_max3_f32 v252, v252, v142, v143
    v_max_f32 v252, v252, v253
    v_mov_b32 v253, v252
    v_mov_b32 v254, v252
    s_nop 1
    v_permlane32_swap_b32 v253, v254
    v_max_f32 v252, v253, v254
    v_max_f32 v252, 0, v252
    v_sub_f32 v128, v128, v252
    v_sub_f32 v160, v160, v252
    v_sub_f32 v129, v129, v252
    v_sub_f32 v161, v161, v252
    v_sub_f32 v130, v130, v252
    v_sub_f32 v162, v162, v252
    v_sub_f32 v131, v131, v252
    v_sub_f32 v163, v163, v252
    v_sub_f32 v132, v132, v252
    v_sub_f32 v164, v164, v252
    v_sub_f32 v133, v133, v252
    v_sub_f32 v165, v165, v252
    v_sub_f32 v134, v134, v252
    v_sub_f32 v166, v166, v252
    v_sub_f32 v135, v135, v252
    v_sub_f32 v167, v167, v252
    v_sub_f32 v136, v136, v252
    v_sub_f32 v168, v168, v252
    v_sub_f32 v137, v137, v252
    v_sub_f32 v169, v169, v252
    v_sub_f32 v138, v138, v252
    v_sub_f32 v170, v170, v252
    v_sub_f32 v139, v139, v252
    v_sub_f32 v171, v171, v252
    v_sub_f32 v140, v140, v252
    v_sub_f32 v172, v172, v252
    v_sub_f32 v141, v141, v252
    v_sub_f32 v173, v173, v252
    v_sub_f32 v142, v142, v252
    v_sub_f32 v174, v174, v252
    v_sub_f32 v143, v143, v252
    v_sub_f32 v175, v175, v252
    v_sub_f32 v253, 0, v252
    v_exp_f32 v253, v253
    s_nop 0
    v_mul_f32 v64, v64, v253
    v_mul_f32 v65, v65, v253
    v_mul_f32 v66, v66, v253
    v_mul_f32 v67, v67, v253
    v_mul_f32 v68, v68, v253
    v_mul_f32 v69, v69, v253
    v_mul_f32 v70, v70, v253
    v_mul_f32 v71, v71, v253
    v_mul_f32 v72, v72, v253
    v_mul_f32 v73, v73, v253
    v_mul_f32 v74, v74, v253
    v_mul_f32 v75, v75, v253
    v_mul_f32 v76, v76, v253
    v_mul_f32 v77, v77, v253
    v_mul_f32 v78, v78, v253
    v_mul_f32 v79, v79, v253
    v_mul_f32 v80, v80, v253
    v_mul_f32 v81, v81, v253
    v_mul_f32 v82, v82, v253
    v_mul_f32 v83, v83, v253
    v_mul_f32 v84, v84, v253
    v_mul_f32 v85, v85, v253
    v_mul_f32 v86, v86, v253
    v_mul_f32 v87, v87, v253
    v_mul_f32 v88, v88, v253
    v_mul_f32 v89, v89, v253
    v_mul_f32 v90, v90, v253
    v_mul_f32 v91, v91, v253
    v_mul_f32 v92, v92, v253
    v_mul_f32 v93, v93, v253
    v_mul_f32 v94, v94, v253
    v_mul_f32 v95, v95, v253
    v_mul_f32 v96, v96, v253
    v_mul_f32 v97, v97, v253
    v_mul_f32 v98, v98, v253
    v_mul_f32 v99, v99, v253
    v_mul_f32 v100, v100, v253
    v_mul_f32 v101, v101, v253
    v_mul_f32 v102, v102, v253
    v_mul_f32 v103, v103, v253
    v_mul_f32 v104, v104, v253
    v_mul_f32 v105, v105, v253
    v_mul_f32 v106, v106, v253
    v_mul_f32 v107, v107, v253
    v_mul_f32 v108, v108, v253
    v_mul_f32 v109, v109, v253
    v_mul_f32 v110, v110, v253
    v_mul_f32 v111, v111, v253
    v_mul_f32 v112, v112, v253
    v_mul_f32 v113, v113, v253
    v_mul_f32 v114, v114, v253
    v_mul_f32 v115, v115, v253
    v_mul_f32 v116, v116, v253
    v_mul_f32 v117, v117, v253
    v_mul_f32 v118, v118, v253
    v_mul_f32 v119, v119, v253
    v_mul_f32 v120, v120, v253
    v_mul_f32 v121, v121, v253
    v_mul_f32 v122, v122, v253
    v_mul_f32 v123, v123, v253
    v_mul_f32 v124, v124, v253
    v_mul_f32 v125, v125, v253
    v_mul_f32 v126, v126, v253
    v_mul_f32 v127, v127, v253
    v_mul_f32 v248, v248, v253
    v_mul_f32 v249, v249, v253
    v_mul_f32 v250, v250, v253
    v_mul_f32 v251, v251, v253
    s_nop 1
    s_branch bback_54
brare_59:
    s_nop 15
    v_max3_f32 v252, v128, v129, v130
    v_max3_f32 v253, v131, v132, v133
    v_max3_f32 v252, v252, v134, v135
    v_max3_f32 v253, v253, v136, v137
    v_max3_f32 v252, v252, v138, v139
    v_max3_f32 v253, v253, v140, v141
    v_max3_f32 v252, v252, v142, v143
    v_max_f32 v252, v252, v253
    v_mov_b32 v253, v252
    v_mov_b32 v254, v252
    s_nop 1
    v_permlane32_swap_b32 v253, v254
    v_max_f32 v252, v253, v254
    v_max_f32 v252, 0, v252
    v_sub_f32 v128, v128, v252
    v_sub_f32 v160, v160, v252
    v_sub_f32 v129, v129, v252
    v_sub_f32 v161, v161, v252
    v_sub_f32 v130, v130, v252
    v_sub_f32 v162, v162, v252
    v_sub_f32 v131, v131, v252
    v_sub_f32 v163, v163, v252
    v_sub_f32 v132, v132, v252
    v_sub_f32 v164, v164, v252
    v_sub_f32 v133, v133, v252
    v_sub_f32 v165, v165, v252
    v_sub_f32 v134, v134, v252
    v_sub_f32 v166, v166, v252
    v_sub_f32 v135, v135, v252
    v_sub_f32 v167, v167, v252
    v_sub_f32 v136, v136, v252
    v_sub_f32 v168, v168, v252
    v_sub_f32 v137, v137, v252
    v_sub_f32 v169, v169, v252
    v_sub_f32 v138, v138, v252
    v_sub_f32 v170, v170, v252
    v_sub_f32 v139, v139, v252
    v_sub_f32 v171, v171, v252
    v_sub_f32 v140, v140, v252
    v_sub_f32 v172, v172, v252
    v_sub_f32 v141, v141, v252
    v_sub_f32 v173, v173, v252
    v_sub_f32 v142, v142, v252
    v_sub_f32 v174, v174, v252
    v_sub_f32 v143, v143, v252
    v_sub_f32 v175, v175, v252
    v_sub_f32 v253, 0, v252
    v_exp_f32 v253, v253
    s_nop 0
    v_mul_f32 v64, v64, v253
    v_mul_f32 v65, v65, v253
    v_mul_f32 v66, v66, v253
    v_mul_f32 v67, v67, v253
    v_mul_f32 v68, v68, v253
    v_mul_f32 v69, v69, v253
    v_mul_f32 v70, v70, v253
    v_mul_f32 v71, v71, v253
    v_mul_f32 v72, v72, v253
    v_mul_f32 v73, v73, v253
    v_mul_f32 v74, v74, v253
    v_mul_f32 v75, v75, v253
    v_mul_f32 v76, v76, v253
    v_mul_f32 v77, v77, v253
    v_mul_f32 v78, v78, v253
    v_mul_f32 v79, v79, v253
    v_mul_f32 v80, v80, v253
    v_mul_f32 v81, v81, v253
    v_mul_f32 v82, v82, v253
    v_mul_f32 v83, v83, v253
    v_mul_f32 v84, v84, v253
    v_mul_f32 v85, v85, v253
    v_mul_f32 v86, v86, v253
    v_mul_f32 v87, v87, v253
    v_mul_f32 v88, v88, v253
    v_mul_f32 v89, v89, v253
    v_mul_f32 v90, v90, v253
    v_mul_f32 v91, v91, v253
    v_mul_f32 v92, v92, v253
    v_mul_f32 v93, v93, v253
    v_mul_f32 v94, v94, v253
    v_mul_f32 v95, v95, v253
    v_mul_f32 v96, v96, v253
    v_mul_f32 v97, v97, v253
    v_mul_f32 v98, v98, v253
    v_mul_f32 v99, v99, v253
    v_mul_f32 v100, v100, v253
    v_mul_f32 v101, v101, v253
    v_mul_f32 v102, v102, v253
    v_mul_f32 v103, v103, v253
    v_mul_f32 v104, v104, v253
    v_mul_f32 v105, v105, v253
    v_mul_f32 v106, v106, v253
    v_mul_f32 v107, v107, v253
    v_mul_f32 v108, v108, v253
    v_mul_f32 v109, v109, v253
    v_mul_f32 v110, v110, v253
    v_mul_f32 v111, v111, v253
    v_mul_f32 v112, v112, v253
    v_mul_f32 v113, v113, v253
    v_mul_f32 v114, v114, v253
    v_mul_f32 v115, v115, v253
    v_mul_f32 v116, v116, v253
    v_mul_f32 v117, v117, v253
    v_mul_f32 v118, v118, v253
    v_mul_f32 v119, v119, v253
    v_mul_f32 v120, v120, v253
    v_mul_f32 v121, v121, v253
    v_mul_f32 v122, v122, v253
    v_mul_f32 v123, v123, v253
    v_mul_f32 v124, v124, v253
    v_mul_f32 v125, v125, v253
    v_mul_f32 v126, v126, v253
    v_mul_f32 v127, v127, v253
    v_mul_f32 v248, v248, v253
    v_mul_f32 v249, v249, v253
    v_mul_f32 v250, v250, v253
    v_mul_f32 v251, v251, v253
    s_nop 1
    s_branch bback_60
aend_21:
    s_endpgm
aja_22:
    s_sub_u32 s3, s2, 256
    s_and_b32 s53, s3, 31
    s_lshr_b32 s52, s3, 5
    s_add_u32 s40, s38, 4194304
    s_addc_u32 s41, s39, 0
    s_and_b32 s41, s41, 0xffff
    s_mov_b32 s42, 4194304
    s_mov_b32 s43, 0x00020000
    s_add_u32 s44, s38, 8388608
    s_addc_u32 s45, s39, 0
    s_and_b32 s45, s45, 0xffff
    s_mov_b32 s46, 4194304
    s_mov_b32 s47, 0x00020000
    v_and_b32 v1, 63, v0
    v_lshrrev_b32 v2, 6, v0
    s_nop 0
    v_readfirstlane_b32 s57, v2
    v_lshrrev_b32 v2, 2, v1
    v_bfe_u32 v3, v1, 4, 2
    v_and_b32 v4, 3, v1
    v_xor_b32 v4, v4, v3
    s_lshl_b32 s60, s53, 11
    s_lshl_b32 s61, s57, 5
    s_add_u32 s60, s60, s61
    v_add_u32 v2, s60, v2
    v_lshlrev_b32 v2, 6, v2
    v_lshl_add_u32 v8, v4, 4, v2
    v_lshrrev_b32 v2, 4, v1
    v_and_b32 v3, 15, v1
    s_lshl_b32 s61, s57, 3
    s_lshl_b32 s60, s53, 5
    s_add_u32 s60, s60, s61
    v_add_u32 v4, 0, v2
    v_add_u32 v5, s61, v4
    v_and_b32 v5, 15, v5
    v_xor_b32 v5, v5, v3
    v_add_u32 v4, s60, v4
    v_lshlrev_b32 v4, 12, v4
    v_lshl_add_u32 v4, v5, 4, v4
    v_subrev_u32 v12, 0, v4
    v_add_u32 v4, 4, v2
    v_add_u32 v5, s61, v4
    v_and_b32 v5, 15, v5
    v_xor_b32 v5, v5, v3
    v_add_u32 v4, s60, v4
    v_lshlrev_b32 v4, 12, v4
    v_lshl_add_u32 v4, v5, 4, v4
    v_subrev_u32 v13, 1024, v4
    v_and_b32 v2, 31, v1
    v_lshrrev_b32 v3, 5, v1
    v_bfe_u32 v4, v1, 2, 2
    v_xor_b32 v4, v4, v3
    v_lshlrev_b32 v4, 4, v4
    v_lshl_add_u32 v16, v2, 6, v4
    v_xor_b32 v17, 32, v16
    v_and_b32 v4, 15, v1
    v_xor_b32 v4, v4, v3
    v_lshlrev_b32 v4, 4, v4
    v_lshl_add_u32 v18, v2, 8, v4
    v_add_u32 v18, 8192, v18
    v_xor_b32 v19, 32, v18
    v_xor_b32 v20, 64, v18
    v_xor_b32 v21, 96, v18
    v_xor_b32 v22, 128, v18
    v_xor_b32 v23, 160, v18
    v_xor_b32 v24, 192, v18
    v_xor_b32 v25, 224, v18
    s_lshl_b32 s62, s57, 11
    s_mov_b32 s54, 0
    s_mov_b32 s55, 0
    s_add_u32 m0, s62, 0
    s_nop 0
    buffer_load_dwordx4 v8, s[40:43], s54 offen offset:0 lds
    buffer_load_dwordx4 v8, s[40:43], s54 offen offset:1024 lds
    s_add_u32 s54, s54, 8192
    s_add_u32 m0, s62, 8192
    s_nop 0
    buffer_load_dwordx4 v12, s[44:47], s55 offen offset:0 lds
    buffer_load_dwordx4 v13, s[44:47], s55 offen offset:1024 lds
    s_add_u32 s55, s55, 256
    s_add_u32 m0, s62, 16384
    s_nop 0
    buffer_load_dwordx4 v8, s[40:43], s54 offen offset:0 lds
    buffer_load_dwordx4 v8, s[40:43], s54 offen offset:1024 lds
    s_add_u32 s54, s54, 8192
    s_mov_b32 s48, s38
    s_mov_b32 s49, s39
    s_and_b32 s49, s49, 0xffff
    s_mov_b32 s50, 4194304
    s_mov_b32 s51, 0x00020000
    v_and_b32 v2, 31, v1
    s_lshl_b32 s60, s53, 11
    s_lshl_b32 s61, s52, 8
    s_add_u32 s60, s60, s61
    s_lshl_b32 s61, s57, 6
    s_add_u32 s60, s60, s61
    v_add_u32 v2, s60, v2
    v_lshlrev_b32 v2, 6, v2
    v_lshrrev_b32 v3, 5, v1
    v_lshl_add_u32 v2, v3, 4, v2
    buffer_load_dwordx4 v[32:35], v2, s[48:51], 0 offen offset:0
    buffer_load_dwordx4 v[36:39], v2, s[48:51], 0 offen offset:32
    buffer_load_dwordx4 v[40:43], v2, s[48:51], 0 offen offset:2048
    buffer_load_dwordx4 v[44:47], v2, s[48:51], 0 offen offset:2080
    v_mov_b32 v64, 0
    v_mov_b32 v96, 0
    v_mov_b32 v65, 0
    v_mov_b32 v97, 0
    v_mov_b32 v66, 0
    v_mov_b32 v98, 0
    v_mov_b32 v67, 0
    v_mov_b32 v99, 0
    v_mov_b32 v68, 0
    v_mov_b32 v100, 0
    v_mov_b32 v69, 0
    v_mov_b32 v101, 0
    v_mov_b32 v70, 0
    v_mov_b32 v102, 0
    v_mov_b32 v71, 0
    v_mov_b32 v103, 0
    v_mov_b32 v72, 0
    v_mov_b32 v104, 0
    v_mov_b32 v73, 0
    v_mov_b32 v105, 0
    v_mov_b32 v74, 0
    v_mov_b32 v106, 0
    v_mov_b32 v75, 0
    v_mov_b32 v107, 0
    v_mov_b32 v76, 0
    v_mov_b32 v108, 0
    v_mov_b32 v77, 0
    v_mov_b32 v109, 0
    v_mov_b32 v78, 0
    v_mov_b32 v110, 0
    v_mov_b32 v79, 0
    v_mov_b32 v111, 0
    v_mov_b32 v80, 0
    v_mov_b32 v112, 0
    v_mov_b32 v81, 0
    v_mov_b32 v113, 0
    v_mov_b32 v82, 0
    v_mov_b32 v114, 0
    v_mov_b32 v83, 0
    v_mov_b32 v115, 0
    v_mov_b32 v84, 0
    v_mov_b32 v116, 0
    v_mov_b32 v85, 0
    v_mov_b32 v117, 0
    v_mov_b32 v86, 0
    v_mov_b32 v118, 0
    v_mov_b32 v87, 0
    v_mov_b32 v119, 0
    v_mov_b32 v88, 0
    v_mov_b32 v120, 0
    v_mov_b32 v89, 0
    v_mov_b32 v121, 0
    v_mov_b32 v90, 0
    v_mov_b32 v122, 0
    v_mov_b32 v91, 0
    v_mov_b32 v123, 0
    v_mov_b32 v92, 0
    v_mov_b32 v124, 0
    v_mov_b32 v93, 0
    v_mov_b32 v125, 0
    v_mov_b32 v94, 0
    v_mov_b32 v126, 0
    v_mov_b32 v95, 0
    v_mov_b32 v127, 0
    s_waitcnt vmcnt(0)
    s_barrier
    ds_read_b128 v[208:211], v16 offset:0
    ds_read_b128 v[212:215], v17 offset:0
    s_waitcnt lgkmcnt(1)
    v_mfma_f32_32x32x16_bf16 v[128:143], v[208:211], v[32:35], v[96:111]
    s_waitcnt lgkmcnt(0)
    v_mfma_f32_32x32x16_bf16 v[128:143], v[212:215], v[36:39], v[128:143]
    v_mfma_f32_32x32x16_bf16 v[144:159], v[208:211], v[40:43], v[112:127]
    v_mfma_f32_32x32x16_bf16 v[144:159], v[212:215], v[44:47], v[144:159]
    s_nop 11
    v_max3_f32 v240, v128, v129, v130
    v_max3_f32 v242, v131, v132, v133
    v_max3_f32 v240, v240, v134, v135
    v_max3_f32 v242, v242, v136, v137
    v_max3_f32 v240, v240, v138, v139
    v_max3_f32 v242, v242, v140, v141
    v_max3_f32 v240, v240, v142, v143
    v_max_f32 v240, v240, v242
    v_mov_b32 v242, v240
    v_mov_b32 v243, v240
    s_nop 1
    v_permlane32_swap_b32 v242, v243
    v_max_f32 v240, v242, v243
    v_sub_f32 v128, v128, v240
    v_sub_f32 v96, v96, v240
    v_sub_f32 v129, v129, v240
    v_sub_f32 v97, v97, v240
    v_sub_f32 v130, v130, v240
    v_sub_f32 v98, v98, v240
    v_sub_f32 v131, v131, v240
    v_sub_f32 v99, v99, v240
    v_sub_f32 v132, v132, v240
    v_sub_f32 v100, v100, v240
    v_sub_f32 v133, v133, v240
    v_sub_f32 v101, v101, v240
    v_sub_f32 v134, v134, v240
    v_sub_f32 v102, v102, v240
    v_sub_f32 v135, v135, v240
    v_sub_f32 v103, v103, v240
    v_sub_f32 v136, v136, v240
    v_sub_f32 v104, v104, v240
    v_sub_f32 v137, v137, v240
    v_sub_f32 v105, v105, v240
    v_sub_f32 v138, v138, v240
    v_sub_f32 v106, v106, v240
    v_sub_f32 v139, v139, v240
    v_sub_f32 v107, v107, v240
    v_sub_f32 v140, v140, v240
    v_sub_f32 v108, v108, v240
    v_sub_f32 v141, v141, v240
    v_sub_f32 v109, v109, v240
    v_sub_f32 v142, v142, v240
    v_sub_f32 v110, v110, v240
    v_sub_f32 v143, v143, v240
    v_sub_f32 v111, v111, v240
    s_nop 1
    v_mov_b32 v240, 0
    s_nop 1
    v_max3_f32 v241, v144, v145, v146
    v_max3_f32 v242, v147, v148, v149
    v_max3_f32 v241, v241, v150, v151
    v_max3_f32 v242, v242, v152, v153
    v_max3_f32 v241, v241, v154, v155
    v_max3_f32 v242, v242, v156, v157
    v_max3_f32 v241, v241, v158, v159
    v_max_f32 v241, v241, v242
    v_mov_b32 v242, v241
    v_mov_b32 v243, v241
    s_nop 1
    v_permlane32_swap_b32 v242, v243
    v_max_f32 v241, v242, v243
    v_sub_f32 v144, v144, v241
    v_sub_f32 v112, v112, v241
    v_sub_f32 v145, v145, v241
    v_sub_f32 v113, v113, v241
    v_sub_f32 v146, v146, v241
    v_sub_f32 v114, v114, v241
    v_sub_f32 v147, v147, v241
    v_sub_f32 v115, v115, v241
    v_sub_f32 v148, v148, v241
    v_sub_f32 v116, v116, v241
    v_sub_f32 v149, v149, v241
    v_sub_f32 v117, v117, v241
    v_sub_f32 v150, v150, v241
    v_sub_f32 v118, v118, v241
    v_sub_f32 v151, v151, v241
    v_sub_f32 v119, v119, v241
    v_sub_f32 v152, v152, v241
    v_sub_f32 v120, v120, v241
    v_sub_f32 v153, v153, v241
    v_sub_f32 v121, v121, v241
    v_sub_f32 v154, v154, v241
    v_sub_f32 v122, v122, v241
    v_sub_f32 v155, v155, v241
    v_sub_f32 v123, v123, v241
    v_sub_f32 v156, v156, v241
    v_sub_f32 v124, v124, v241
    v_sub_f32 v157, v157, v241
    v_sub_f32 v125, v125, v241
    v_sub_f32 v158, v158, v241
    v_sub_f32 v126, v126, v241
    v_sub_f32 v159, v159, v241
    v_sub_f32 v127, v127, v241
    s_nop 1
    v_mov_b32 v241, 0
    ds_read_b128 v[216:219], v16 offset:2048
    ds_read_b128 v[220:223], v17 offset:2048
    s_add_u32 m0, s62, 24576
    s_nop 0
    buffer_load_dwordx4 v12, s[44:47], s55 offen offset:0 lds
    buffer_load_dwordx4 v13, s[44:47], s55 offen offset:1024 lds
    s_add_u32 s55, s55, 256
    s_mov_b32 s56, 8
    s_waitcnt lgkmcnt(0)
al_61:
    v_max_f32 v243, v240, v241
    v_cmp_lt_f32 vcc, 16.0, v243
    s_cbranch_vccnz arare_62
aback_63:
    v_mfma_f32_32x32x16_bf16 v[160:175], v[216:219], v[32:35], v[96:111]
    ds_read_b128 v[224:227], v18 offset:0
    ds_read_b128 v[228:231], v19 offset:0
    v_exp_f32 v128, v128
    v_exp_f32 v129, v129
    v_exp_f32 v130, v130
    v_exp_f32 v131, v131
    v_cvt_pk_bf16_f32 v192, v128, v129
    v_exp_f32 v132, v132
    v_exp_f32 v133, v133
    v_cvt_pk_bf16_f32 v193, v130, v131
    v_exp_f32 v134, v134
    v_exp_f32 v135, v135
    v_cvt_pk_bf16_f32 v194, v132, v133
    v_mfma_f32_32x32x16_bf16 v[160:175], v[220:223], v[36:39], v[160:175]
    v_exp_f32 v136, v136
    v_exp_f32 v137, v137
    v_cvt_pk_bf16_f32 v195, v134, v135
    v_exp_f32 v138, v138
    v_exp_f32 v139, v139
    v_cvt_pk_bf16_f32 v196, v136, v137
    v_exp_f32 v140, v140
    v_exp_f32 v141, v141
    v_cvt_pk_bf16_f32 v197, v138, v139
    v_exp_f32 v142, v142
    v_exp_f32 v143, v143
    v_cvt_pk_bf16_f32 v198, v140, v141
    v_mfma_f32_32x32x16_bf16 v[176:191], v[216:219], v[40:43], v[112:127]
    v_cvt_pk_bf16_f32 v199, v142, v143
    v_exp_f32 v144, v144
    v_exp_f32 v145, v145
    v_exp_f32 v146, v146
    v_exp_f32 v147, v147
    v_cvt_pk_bf16_f32 v200, v144, v145
    v_exp_f32 v148, v148
    v_exp_f32 v149, v149
    v_cvt_pk_bf16_f32 v201, v146, v147
    v_exp_f32 v150, v150
    v_exp_f32 v151, v151
    v_cvt_pk_bf16_f32 v202, v148, v149
    v_exp_f32 v152, v152
    v_mfma_f32_32x32x16_bf16 v[176:191], v[220:223], v[44:47], v[176:191]
    v_exp_f32 v153, v153
    v_cvt_pk_bf16_f32 v203, v150, v151
    v_exp_f32 v154, v154
    v_exp_f32 v155, v155
    v_cvt_pk_bf16_f32 v204, v152, v153
    v_exp_f32 v156, v156
    v_exp_f32 v157, v157
    v_cvt_pk_bf16_f32 v205, v154, v155
    v_exp_f32 v158, v158
    v_exp_f32 v159, v159
    v_cvt_pk_bf16_f32 v206, v156, v157
    v_cvt_pk_bf16_f32 v207, v158, v159
    s_waitcnt lgkmcnt(1)
    v_mfma_f32_32x32x16_bf16 v[64:79], v[224:227], v[192:195], v[64:79]
    ds_read_b128 v[208:211], v16 offset:4096
    ds_read_b128 v[212:215], v17 offset:4096
    v_max3_f32 v240, v160, v161, v162
    v_max3_f32 v242, v163, v164, v165
    v_max3_f32 v240, v240, v166, v167
    s_waitcnt lgkmcnt(2)
    v_mfma_f32_32x32x16_bf16 v[64:79], v[228:231], v[196:199], v[64:79]
    v_max3_f32 v242, v242, v168, v169
    v_max3_f32 v240, v240, v170, v171
    v_max3_f32 v242, v242, v172, v173
    v_max3_f32 v240, v240, v174, v175
    v_mfma_f32_32x32x16_bf16 v[80:95], v[224:227], v[200:203], v[80:95]
    v_max_f32 v240, v240, v242
    v_max3_f32 v241, v176, v177, v178
    v_max3_f32 v243, v179, v180, v181
    v_max3_f32 v241, v241, v182, v183
    v_max3_f32 v243, v243, v184, v185
    v_mfma_f32_32x32x16_bf16 v[80:95], v[228:231], v[204:207], v[80:95]
    v_max3_f32 v241, v241, v186, v187
    v_max3_f32 v243, v243, v188, v189
    v_max3_f32 v241, v241, v190, v191
    v_max_f32 v241, v241, v243
    v_max_f32 v243, v240, v241
    v_cmp_lt_f32 vcc, 16.0, v243
    s_cbranch_vccnz arare_64
aback_65:
    s_waitcnt lgkmcnt(1)
    v_mfma_f32_32x32x16_bf16 v[128:143], v[208:211], v[32:35], v[96:111]
    ds_read_b128 v[232:235], v20 offset:0
    ds_read_b128 v[236:239], v21 offset:0
    v_exp_f32 v160, v160
    v_exp_f32 v161, v161
    v_exp_f32 v162, v162
    v_exp_f32 v163, v163
    v_cvt_pk_bf16_f32 v192, v160, v161
    v_exp_f32 v164, v164
    v_exp_f32 v165, v165
    v_cvt_pk_bf16_f32 v193, v162, v163
    v_exp_f32 v166, v166
    v_exp_f32 v167, v167
    v_cvt_pk_bf16_f32 v194, v164, v165
    s_waitcnt lgkmcnt(2)
    v_mfma_f32_32x32x16_bf16 v[128:143], v[212:215], v[36:39], v[128:143]
    v_exp_f32 v168, v168
    v_exp_f32 v169, v169
    v_cvt_pk_bf16_f32 v195, v166, v167
    v_exp_f32 v170, v170
    v_exp_f32 v171, v171
    v_cvt_pk_bf16_f32 v196, v168, v169
    v_exp_f32 v172, v172
    v_exp_f32 v173, v173
    v_cvt_pk_bf16_f32 v197, v170, v171
    v_exp_f32 v174, v174
    v_exp_f32 v175, v175
    v_cvt_pk_bf16_f32 v198, v172, v173
    v_mfma_f32_32x32x16_bf16 v[144:159], v[208:211], v[40:43], v[112:127]
    v_cvt_pk_bf16_f32 v199, v174, v175
    v_exp_f32 v176, v176
    v_exp_f32 v177, v177
    v_exp_f32 v178, v178
    v_exp_f32 v179, v179
    v_cvt_pk_bf16_f32 v200, v176, v177
    v_exp_f32 v180, v180
    v_exp_f32 v181, v181
    v_cvt_pk_bf16_f32 v201, v178, v179
    v_exp_f32 v182, v182
    v_exp_f32 v183, v183
    v_cvt_pk_bf16_f32 v202, v180, v181
    v_exp_f32 v184, v184
    v_mfma_f32_32x32x16_bf16 v[144:159], v[212:215], v[44:47], v[144:159]
    v_exp_f32 v185, v185
    v_cvt_pk_bf16_f32 v203, v182, v183
    v_exp_f32 v186, v186
    v_exp_f32 v187, v187
    v_cvt_pk_bf16_f32 v204, v184, v185
    v_exp_f32 v188, v188
    v_exp_f32 v189, v189
    v_cvt_pk_bf16_f32 v205, v186, v187
    v_exp_f32 v190, v190
    v_exp_f32 v191, v191
    v_cvt_pk_bf16_f32 v206, v188, v189
    v_cvt_pk_bf16_f32 v207, v190, v191
    s_waitcnt lgkmcnt(1)
    v_mfma_f32_32x32x16_bf16 v[64:79], v[232:235], v[192:195], v[64:79]
    ds_read_b128 v[216:219], v16 offset:6144
    ds_read_b128 v[220:223], v17 offset:6144
    v_max3_f32 v240, v128, v129, v130
    v_max3_f32 v242, v131, v132, v133
    v_max3_f32 v240, v240, v134, v135
    s_waitcnt lgkmcnt(2)
    v_mfma_f32_32x32x16_bf16 v[64:79], v[236:239], v[196:199], v[64:79]
    v_max3_f32 v242, v242, v136, v137
    v_max3_f32 v240, v240, v138, v139
    v_max3_f32 v242, v242, v140, v141
    v_max3_f32 v240, v240, v142, v143
    v_mfma_f32_32x32x16_bf16 v[80:95], v[232:235], v[200:203], v[80:95]
    v_max_f32 v240, v240, v242
    v_max3_f32 v241, v144, v145, v146
    v_max3_f32 v243, v147, v148, v149
    v_max3_f32 v241, v241, v150, v151
    v_max3_f32 v243, v243, v152, v153
    v_mfma_f32_32x32x16_bf16 v[80:95], v[236:239], v[204:207], v[80:95]
    v_max3_f32 v241, v241, v154, v155
    v_max3_f32 v243, v243, v156, v157
    v_max3_f32 v241, v241, v158, v159
    v_max_f32 v241, v241, v243
    s_waitcnt vmcnt(0)
    s_waitcnt lgkmcnt(0)
    s_nop 5
    s_barrier
    s_add_u32 m0, s62, 0
    s_nop 0
    buffer_load_dwordx4 v8, s[40:43], s54 offen offset:0 lds
    buffer_load_dwordx4 v8, s[40:43], s54 offen offset:1024 lds
    s_add_u32 s54, s54, 8192
    v_max_f32 v243, v240, v241
    v_cmp_lt_f32 vcc, 16.0, v243
    s_cbranch_vccnz arare_66
aback_67:
    v_mfma_f32_32x32x16_bf16 v[160:175], v[216:219], v[32:35], v[96:111]
    ds_read_b128 v[224:227], v22 offset:0
    ds_read_b128 v[228:231], v23 offset:0
    v_exp_f32 v128, v128
    v_exp_f32 v129, v129
    v_exp_f32 v130, v130
    v_exp_f32 v131, v131
    v_cvt_pk_bf16_f32 v192, v128, v129
    v_exp_f32 v132, v132
    v_exp_f32 v133, v133
    v_cvt_pk_bf16_f32 v193, v130, v131
    v_exp_f32 v134, v134
    v_exp_f32 v135, v135
    v_cvt_pk_bf16_f32 v194, v132, v133
    v_mfma_f32_32x32x16_bf16 v[160:175], v[220:223], v[36:39], v[160:175]
    v_exp_f32 v136, v136
    v_exp_f32 v137, v137
    v_cvt_pk_bf16_f32 v195, v134, v135
    v_exp_f32 v138, v138
    v_exp_f32 v139, v139
    v_cvt_pk_bf16_f32 v196, v136, v137
    v_exp_f32 v140, v140
    v_exp_f32 v141, v141
    v_cvt_pk_bf16_f32 v197, v138, v139
    v_exp_f32 v142, v142
    v_exp_f32 v143, v143
    v_cvt_pk_bf16_f32 v198, v140, v141
    v_mfma_f32_32x32x16_bf16 v[176:191], v[216:219], v[40:43], v[112:127]
    v_cvt_pk_bf16_f32 v199, v142, v143
    v_exp_f32 v144, v144
    v_exp_f32 v145, v145
    v_exp_f32 v146, v146
    v_exp_f32 v147, v147
    v_cvt_pk_bf16_f32 v200, v144, v145
    v_exp_f32 v148, v148
    v_exp_f32 v149, v149
    v_cvt_pk_bf16_f32 v201, v146, v147
    v_exp_f32 v150, v150
    v_exp_f32 v151, v151
    v_cvt_pk_bf16_f32 v202, v148, v149
    v_exp_f32 v152, v152
    v_mfma_f32_32x32x16_bf16 v[176:191], v[220:223], v[44:47], v[176:191]
    v_exp_f32 v153, v153
    v_cvt_pk_bf16_f32 v203, v150, v151
    v_exp_f32 v154, v154
    v_exp_f32 v155, v155
    v_cvt_pk_bf16_f32 v204, v152, v153
    v_exp_f32 v156, v156
    v_exp_f32 v157, v157
    v_cvt_pk_bf16_f32 v205, v154, v155
    v_exp_f32 v158, v158
    v_exp_f32 v159, v159
    v_cvt_pk_bf16_f32 v206, v156, v157
    v_cvt_pk_bf16_f32 v207, v158, v159
    s_waitcnt lgkmcnt(1)
    v_mfma_f32_32x32x16_bf16 v[64:79], v[224:227], v[192:195], v[64:79]
    ds_read_b128 v[208:211], v16 offset:16384
    ds_read_b128 v[212:215], v17 offset:16384
    v_max3_f32 v240, v160, v161, v162
    v_max3_f32 v242, v163, v164, v165
    v_max3_f32 v240, v240, v166, v167
    s_waitcnt lgkmcnt(2)
    v_mfma_f32_32x32x16_bf16 v[64:79], v[228:231], v[196:199], v[64:79]
    v_max3_f32 v242, v242, v168, v169
    v_max3_f32 v240, v240, v170, v171
    v_max3_f32 v242, v242, v172, v173
    v_max3_f32 v240, v240, v174, v175
    v_mfma_f32_32x32x16_bf16 v[80:95], v[224:227], v[200:203], v[80:95]
    v_max_f32 v240, v240, v242
    v_max3_f32 v241, v176, v177, v178
    v_max3_f32 v243, v179, v180, v181
    v_max3_f32 v241, v241, v182, v183
    v_max3_f32 v243, v243, v184, v185
    v_mfma_f32_32x32x16_bf16 v[80:95], v[228:231], v[204:207], v[80:95]
    v_max3_f32 v241, v241, v186, v187
    v_max3_f32 v243, v243, v188, v189
    v_max3_f32 v241, v241, v190, v191
    v_max_f32 v241, v241, v243
    v_max_f32 v243, v240, v241
    v_cmp_lt_f32 vcc, 16.0, v243
    s_cbranch_vccnz arare_68
aback_69:
    s_waitcnt lgkmcnt(1)
    v_mfma_f32_32x32x16_bf16 v[128:143], v[208:211], v[32:35], v[96:111]
    ds_read_b128 v[232:235], v24 offset:0
    ds_read_b128 v[236:239], v25 offset:0
    v_exp_f32 v160, v160
    v_exp_f32 v161, v161
    v_exp_f32 v162, v162
    v_exp_f32 v163, v163
    v_cvt_pk_bf16_f32 v192, v160, v161
    v_exp_f32 v164, v164
    v_exp_f32 v165, v165
    v_cvt_pk_bf16_f32 v193, v162, v163
    v_exp_f32 v166, v166
    v_exp_f32 v167, v167
    v_cvt_pk_bf16_f32 v194, v164, v165
    s_waitcnt lgkmcnt(2)
    v_mfma_f32_32x32x16_bf16 v[128:143], v[212:215], v[36:39], v[128:143]
    v_exp_f32 v168, v168
    v_exp_f32 v169, v169
    v_cvt_pk_bf16_f32 v195, v166, v167
    v_exp_f32 v170, v170
    v_exp_f32 v171, v171
    v_cvt_pk_bf16_f32 v196, v168, v169
    v_exp_f32 v172, v172
    v_exp_f32 v173, v173
    v_cvt_pk_bf16_f32 v197, v170, v171
    v_exp_f32 v174, v174
    v_exp_f32 v175, v175
    v_cvt_pk_bf16_f32 v198, v172, v173
    v_mfma_f32_32x32x16_bf16 v[144:159], v[208:211], v[40:43], v[112:127]
    v_cvt_pk_bf16_f32 v199, v174, v175
    v_exp_f32 v176, v176
    v_exp_f32 v177, v177
    v_exp_f32 v178, v178
    v_exp_f32 v179, v179
    v_cvt_pk_bf16_f32 v200, v176, v177
    v_exp_f32 v180, v180
    v_exp_f32 v181, v181
    v_cvt_pk_bf16_f32 v201, v178, v179
    v_exp_f32 v182, v182
    v_exp_f32 v183, v183
    v_cvt_pk_bf16_f32 v202, v180, v181
    v_exp_f32 v184, v184
    v_mfma_f32_32x32x16_bf16 v[144:159], v[212:215], v[44:47], v[144:159]
    v_exp_f32 v185, v185
    v_cvt_pk_bf16_f32 v203, v182, v183
    v_exp_f32 v186, v186
    v_exp_f32 v187, v187
    v_cvt_pk_bf16_f32 v204, v184, v185
    v_exp_f32 v188, v188
    v_exp_f32 v189, v189
    v_cvt_pk_bf16_f32 v205, v186, v187
    v_exp_f32 v190, v190
    v_exp_f32 v191, v191
    v_cvt_pk_bf16_f32 v206, v188, v189
    v_cvt_pk_bf16_f32 v207, v190, v191
    s_waitcnt lgkmcnt(1)
    v_mfma_f32_32x32x16_bf16 v[64:79], v[232:235], v[192:195], v[64:79]
    ds_read_b128 v[216:219], v16 offset:18432
    ds_read_b128 v[220:223], v17 offset:18432
    v_max3_f32 v240, v128, v129, v130
    v_max3_f32 v242, v131, v132, v133
    v_max3_f32 v240, v240, v134, v135
    s_waitcnt lgkmcnt(2)
    v_mfma_f32_32x32x16_bf16 v[64:79], v[236:239], v[196:199], v[64:79]
    v_max3_f32 v242, v242, v136, v137
    v_max3_f32 v240, v240, v138, v139
    v_max3_f32 v242, v242, v140, v141
    v_max3_f32 v240, v240, v142, v143
    v_mfma_f32_32x32x16_bf16 v[80:95], v[232:235], v[200:203], v[80:95]
    v_max_f32 v240, v240, v242
    v_max3_f32 v241, v144, v145, v146
    v_max3_f32 v243, v147, v148, v149
    v_max3_f32 v241, v241, v150, v151
    v_max3_f32 v243, v243, v152, v153
    v_mfma_f32_32x32x16_bf16 v[80:95], v[236:239], v[204:207], v[80:95]
    v_max3_f32 v241, v241, v154, v155
    v_max3_f32 v243, v243, v156, v157
    v_max3_f32 v241, v241, v158, v159
    v_max_f32 v241, v241, v243
    s_waitcnt lgkmcnt(0)
    s_nop 6
    s_barrier
    s_add_u32 m0, s62, 8192
    s_nop 0
    buffer_load_dwordx4 v12, s[44:47], s55 offen offset:0 lds
    buffer_load_dwordx4 v13, s[44:47], s55 offen offset:1024 lds
    s_add_u32 s55, s55, 256
    v_max_f32 v243, v240, v241
    v_cmp_lt_f32 vcc, 16.0, v243
    s_cbranch_vccnz arare_70
aback_71:
    v_mfma_f32_32x32x16_bf16 v[160:175], v[216:219], v[32:35], v[96:111]
    ds_read_b128 v[224:227], v18 offset:16384
    ds_read_b128 v[228:231], v19 offset:16384
    v_exp_f32 v128, v128
    v_exp_f32 v129, v129
    v_exp_f32 v130, v130
    v_exp_f32 v131, v131
    v_cvt_pk_bf16_f32 v192, v128, v129
    v_exp_f32 v132, v132
    v_exp_f32 v133, v133
    v_cvt_pk_bf16_f32 v193, v130, v131
    v_exp_f32 v134, v134
    v_exp_f32 v135, v135
    v_cvt_pk_bf16_f32 v194, v132, v133
    v_mfma_f32_32x32x16_bf16 v[160:175], v[220:223], v[36:39], v[160:175]
    v_exp_f32 v136, v136
    v_exp_f32 v137, v137
    v_cvt_pk_bf16_f32 v195, v134, v135
    v_exp_f32 v138, v138
    v_exp_f32 v139, v139
    v_cvt_pk_bf16_f32 v196, v136, v137
    v_exp_f32 v140, v140
    v_exp_f32 v141, v141
    v_cvt_pk_bf16_f32 v197, v138, v139
    v_exp_f32 v142, v142
    v_exp_f32 v143, v143
    v_cvt_pk_bf16_f32 v198, v140, v141
    v_mfma_f32_32x32x16_bf16 v[176:191], v[216:219], v[40:43], v[112:127]
    v_cvt_pk_bf16_f32 v199, v142, v143
    v_exp_f32 v144, v144
    v_exp_f32 v145, v145
    v_exp_f32 v146, v146
    v_exp_f32 v147, v147
    v_cvt_pk_bf16_f32 v200, v144, v145
    v_exp_f32 v148, v148
    v_exp_f32 v149, v149
    v_cvt_pk_bf16_f32 v201, v146, v147
    v_exp_f32 v150, v150
    v_exp_f32 v151, v151
    v_cvt_pk_bf16_f32 v202, v148, v149
    v_exp_f32 v152, v152
    v_mfma_f32_32x32x16_bf16 v[176:191], v[220:223], v[44:47], v[176:191]
    v_exp_f32 v153, v153
    v_cvt_pk_bf16_f32 v203, v150, v151
    v_exp_f32 v154, v154
    v_exp_f32 v155, v155
    v_cvt_pk_bf16_f32 v204, v152, v153
    v_exp_f32 v156, v156
    v_exp_f32 v157, v157
    v_cvt_pk_bf16_f32 v205, v154, v155
    v_exp_f32 v158, v158
    v_exp_f32 v159, v159
    v_cvt_pk_bf16_f32 v206, v156, v157
    v_cvt_pk_bf16_f32 v207, v158, v159
    s_waitcnt lgkmcnt(1)
    v_mfma_f32_32x32x16_bf16 v[64:79], v[224:227], v[192:195], v[64:79]
    ds_read_b128 v[208:211], v16 offset:20480
    ds_read_b128 v[212:215], v17 offset:20480
    v_max3_f32 v240, v160, v161, v162
    v_max3_f32 v242, v163, v164, v165
    v_max3_f32 v240, v240, v166, v167
    s_waitcnt lgkmcnt(2)
    v_mfma_f32_32x32x16_bf16 v[64:79], v[228:231], v[196:199], v[64:79]
    v_max3_f32 v242, v242, v168, v169
    v_max3_f32 v240, v240, v170, v171
    v_max3_f32 v242, v242, v172, v173
    v_max3_f32 v240, v240, v174, v175
    v_mfma_f32_32x32x16_bf16 v[80:95], v[224:227], v[200:203], v[80:95]
    v_max_f32 v240, v240, v242
    v_max3_f32 v241, v176, v177, v178
    v_max3_f32 v243, v179, v180, v181
    v_max3_f32 v241, v241, v182, v183
    v_max3_f32 v243, v243, v184, v185
    v_mfma_f32_32x32x16_bf16 v[80:95], v[228:231], v[204:207], v[80:95]
    v_max3_f32 v241, v241, v186, v187
    v_max3_f32 v243, v243, v188, v189
    v_max3_f32 v241, v241, v190, v191
    v_max_f32 v241, v241, v243
    v_max_f32 v243, v240, v241
    v_cmp_lt_f32 vcc, 16.0, v243
    s_cbranch_vccnz arare_72
aback_73:
    s_waitcnt lgkmcnt(1)
    v_mfma_f32_32x32x16_bf16 v[128:143], v[208:211], v[32:35], v[96:111]
    ds_read_b128 v[232:235], v20 offset:16384
    ds_read_b128 v[236:239], v21 offset:16384
    v_exp_f32 v160, v160
    v_exp_f32 v161, v161
    v_exp_f32 v162, v162
    v_exp_f32 v163, v163
    v_cvt_pk_bf16_f32 v192, v160, v161
    v_exp_f32 v164, v164
    v_exp_f32 v165, v165
    v_cvt_pk_bf16_f32 v193, v162, v163
    v_exp_f32 v166, v166
    v_exp_f32 v167, v167
    v_cvt_pk_bf16_f32 v194, v164, v165
    s_waitcnt lgkmcnt(2)
    v_mfma_f32_32x32x16_bf16 v[128:143], v[212:215], v[36:39], v[128:143]
    v_exp_f32 v168, v168
    v_exp_f32 v169, v169
    v_cvt_pk_bf16_f32 v195, v166, v167
    v_exp_f32 v170, v170
    v_exp_f32 v171, v171
    v_cvt_pk_bf16_f32 v196, v168, v169
    v_exp_f32 v172, v172
    v_exp_f32 v173, v173
    v_cvt_pk_bf16_f32 v197, v170, v171
    v_exp_f32 v174, v174
    v_exp_f32 v175, v175
    v_cvt_pk_bf16_f32 v198, v172, v173
    v_mfma_f32_32x32x16_bf16 v[144:159], v[208:211], v[40:43], v[112:127]
    v_cvt_pk_bf16_f32 v199, v174, v175
    v_exp_f32 v176, v176
    v_exp_f32 v177, v177
    v_exp_f32 v178, v178
    v_exp_f32 v179, v179
    v_cvt_pk_bf16_f32 v200, v176, v177
    v_exp_f32 v180, v180
    v_exp_f32 v181, v181
    v_cvt_pk_bf16_f32 v201, v178, v179
    v_exp_f32 v182, v182
    v_exp_f32 v183, v183
    v_cvt_pk_bf16_f32 v202, v180, v181
    v_exp_f32 v184, v184
    v_mfma_f32_32x32x16_bf16 v[144:159], v[212:215], v[44:47], v[144:159]
    v_exp_f32 v185, v185
    v_cvt_pk_bf16_f32 v203, v182, v183
    v_exp_f32 v186, v186
    v_exp_f32 v187, v187
    v_cvt_pk_bf16_f32 v204, v184, v185
    v_exp_f32 v188, v188
    v_exp_f32 v189, v189
    v_cvt_pk_bf16_f32 v205, v186, v187
    v_exp_f32 v190, v190
    v_exp_f32 v191, v191
    v_cvt_pk_bf16_f32 v206, v188, v189
    v_cvt_pk_bf16_f32 v207, v190, v191
    s_waitcnt lgkmcnt(1)
    v_mfma_f32_32x32x16_bf16 v[64:79], v[232:235], v[192:195], v[64:79]
    ds_read_b128 v[216:219], v16 offset:22528
    ds_read_b128 v[220:223], v17 offset:22528
    v_max3_f32 v240, v128, v129, v130
    v_max3_f32 v242, v131, v132, v133
    v_max3_f32 v240, v240, v134, v135
    s_waitcnt lgkmcnt(2)
    v_mfma_f32_32x32x16_bf16 v[64:79], v[236:239], v[196:199], v[64:79]
    v_max3_f32 v242, v242, v136, v137
    v_max3_f32 v240, v240, v138, v139
    v_max3_f32 v242, v242, v140, v141
    v_max3_f32 v240, v240, v142, v143
    v_mfma_f32_32x32x16_bf16 v[80:95], v[232:235], v[200:203], v[80:95]
    v_max_f32 v240, v240, v242
    v_max3_f32 v241, v144, v145, v146
    v_max3_f32 v243, v147, v148, v149
    v_max3_f32 v241, v241, v150, v151
    v_max3_f32 v243, v243, v152, v153
    v_mfma_f32_32x32x16_bf16 v[80:95], v[236:239], v[204:207], v[80:95]
    v_max3_f32 v241, v241, v154, v155
    v_max3_f32 v243, v243, v156, v157
    v_max3_f32 v241, v241, v158, v159
    v_max_f32 v241, v241, v243
    s_waitcnt vmcnt(0)
    s_waitcnt lgkmcnt(0)
    s_nop 5
    s_barrier
    s_add_u32 m0, s62, 16384
    s_nop 0
    buffer_load_dwordx4 v8, s[40:43], s54 offen offset:0 lds
    buffer_load_dwordx4 v8, s[40:43], s54 offen offset:1024 lds
    s_add_u32 s54, s54, 8192
    v_max_f32 v243, v240, v241
    v_cmp_lt_f32 vcc, 16.0, v243
    s_cbranch_vccnz arare_74
aback_75:
    v_mfma_f32_32x32x16_bf16 v[160:175], v[216:219], v[32:35], v[96:111]
    ds_read_b128 v[224:227], v22 offset:16384
    ds_read_b128 v[228:231], v23 offset:16384
    v_exp_f32 v128, v128
    v_exp_f32 v129, v129
    v_exp_f32 v130, v130
    v_exp_f32 v131, v131
    v_cvt_pk_bf16_f32 v192, v128, v129
    v_exp_f32 v132, v132
    v_exp_f32 v133, v133
    v_cvt_pk_bf16_f32 v193, v130, v131
    v_exp_f32 v134, v134
    v_exp_f32 v135, v135
    v_cvt_pk_bf16_f32 v194, v132, v133
    v_mfma_f32_32x32x16_bf16 v[160:175], v[220:223], v[36:39], v[160:175]
    v_exp_f32 v136, v136
    v_exp_f32 v137, v137
    v_cvt_pk_bf16_f32 v195, v134, v135
    v_exp_f32 v138, v138
    v_exp_f32 v139, v139
    v_cvt_pk_bf16_f32 v196, v136, v137
    v_exp_f32 v140, v140
    v_exp_f32 v141, v141
    v_cvt_pk_bf16_f32 v197, v138, v139
    v_exp_f32 v142, v142
    v_exp_f32 v143, v143
    v_cvt_pk_bf16_f32 v198, v140, v141
    v_mfma_f32_32x32x16_bf16 v[176:191], v[216:219], v[40:43], v[112:127]
    v_cvt_pk_bf16_f32 v199, v142, v143
    v_exp_f32 v144, v144
    v_exp_f32 v145, v145
    v_exp_f32 v146, v146
    v_exp_f32 v147, v147
    v_cvt_pk_bf16_f32 v200, v144, v145
    v_exp_f32 v148, v148
    v_exp_f32 v149, v149
    v_cvt_pk_bf16_f32 v201, v146, v147
    v_exp_f32 v150, v150
    v_exp_f32 v151, v151
    v_cvt_pk_bf16_f32 v202, v148, v149
    v_exp_f32 v152, v152
    v_mfma_f32_32x32x16_bf16 v[176:191], v[220:223], v[44:47], v[176:191]
    v_exp_f32 v153, v153
    v_cvt_pk_bf16_f32 v203, v150, v151
    v_exp_f32 v154, v154
    v_exp_f32 v155, v155
    v_cvt_pk_bf16_f32 v204, v152, v153
    v_exp_f32 v156, v156
    v_exp_f32 v157, v157
    v_cvt_pk_bf16_f32 v205, v154, v155
    v_exp_f32 v158, v158
    v_exp_f32 v159, v159
    v_cvt_pk_bf16_f32 v206, v156, v157
    v_cvt_pk_bf16_f32 v207, v158, v159
    s_waitcnt lgkmcnt(1)
    v_mfma_f32_32x32x16_bf16 v[64:79], v[224:227], v[192:195], v[64:79]
    ds_read_b128 v[208:211], v16 offset:0
    ds_read_b128 v[212:215], v17 offset:0
    v_max3_f32 v240, v160, v161, v162
    v_max3_f32 v242, v163, v164, v165
    v_max3_f32 v240, v240, v166, v167
    s_waitcnt lgkmcnt(2)
    v_mfma_f32_32x32x16_bf16 v[64:79], v[228:231], v[196:199], v[64:79]
    v_max3_f32 v242, v242, v168, v169
    v_max3_f32 v240, v240, v170, v171
    v_max3_f32 v242, v242, v172, v173
    v_max3_f32 v240, v240, v174, v175
    v_mfma_f32_32x32x16_bf16 v[80:95], v[224:227], v[200:203], v[80:95]
    v_max_f32 v240, v240, v242
    v_max3_f32 v241, v176, v177, v178
    v_max3_f32 v243, v179, v180, v181
    v_max3_f32 v241, v241, v182, v183
    v_max3_f32 v243, v243, v184, v185
    v_mfma_f32_32x32x16_bf16 v[80:95], v[228:231], v[204:207], v[80:95]
    v_max3_f32 v241, v241, v186, v187
    v_max3_f32 v243, v243, v188, v189
    v_max3_f32 v241, v241, v190, v191
    v_max_f32 v241, v241, v243
    v_max_f32 v243, v240, v241
    v_cmp_lt_f32 vcc, 16.0, v243
    s_cbranch_vccnz arare_76
aback_77:
    s_waitcnt lgkmcnt(1)
    v_mfma_f32_32x32x16_bf16 v[128:143], v[208:211], v[32:35], v[96:111]
    ds_read_b128 v[232:235], v24 offset:16384
    ds_read_b128 v[236:239], v25 offset:16384
    v_exp_f32 v160, v160
    v_exp_f32 v161, v161
    v_exp_f32 v162, v162
    v_exp_f32 v163, v163
    v_cvt_pk_bf16_f32 v192, v160, v161
    v_exp_f32 v164, v164
    v_exp_f32 v165, v165
    v_cvt_pk_bf16_f32 v193, v162, v163
    v_exp_f32 v166, v166
    v_exp_f32 v167, v167
    v_cvt_pk_bf16_f32 v194, v164, v165
    s_waitcnt lgkmcnt(2)
    v_mfma_f32_32x32x16_bf16 v[128:143], v[212:215], v[36:39], v[128:143]
    v_exp_f32 v168, v168
    v_exp_f32 v169, v169
    v_cvt_pk_bf16_f32 v195, v166, v167
    v_exp_f32 v170, v170
    v_exp_f32 v171, v171
    v_cvt_pk_bf16_f32 v196, v168, v169
    v_exp_f32 v172, v172
    v_exp_f32 v173, v173
    v_cvt_pk_bf16_f32 v197, v170, v171
    v_exp_f32 v174, v174
    v_exp_f32 v175, v175
    v_cvt_pk_bf16_f32 v198, v172, v173
    v_mfma_f32_32x32x16_bf16 v[144:159], v[208:211], v[40:43], v[112:127]
    v_cvt_pk_bf16_f32 v199, v174, v175
    v_exp_f32 v176, v176
    v_exp_f32 v177, v177
    v_exp_f32 v178, v178
    v_exp_f32 v179, v179
    v_cvt_pk_bf16_f32 v200, v176, v177
    v_exp_f32 v180, v180
    v_exp_f32 v181, v181
    v_cvt_pk_bf16_f32 v201, v178, v179
    v_exp_f32 v182, v182
    v_exp_f32 v183, v183
    v_cvt_pk_bf16_f32 v202, v180, v181
    v_exp_f32 v184, v184
    v_mfma_f32_32x32x16_bf16 v[144:159], v[212:215], v[44:47], v[144:159]
    v_exp_f32 v185, v185
    v_cvt_pk_bf16_f32 v203, v182, v183
    v_exp_f32 v186, v186
    v_exp_f32 v187, v187
    v_cvt_pk_bf16_f32 v204, v184, v185
    v_exp_f32 v188, v188
    v_exp_f32 v189, v189
    v_cvt_pk_bf16_f32 v205, v186, v187
    v_exp_f32 v190, v190
    v_exp_f32 v191, v191
    v_cvt_pk_bf16_f32 v206, v188, v189
    v_cvt_pk_bf16_f32 v207, v190, v191
    s_waitcnt lgkmcnt(1)
    v_mfma_f32_32x32x16_bf16 v[64:79], v[232:235], v[192:195], v[64:79]
    ds_read_b128 v[216:219], v16 offset:2048
    ds_read_b128 v[220:223], v17 offset:2048
    v_max3_f32 v240, v128, v129, v130
    v_max3_f32 v242, v131, v132, v133
    v_max3_f32 v240, v240, v134, v135
    s_waitcnt lgkmcnt(2)
    v_mfma_f32_32x32x16_bf16 v[64:79], v[236:239], v[196:199], v[64:79]
    v_max3_f32 v242, v242, v136, v137
    v_max3_f32 v240, v240, v138, v139
    v_max3_f32 v242, v242, v140, v141
    v_max3_f32 v240, v240, v142, v143
    v_mfma_f32_32x32x16_bf16 v[80:95], v[232:235], v[200:203], v[80:95]
    v_max_f32 v240, v240, v242
    v_max3_f32 v241, v144, v145, v146
    v_max3_f32 v243, v147, v148, v149
    v_max3_f32 v241, v241, v150, v151
    v_max3_f32 v243, v243, v152, v153
    v_mfma_f32_32x32x16_bf16 v[80:95], v[236:239], v[204:207], v[80:95]
    v_max3_f32 v241, v241, v154, v155
    v_max3_f32 v243, v243, v156, v157
    v_max3_f32 v241, v241, v158, v159
    v_max_f32 v241, v241, v243
    s_waitcnt lgkmcnt(0)
    s_nop 6
    s_barrier
    s_add_u32 m0, s62, 24576
    s_nop 0
    buffer_load_dwordx4 v12, s[44:47], s55 offen offset:0 lds
    buffer_load_dwordx4 v13, s[44:47], s55 offen offset:1024 lds
    s_add_u32 s55, s55, 256
    s_sub_u32 s56, s56, 1
    s_cmp_lg_u32 s56, 0
    s_cbranch_scc1 al_61
    s_add_u32 s48, s38, 62914560
    s_addc_u32 s49, s39, 0
    s_and_b32 s49, s49, 0xffff
    s_mov_b32 s50, 2621440
    s_mov_b32 s51, 0x00020000
    v_and_b32 v2, 31, v1
    s_lshl_b32 s60, s52, 8
    s_lshl_b32 s61, s57, 6
    s_add_u32 s60, s60, s61
    v_add_u32 v2, s60, v2
    v_lshlrev_b32 v2, 5, v2
    v_lshrrev_b32 v3, 5, v1
    v_lshlrev_b32 v3, 2, v3
    s_mul_i32 s60, s53, 20
    v_add_u32 v3, s60, v3
    v_add_u32 v4, 0, v3
    v_lshrrev_b32 v5, 4, v4
    v_and_b32 v4, 15, v4
    v_lshlrev_b32 v5, 16, v5
    v_lshl_add_u32 v5, v4, 1, v5
    v_add_u32 v160, v5, v2
    v_add_u32 v4, 8, v3
    v_lshrrev_b32 v5, 4, v4
    v_and_b32 v4, 15, v4
    v_lshlrev_b32 v5, 16, v5
    v_lshl_add_u32 v5, v4, 1, v5
    v_add_u32 v161, v5, v2
    v_add_u32 v4, 16, v3
    v_lshrrev_b32 v5, 4, v4
    v_and_b32 v4, 15, v4
    v_lshlrev_b32 v5, 16, v5
    v_lshl_add_u32 v5, v4, 1, v5
    v_add_u32 v162, v5, v2
    v_mov_b32 v242, v72
    v_mov_b32 v243, v72
    s_nop 1
    v_permlane32_swap_b32 v242, v243
    v_rcp_f32 v243, v243
    s_nop 0
    v_mul_f32 v130, v64, v243
    v_mul_f32 v131, v65, v243
    v_mul_f32 v132, v66, v243
    v_mul_f32 v133, v67, v243
    v_cvt_pk_bf16_f32 v128, v130, v131
    v_cvt_pk_bf16_f32 v129, v132, v133
    buffer_store_dwordx2 v[128:129], v160, s[48:51], 0 offen offset:0
    v_mul_f32 v138, v68, v243
    v_mul_f32 v139, v69, v243
    v_mul_f32 v140, v70, v243
    v_mul_f32 v141, v71, v243
    v_cvt_pk_bf16_f32 v136, v138, v139
    v_cvt_pk_bf16_f32 v137, v140, v141
    buffer_store_dwordx2 v[136:137], v161, s[48:51], 0 offen offset:0
    v_mul_f32 v146, v72, v243
    v_mul_f32 v147, v73, v243
    v_mul_f32 v148, v74, v243
    v_mul_f32 v149, v75, v243
    v_cvt_pk_bf16_f32 v144, v146, v147
    v_cvt_pk_bf16_f32 v145, v148, v149
    v_cmp_gt_u32 vcc, 32, v1
    s_and_saveexec_b64 s[68:69], vcc
    buffer_store_dwordx2 v[144:145], v162, s[48:51], 0 offen offset:0
    s_mov_b64 exec, s[68:69]
    v_mov_b32 v242, v88
    v_mov_b32 v243, v88
    s_nop 1
    v_permlane32_swap_b32 v242, v243
    v_rcp_f32 v243, v243
    s_nop 0
    v_mul_f32 v130, v80, v243
    v_mul_f32 v131, v81, v243
    v_mul_f32 v132, v82, v243
    v_mul_f32 v133, v83, v243
    v_cvt_pk_bf16_f32 v128, v130, v131
    v_cvt_pk_bf16_f32 v129, v132, v133
    buffer_store_dwordx2 v[128:129], v160, s[48:51], 0 offen offset:1024
    v_mul_f32 v138, v84, v243
    v_mul_f32 v139, v85, v243
    v_mul_f32 v140, v86, v243
    v_mul_f32 v141, v87, v243
    v_cvt_pk_bf16_f32 v136, v138, v139
    v_cvt_pk_bf16_f32 v137, v140, v141
    buffer_store_dwordx2 v[136:137], v161, s[48:51], 0 offen offset:1024
    v_mul_f32 v146, v88, v243
    v_mul_f32 v147, v89, v243
    v_mul_f32 v148, v90, v243
    v_mul_f32 v149, v91, v243
    v_cvt_pk_bf16_f32 v144, v146, v147
    v_cvt_pk_bf16_f32 v145, v148, v149
    v_cmp_gt_u32 vcc, 32, v1
    s_and_saveexec_b64 s[68:69], vcc
    buffer_store_dwordx2 v[144:145], v162, s[48:51], 0 offen offset:1024
    s_mov_b64 exec, s[68:69]
    s_endpgm
    s_nop 0
arare_62:
    s_nop 15
    v_max3_f32 v240, v128, v129, v130
    v_max3_f32 v242, v131, v132, v133
    v_max3_f32 v240, v240, v134, v135
    v_max3_f32 v242, v242, v136, v137
    v_max3_f32 v240, v240, v138, v139
    v_max3_f32 v242, v242, v140, v141
    v_max3_f32 v240, v240, v142, v143
    v_max_f32 v240, v240, v242
    v_mov_b32 v242, v240
    v_mov_b32 v243, v240
    s_nop 1
    v_permlane32_swap_b32 v242, v243
    v_max_f32 v240, v242, v243
    v_max_f32 v240, 0, v240
    v_sub_f32 v128, v128, v240
    v_sub_f32 v96, v96, v240
    v_sub_f32 v129, v129, v240
    v_sub_f32 v97, v97, v240
    v_sub_f32 v130, v130, v240
    v_sub_f32 v98, v98, v240
    v_sub_f32 v131, v131, v240
    v_sub_f32 v99, v99, v240
    v_sub_f32 v132, v132, v240
    v_sub_f32 v100, v100, v240
    v_sub_f32 v133, v133, v240
    v_sub_f32 v101, v101, v240
    v_sub_f32 v134, v134, v240
    v_sub_f32 v102, v102, v240
    v_sub_f32 v135, v135, v240
    v_sub_f32 v103, v103, v240
    v_sub_f32 v136, v136, v240
    v_sub_f32 v104, v104, v240
    v_sub_f32 v137, v137, v240
    v_sub_f32 v105, v105, v240
    v_sub_f32 v138, v138, v240
    v_sub_f32 v106, v106, v240
    v_sub_f32 v139, v139, v240
    v_sub_f32 v107, v107, v240
    v_sub_f32 v140, v140, v240
    v_sub_f32 v108, v108, v240
    v_sub_f32 v141, v141, v240
    v_sub_f32 v109, v109, v240
    v_sub_f32 v142, v142, v240
    v_sub_f32 v110, v110, v240
    v_sub_f32 v143, v143, v240
    v_sub_f32 v111, v111, v240
    v_sub_f32 v242, 0, v240
    v_exp_f32 v242, v242
    s_nop 0
    v_mul_f32 v64, v64, v242
    v_mul_f32 v65, v65, v242
    v_mul_f32 v66, v66, v242
    v_mul_f32 v67, v67, v242
    v_mul_f32 v68, v68, v242
    v_mul_f32 v69, v69, v242
    v_mul_f32 v70, v70, v242
    v_mul_f32 v71, v71, v242
    v_mul_f32 v72, v72, v242
    v_mul_f32 v73, v73, v242
    v_mul_f32 v74, v74, v242
    v_mul_f32 v75, v75, v242
    v_mul_f32 v76, v76, v242
    v_mul_f32 v77, v77, v242
    v_mul_f32 v78, v78, v242
    v_mul_f32 v79, v79, v242
    s_nop 1
    v_max3_f32 v241, v144, v145, v146
    v_max3_f32 v242, v147, v148, v149
    v_max3_f32 v241, v241, v150, v151
    v_max3_f32 v242, v242, v152, v153
    v_max3_f32 v241, v241, v154, v155
    v_max3_f32 v242, v242, v156, v157
    v_max3_f32 v241, v241, v158, v159
    v_max_f32 v241, v241, v242
    v_mov_b32 v242, v241
    v_mov_b32 v243, v241
    s_nop 1
    v_permlane32_swap_b32 v242, v243
    v_max_f32 v241, v242, v243
    v_max_f32 v241, 0, v241
    v_sub_f32 v144, v144, v241
    v_sub_f32 v112, v112, v241
    v_sub_f32 v145, v145, v241
    v_sub_f32 v113, v113, v241
    v_sub_f32 v146, v146, v241
    v_sub_f32 v114, v114, v241
    v_sub_f32 v147, v147, v241
    v_sub_f32 v115, v115, v241
    v_sub_f32 v148, v148, v241
    v_sub_f32 v116, v116, v241
    v_sub_f32 v149, v149, v241
    v_sub_f32 v117, v117, v241
    v_sub_f32 v150, v150, v241
    v_sub_f32 v118, v118, v241
    v_sub_f32 v151, v151, v241
    v_sub_f32 v119, v119, v241
    v_sub_f32 v152, v152, v241
    v_sub_f32 v120, v120, v241
    v_sub_f32 v153, v153, v241
    v_sub_f32 v121, v121, v241
    v_sub_f32 v154, v154, v241
    v_sub_f32 v122, v122, v241
    v_sub_f32 v155, v155, v241
    v_sub_f32 v123, v123, v241
    v_sub_f32 v156, v156, v241
    v_sub_f32 v124, v124, v241
    v_sub_f32 v157, v157, v241
    v_sub_f32 v125, v125, v241
    v_sub_f32 v158, v158, v241
    v_sub_f32 v126, v126, v241
    v_sub_f32 v159, v159, v241
    v_sub_f32 v127, v127, v241
    v_sub_f32 v242, 0, v241
    v_exp_f32 v242, v242
    s_nop 0
    v_mul_f32 v80, v80, v242
    v_mul_f32 v81, v81, v242
    v_mul_f32 v82, v82, v242
    v_mul_f32 v83, v83, v242
    v_mul_f32 v84, v84, v242
    v_mul_f32 v85, v85, v242
    v_mul_f32 v86, v86, v242
    v_mul_f32 v87, v87, v242
    v_mul_f32 v88, v88, v242
    v_mul_f32 v89, v89, v242
    v_mul_f32 v90, v90, v242
    v_mul_f32 v91, v91, v242
    v_mul_f32 v92, v92, v242
    v_mul_f32 v93, v93, v242
    v_mul_f32 v94, v94, v242
    v_mul_f32 v95, v95, v242
    s_nop 1
    s_branch aback_63
arare_64:
    s_nop 15
    v_max3_f32 v240, v160, v161, v162
    v_max3_f32 v242, v163, v164, v165
    v_max3_f32 v240, v240, v166, v167
    v_max3_f32 v242, v242, v168, v169
    v_max3_f32 v240, v240, v170, v171
    v_max3_f32 v242, v242, v172, v173
    v_max3_f32 v240, v240, v174, v175
    v_max_f32 v240, v240, v242
    v_mov_b32 v242, v240
    v_mov_b32 v243, v240
    s_nop 1
    v_permlane32_swap_b32 v242, v243
    v_max_f32 v240, v242, v243
    v_max_f32 v240, 0, v240
    v_sub_f32 v160, v160, v240
    v_sub_f32 v96, v96, v240
    v_sub_f32 v161, v161, v240
    v_sub_f32 v97, v97, v240
    v_sub_f32 v162, v162, v240
    v_sub_f32 v98, v98, v240
    v_sub_f32 v163, v163, v240
    v_sub_f32 v99, v99, v240
    v_sub_f32 v164, v164, v240
    v_sub_f32 v100, v100, v240
    v_sub_f32 v165, v165, v240
    v_sub_f32 v101, v101, v240
    v_sub_f32 v166, v166, v240
    v_sub_f32 v102, v102, v240
    v_sub_f32 v167, v167, v240
    v_sub_f32 v103, v103, v240
    v_sub_f32 v168, v168, v240
    v_sub_f32 v104, v104, v240
    v_sub_f32 v169, v169, v240
    v_sub_f32 v105, v105, v240
    v_sub_f32 v170, v170, v240
    v_sub_f32 v106, v106, v240
    v_sub_f32 v171, v171, v240
    v_sub_f32 v107, v107, v240
    v_sub_f32 v172, v172, v240
    v_sub_f32 v108, v108, v240
    v_sub_f32 v173, v173, v240
    v_sub_f32 v109, v109, v240
    v_sub_f32 v174, v174, v240
    v_sub_f32 v110, v110, v240
    v_sub_f32 v175, v175, v240
    v_sub_f32 v111, v111, v240
    v_sub_f32 v242, 0, v240
    v_exp_f32 v242, v242
    s_nop 0
    v_mul_f32 v64, v64, v242
    v_mul_f32 v65, v65, v242
    v_mul_f32 v66, v66, v242
    v_mul_f32 v67, v67, v242
    v_mul_f32 v68, v68, v242
    v_mul_f32 v69, v69, v242
    v_mul_f32 v70, v70, v242
    v_mul_f32 v71, v71, v242
    v_mul_f32 v72, v72, v242
    v_mul_f32 v73, v73, v242
    v_mul_f32 v74, v74, v242
    v_mul_f32 v75, v75, v242
    v_mul_f32 v76, v76, v242
    v_mul_f32 v77, v77, v242
    v_mul_f32 v78, v78, v242
    v_mul_f32 v79, v79, v242
    s_nop 1
    v_max3_f32 v241, v176, v177, v178
    v_max3_f32 v242, v179, v180, v181
    v_max3_f32 v241, v241, v182, v183
    v_max3_f32 v242, v242, v184, v185
    v_max3_f32 v241, v241, v186, v187
    v_max3_f32 v242, v242, v188, v189
    v_max3_f32 v241, v241, v190, v191
    v_max_f32 v241, v241, v242
    v_mov_b32 v242, v241
    v_mov_b32 v243, v241
    s_nop 1
    v_permlane32_swap_b32 v242, v243
    v_max_f32 v241, v242, v243
    v_max_f32 v241, 0, v241
    v_sub_f32 v176, v176, v241
    v_sub_f32 v112, v112, v241
    v_sub_f32 v177, v177, v241
    v_sub_f32 v113, v113, v241
    v_sub_f32 v178, v178, v241
    v_sub_f32 v114, v114, v241
    v_sub_f32 v179, v179, v241
    v_sub_f32 v115, v115, v241
    v_sub_f32 v180, v180, v241
    v_sub_f32 v116, v116, v241
    v_sub_f32 v181, v181, v241
    v_sub_f32 v117, v117, v241
    v_sub_f32 v182, v182, v241
    v_sub_f32 v118, v118, v241
    v_sub_f32 v183, v183, v241
    v_sub_f32 v119, v119, v241
    v_sub_f32 v184, v184, v241
    v_sub_f32 v120, v120, v241
    v_sub_f32 v185, v185, v241
    v_sub_f32 v121, v121, v241
    v_sub_f32 v186, v186, v241
    v_sub_f32 v122, v122, v241
    v_sub_f32 v187, v187, v241
    v_sub_f32 v123, v123, v241
    v_sub_f32 v188, v188, v241
    v_sub_f32 v124, v124, v241
    v_sub_f32 v189, v189, v241
    v_sub_f32 v125, v125, v241
    v_sub_f32 v190, v190, v241
    v_sub_f32 v126, v126, v241
    v_sub_f32 v191, v191, v241
    v_sub_f32 v127, v127, v241
    v_sub_f32 v242, 0, v241
    v_exp_f32 v242, v242
    s_nop 0
    v_mul_f32 v80, v80, v242
    v_mul_f32 v81, v81, v242
    v_mul_f32 v82, v82, v242
    v_mul_f32 v83, v83, v242
    v_mul_f32 v84, v84, v242
    v_mul_f32 v85, v85, v242
    v_mul_f32 v86, v86, v242
    v_mul_f32 v87, v87, v242
    v_mul_f32 v88, v88, v242
    v_mul_f32 v89, v89, v242
    v_mul_f32 v90, v90, v242
    v_mul_f32 v91, v91, v242
    v_mul_f32 v92, v92, v242
    v_mul_f32 v93, v93, v242
    v_mul_f32 v94, v94, v242
    v_mul_f32 v95, v95, v242
    s_nop 1
    s_branch aback_65
arare_66:
    s_nop 15
    v_max3_f32 v240, v128, v129, v130
    v_max3_f32 v242, v131, v132, v133
    v_max3_f32 v240, v240, v134, v135
    v_max3_f32 v242, v242, v136, v137
    v_max3_f32 v240, v240, v138, v139
    v_max3_f32 v242, v242, v140, v141
    v_max3_f32 v240, v240, v142, v143
    v_max_f32 v240, v240, v242
    v_mov_b32 v242, v240
    v_mov_b32 v243, v240
    s_nop 1
    v_permlane32_swap_b32 v242, v243
    v_max_f32 v240, v242, v243
    v_max_f32 v240, 0, v240
    v_sub_f32 v128, v128, v240
    v_sub_f32 v96, v96, v240
    v_sub_f32 v129, v129, v240
    v_sub_f32 v97, v97, v240
    v_sub_f32 v130, v130, v240
    v_sub_f32 v98, v98, v240
    v_sub_f32 v131, v131, v240
    v_sub_f32 v99, v99, v240
    v_sub_f32 v132, v132, v240
    v_sub_f32 v100, v100, v240
    v_sub_f32 v133, v133, v240
    v_sub_f32 v101, v101, v240
    v_sub_f32 v134, v134, v240
    v_sub_f32 v102, v102, v240
    v_sub_f32 v135, v135, v240
    v_sub_f32 v103, v103, v240
    v_sub_f32 v136, v136, v240
    v_sub_f32 v104, v104, v240
    v_sub_f32 v137, v137, v240
    v_sub_f32 v105, v105, v240
    v_sub_f32 v138, v138, v240
    v_sub_f32 v106, v106, v240
    v_sub_f32 v139, v139, v240
    v_sub_f32 v107, v107, v240
    v_sub_f32 v140, v140, v240
    v_sub_f32 v108, v108, v240
    v_sub_f32 v141, v141, v240
    v_sub_f32 v109, v109, v240
    v_sub_f32 v142, v142, v240
    v_sub_f32 v110, v110, v240
    v_sub_f32 v143, v143, v240
    v_sub_f32 v111, v111, v240
    v_sub_f32 v242, 0, v240
    v_exp_f32 v242, v242
    s_nop 0
    v_mul_f32 v64, v64, v242
    v_mul_f32 v65, v65, v242
    v_mul_f32 v66, v66, v242
    v_mul_f32 v67, v67, v242
    v_mul_f32 v68, v68, v242
    v_mul_f32 v69, v69, v242
    v_mul_f32 v70, v70, v242
    v_mul_f32 v71, v71, v242
    v_mul_f32 v72, v72, v242
    v_mul_f32 v73, v73, v242
    v_mul_f32 v74, v74, v242
    v_mul_f32 v75, v75, v242
    v_mul_f32 v76, v76, v242
    v_mul_f32 v77, v77, v242
    v_mul_f32 v78, v78, v242
    v_mul_f32 v79, v79, v242
    s_nop 1
    v_max3_f32 v241, v144, v145, v146
    v_max3_f32 v242, v147, v148, v149
    v_max3_f32 v241, v241, v150, v151
    v_max3_f32 v242, v242, v152, v153
    v_max3_f32 v241, v241, v154, v155
    v_max3_f32 v242, v242, v156, v157
    v_max3_f32 v241, v241, v158, v159
    v_max_f32 v241, v241, v242
    v_mov_b32 v242, v241
    v_mov_b32 v243, v241
    s_nop 1
    v_permlane32_swap_b32 v242, v243
    v_max_f32 v241, v242, v243
    v_max_f32 v241, 0, v241
    v_sub_f32 v144, v144, v241
    v_sub_f32 v112, v112, v241
    v_sub_f32 v145, v145, v241
    v_sub_f32 v113, v113, v241
    v_sub_f32 v146, v146, v241
    v_sub_f32 v114, v114, v241
    v_sub_f32 v147, v147, v241
    v_sub_f32 v115, v115, v241
    v_sub_f32 v148, v148, v241
    v_sub_f32 v116, v116, v241
    v_sub_f32 v149, v149, v241
    v_sub_f32 v117, v117, v241
    v_sub_f32 v150, v150, v241
    v_sub_f32 v118, v118, v241
    v_sub_f32 v151, v151, v241
    v_sub_f32 v119, v119, v241
    v_sub_f32 v152, v152, v241
    v_sub_f32 v120, v120, v241
    v_sub_f32 v153, v153, v241
    v_sub_f32 v121, v121, v241
    v_sub_f32 v154, v154, v241
    v_sub_f32 v122, v122, v241
    v_sub_f32 v155, v155, v241
    v_sub_f32 v123, v123, v241
    v_sub_f32 v156, v156, v241
    v_sub_f32 v124, v124, v241
    v_sub_f32 v157, v157, v241
    v_sub_f32 v125, v125, v241
    v_sub_f32 v158, v158, v241
    v_sub_f32 v126, v126, v241
    v_sub_f32 v159, v159, v241
    v_sub_f32 v127, v127, v241
    v_sub_f32 v242, 0, v241
    v_exp_f32 v242, v242
    s_nop 0
    v_mul_f32 v80, v80, v242
    v_mul_f32 v81, v81, v242
    v_mul_f32 v82, v82, v242
    v_mul_f32 v83, v83, v242
    v_mul_f32 v84, v84, v242
    v_mul_f32 v85, v85, v242
    v_mul_f32 v86, v86, v242
    v_mul_f32 v87, v87, v242
    v_mul_f32 v88, v88, v242
    v_mul_f32 v89, v89, v242
    v_mul_f32 v90, v90, v242
    v_mul_f32 v91, v91, v242
    v_mul_f32 v92, v92, v242
    v_mul_f32 v93, v93, v242
    v_mul_f32 v94, v94, v242
    v_mul_f32 v95, v95, v242
    s_nop 1
    s_branch aback_67
arare_68:
    s_nop 15
    v_max3_f32 v240, v160, v161, v162
    v_max3_f32 v242, v163, v164, v165
    v_max3_f32 v240, v240, v166, v167
    v_max3_f32 v242, v242, v168, v169
    v_max3_f32 v240, v240, v170, v171
    v_max3_f32 v242, v242, v172, v173
    v_max3_f32 v240, v240, v174, v175
    v_max_f32 v240, v240, v242
    v_mov_b32 v242, v240
    v_mov_b32 v243, v240
    s_nop 1
    v_permlane32_swap_b32 v242, v243
    v_max_f32 v240, v242, v243
    v_max_f32 v240, 0, v240
    v_sub_f32 v160, v160, v240
    v_sub_f32 v96, v96, v240
    v_sub_f32 v161, v161, v240
    v_sub_f32 v97, v97, v240
    v_sub_f32 v162, v162, v240
    v_sub_f32 v98, v98, v240
    v_sub_f32 v163, v163, v240
    v_sub_f32 v99, v99, v240
    v_sub_f32 v164, v164, v240
    v_sub_f32 v100, v100, v240
    v_sub_f32 v165, v165, v240
    v_sub_f32 v101, v101, v240
    v_sub_f32 v166, v166, v240
    v_sub_f32 v102, v102, v240
    v_sub_f32 v167, v167, v240
    v_sub_f32 v103, v103, v240
    v_sub_f32 v168, v168, v240
    v_sub_f32 v104, v104, v240
    v_sub_f32 v169, v169, v240
    v_sub_f32 v105, v105, v240
    v_sub_f32 v170, v170, v240
    v_sub_f32 v106, v106, v240
    v_sub_f32 v171, v171, v240
    v_sub_f32 v107, v107, v240
    v_sub_f32 v172, v172, v240
    v_sub_f32 v108, v108, v240
    v_sub_f32 v173, v173, v240
    v_sub_f32 v109, v109, v240
    v_sub_f32 v174, v174, v240
    v_sub_f32 v110, v110, v240
    v_sub_f32 v175, v175, v240
    v_sub_f32 v111, v111, v240
    v_sub_f32 v242, 0, v240
    v_exp_f32 v242, v242
    s_nop 0
    v_mul_f32 v64, v64, v242
    v_mul_f32 v65, v65, v242
    v_mul_f32 v66, v66, v242
    v_mul_f32 v67, v67, v242
    v_mul_f32 v68, v68, v242
    v_mul_f32 v69, v69, v242
    v_mul_f32 v70, v70, v242
    v_mul_f32 v71, v71, v242
    v_mul_f32 v72, v72, v242
    v_mul_f32 v73, v73, v242
    v_mul_f32 v74, v74, v242
    v_mul_f32 v75, v75, v242
    v_mul_f32 v76, v76, v242
    v_mul_f32 v77, v77, v242
    v_mul_f32 v78, v78, v242
    v_mul_f32 v79, v79, v242
    s_nop 1
    v_max3_f32 v241, v176, v177, v178
    v_max3_f32 v242, v179, v180, v181
    v_max3_f32 v241, v241, v182, v183
    v_max3_f32 v242, v242, v184, v185
    v_max3_f32 v241, v241, v186, v187
    v_max3_f32 v242, v242, v188, v189
    v_max3_f32 v241, v241, v190, v191
    v_max_f32 v241, v241, v242
    v_mov_b32 v242, v241
    v_mov_b32 v243, v241
    s_nop 1
    v_permlane32_swap_b32 v242, v243
    v_max_f32 v241, v242, v243
    v_max_f32 v241, 0, v241
    v_sub_f32 v176, v176, v241
    v_sub_f32 v112, v112, v241
    v_sub_f32 v177, v177, v241
    v_sub_f32 v113, v113, v241
    v_sub_f32 v178, v178, v241
    v_sub_f32 v114, v114, v241
    v_sub_f32 v179, v179, v241
    v_sub_f32 v115, v115, v241
    v_sub_f32 v180, v180, v241
    v_sub_f32 v116, v116, v241
    v_sub_f32 v181, v181, v241
    v_sub_f32 v117, v117, v241
    v_sub_f32 v182, v182, v241
    v_sub_f32 v118, v118, v241
    v_sub_f32 v183, v183, v241
    v_sub_f32 v119, v119, v241
    v_sub_f32 v184, v184, v241
    v_sub_f32 v120, v120, v241
    v_sub_f32 v185, v185, v241
    v_sub_f32 v121, v121, v241
    v_sub_f32 v186, v186, v241
    v_sub_f32 v122, v122, v241
    v_sub_f32 v187, v187, v241
    v_sub_f32 v123, v123, v241
    v_sub_f32 v188, v188, v241
    v_sub_f32 v124, v124, v241
    v_sub_f32 v189, v189, v241
    v_sub_f32 v125, v125, v241
    v_sub_f32 v190, v190, v241
    v_sub_f32 v126, v126, v241
    v_sub_f32 v191, v191, v241
    v_sub_f32 v127, v127, v241
    v_sub_f32 v242, 0, v241
    v_exp_f32 v242, v242
    s_nop 0
    v_mul_f32 v80, v80, v242
    v_mul_f32 v81, v81, v242
    v_mul_f32 v82, v82, v242
    v_mul_f32 v83, v83, v242
    v_mul_f32 v84, v84, v242
    v_mul_f32 v85, v85, v242
    v_mul_f32 v86, v86, v242
    v_mul_f32 v87, v87, v242
    v_mul_f32 v88, v88, v242
    v_mul_f32 v89, v89, v242
    v_mul_f32 v90, v90, v242
    v_mul_f32 v91, v91, v242
    v_mul_f32 v92, v92, v242
    v_mul_f32 v93, v93, v242
    v_mul_f32 v94, v94, v242
    v_mul_f32 v95, v95, v242
    s_nop 1
    s_branch aback_69
arare_70:
    s_nop 15
    v_max3_f32 v240, v128, v129, v130
    v_max3_f32 v242, v131, v132, v133
    v_max3_f32 v240, v240, v134, v135
    v_max3_f32 v242, v242, v136, v137
    v_max3_f32 v240, v240, v138, v139
    v_max3_f32 v242, v242, v140, v141
    v_max3_f32 v240, v240, v142, v143
    v_max_f32 v240, v240, v242
    v_mov_b32 v242, v240
    v_mov_b32 v243, v240
    s_nop 1
    v_permlane32_swap_b32 v242, v243
    v_max_f32 v240, v242, v243
    v_max_f32 v240, 0, v240
    v_sub_f32 v128, v128, v240
    v_sub_f32 v96, v96, v240
    v_sub_f32 v129, v129, v240
    v_sub_f32 v97, v97, v240
    v_sub_f32 v130, v130, v240
    v_sub_f32 v98, v98, v240
    v_sub_f32 v131, v131, v240
    v_sub_f32 v99, v99, v240
    v_sub_f32 v132, v132, v240
    v_sub_f32 v100, v100, v240
    v_sub_f32 v133, v133, v240
    v_sub_f32 v101, v101, v240
    v_sub_f32 v134, v134, v240
    v_sub_f32 v102, v102, v240
    v_sub_f32 v135, v135, v240
    v_sub_f32 v103, v103, v240
    v_sub_f32 v136, v136, v240
    v_sub_f32 v104, v104, v240
    v_sub_f32 v137, v137, v240
    v_sub_f32 v105, v105, v240
    v_sub_f32 v138, v138, v240
    v_sub_f32 v106, v106, v240
    v_sub_f32 v139, v139, v240
    v_sub_f32 v107, v107, v240
    v_sub_f32 v140, v140, v240
    v_sub_f32 v108, v108, v240
    v_sub_f32 v141, v141, v240
    v_sub_f32 v109, v109, v240
    v_sub_f32 v142, v142, v240
    v_sub_f32 v110, v110, v240
    v_sub_f32 v143, v143, v240
    v_sub_f32 v111, v111, v240
    v_sub_f32 v242, 0, v240
    v_exp_f32 v242, v242
    s_nop 0
    v_mul_f32 v64, v64, v242
    v_mul_f32 v65, v65, v242
    v_mul_f32 v66, v66, v242
    v_mul_f32 v67, v67, v242
    v_mul_f32 v68, v68, v242
    v_mul_f32 v69, v69, v242
    v_mul_f32 v70, v70, v242
    v_mul_f32 v71, v71, v242
    v_mul_f32 v72, v72, v242
    v_mul_f32 v73, v73, v242
    v_mul_f32 v74, v74, v242
    v_mul_f32 v75, v75, v242
    v_mul_f32 v76, v76, v242
    v_mul_f32 v77, v77, v242
    v_mul_f32 v78, v78, v242
    v_mul_f32 v79, v79, v242
    s_nop 1
    v_max3_f32 v241, v144, v145, v146
    v_max3_f32 v242, v147, v148, v149
    v_max3_f32 v241, v241, v150, v151
    v_max3_f32 v242, v242, v152, v153
    v_max3_f32 v241, v241, v154, v155
    v_max3_f32 v242, v242, v156, v157
    v_max3_f32 v241, v241, v158, v159
    v_max_f32 v241, v241, v242
    v_mov_b32 v242, v241
    v_mov_b32 v243, v241
    s_nop 1
    v_permlane32_swap_b32 v242, v243
    v_max_f32 v241, v242, v243
    v_max_f32 v241, 0, v241
    v_sub_f32 v144, v144, v241
    v_sub_f32 v112, v112, v241
    v_sub_f32 v145, v145, v241
    v_sub_f32 v113, v113, v241
    v_sub_f32 v146, v146, v241
    v_sub_f32 v114, v114, v241
    v_sub_f32 v147, v147, v241
    v_sub_f32 v115, v115, v241
    v_sub_f32 v148, v148, v241
    v_sub_f32 v116, v116, v241
    v_sub_f32 v149, v149, v241
    v_sub_f32 v117, v117, v241
    v_sub_f32 v150, v150, v241
    v_sub_f32 v118, v118, v241
    v_sub_f32 v151, v151, v241
    v_sub_f32 v119, v119, v241
    v_sub_f32 v152, v152, v241
    v_sub_f32 v120, v120, v241
    v_sub_f32 v153, v153, v241
    v_sub_f32 v121, v121, v241
    v_sub_f32 v154, v154, v241
    v_sub_f32 v122, v122, v241
    v_sub_f32 v155, v155, v241
    v_sub_f32 v123, v123, v241
    v_sub_f32 v156, v156, v241
    v_sub_f32 v124, v124, v241
    v_sub_f32 v157, v157, v241
    v_sub_f32 v125, v125, v241
    v_sub_f32 v158, v158, v241
    v_sub_f32 v126, v126, v241
    v_sub_f32 v159, v159, v241
    v_sub_f32 v127, v127, v241
    v_sub_f32 v242, 0, v241
    v_exp_f32 v242, v242
    s_nop 0
    v_mul_f32 v80, v80, v242
    v_mul_f32 v81, v81, v242
    v_mul_f32 v82, v82, v242
    v_mul_f32 v83, v83, v242
    v_mul_f32 v84, v84, v242
    v_mul_f32 v85, v85, v242
    v_mul_f32 v86, v86, v242
    v_mul_f32 v87, v87, v242
    v_mul_f32 v88, v88, v242
    v_mul_f32 v89, v89, v242
    v_mul_f32 v90, v90, v242
    v_mul_f32 v91, v91, v242
    v_mul_f32 v92, v92, v242
    v_mul_f32 v93, v93, v242
    v_mul_f32 v94, v94, v242
    v_mul_f32 v95, v95, v242
    s_nop 1
    s_branch aback_71
arare_72:
    s_nop 15
    v_max3_f32 v240, v160, v161, v162
    v_max3_f32 v242, v163, v164, v165
    v_max3_f32 v240, v240, v166, v167
    v_max3_f32 v242, v242, v168, v169
    v_max3_f32 v240, v240, v170, v171
    v_max3_f32 v242, v242, v172, v173
    v_max3_f32 v240, v240, v174, v175
    v_max_f32 v240, v240, v242
    v_mov_b32 v242, v240
    v_mov_b32 v243, v240
    s_nop 1
    v_permlane32_swap_b32 v242, v243
    v_max_f32 v240, v242, v243
    v_max_f32 v240, 0, v240
    v_sub_f32 v160, v160, v240
    v_sub_f32 v96, v96, v240
    v_sub_f32 v161, v161, v240
    v_sub_f32 v97, v97, v240
    v_sub_f32 v162, v162, v240
    v_sub_f32 v98, v98, v240
    v_sub_f32 v163, v163, v240
    v_sub_f32 v99, v99, v240
    v_sub_f32 v164, v164, v240
    v_sub_f32 v100, v100, v240
    v_sub_f32 v165, v165, v240
    v_sub_f32 v101, v101, v240
    v_sub_f32 v166, v166, v240
    v_sub_f32 v102, v102, v240
    v_sub_f32 v167, v167, v240
    v_sub_f32 v103, v103, v240
    v_sub_f32 v168, v168, v240
    v_sub_f32 v104, v104, v240
    v_sub_f32 v169, v169, v240
    v_sub_f32 v105, v105, v240
    v_sub_f32 v170, v170, v240
    v_sub_f32 v106, v106, v240
    v_sub_f32 v171, v171, v240
    v_sub_f32 v107, v107, v240
    v_sub_f32 v172, v172, v240
    v_sub_f32 v108, v108, v240
    v_sub_f32 v173, v173, v240
    v_sub_f32 v109, v109, v240
    v_sub_f32 v174, v174, v240
    v_sub_f32 v110, v110, v240
    v_sub_f32 v175, v175, v240
    v_sub_f32 v111, v111, v240
    v_sub_f32 v242, 0, v240
    v_exp_f32 v242, v242
    s_nop 0
    v_mul_f32 v64, v64, v242
    v_mul_f32 v65, v65, v242
    v_mul_f32 v66, v66, v242
    v_mul_f32 v67, v67, v242
    v_mul_f32 v68, v68, v242
    v_mul_f32 v69, v69, v242
    v_mul_f32 v70, v70, v242
    v_mul_f32 v71, v71, v242
    v_mul_f32 v72, v72, v242
    v_mul_f32 v73, v73, v242
    v_mul_f32 v74, v74, v242
    v_mul_f32 v75, v75, v242
    v_mul_f32 v76, v76, v242
    v_mul_f32 v77, v77, v242
    v_mul_f32 v78, v78, v242
    v_mul_f32 v79, v79, v242
    s_nop 1
    v_max3_f32 v241, v176, v177, v178
    v_max3_f32 v242, v179, v180, v181
    v_max3_f32 v241, v241, v182, v183
    v_max3_f32 v242, v242, v184, v185
    v_max3_f32 v241, v241, v186, v187
    v_max3_f32 v242, v242, v188, v189
    v_max3_f32 v241, v241, v190, v191
    v_max_f32 v241, v241, v242
    v_mov_b32 v242, v241
    v_mov_b32 v243, v241
    s_nop 1
    v_permlane32_swap_b32 v242, v243
    v_max_f32 v241, v242, v243
    v_max_f32 v241, 0, v241
    v_sub_f32 v176, v176, v241
    v_sub_f32 v112, v112, v241
    v_sub_f32 v177, v177, v241
    v_sub_f32 v113, v113, v241
    v_sub_f32 v178, v178, v241
    v_sub_f32 v114, v114, v241
    v_sub_f32 v179, v179, v241
    v_sub_f32 v115, v115, v241
    v_sub_f32 v180, v180, v241
    v_sub_f32 v116, v116, v241
    v_sub_f32 v181, v181, v241
    v_sub_f32 v117, v117, v241
    v_sub_f32 v182, v182, v241
    v_sub_f32 v118, v118, v241
    v_sub_f32 v183, v183, v241
    v_sub_f32 v119, v119, v241
    v_sub_f32 v184, v184, v241
    v_sub_f32 v120, v120, v241
    v_sub_f32 v185, v185, v241
    v_sub_f32 v121, v121, v241
    v_sub_f32 v186, v186, v241
    v_sub_f32 v122, v122, v241
    v_sub_f32 v187, v187, v241
    v_sub_f32 v123, v123, v241
    v_sub_f32 v188, v188, v241
    v_sub_f32 v124, v124, v241
    v_sub_f32 v189, v189, v241
    v_sub_f32 v125, v125, v241
    v_sub_f32 v190, v190, v241
    v_sub_f32 v126, v126, v241
    v_sub_f32 v191, v191, v241
    v_sub_f32 v127, v127, v241
    v_sub_f32 v242, 0, v241
    v_exp_f32 v242, v242
    s_nop 0
    v_mul_f32 v80, v80, v242
    v_mul_f32 v81, v81, v242
    v_mul_f32 v82, v82, v242
    v_mul_f32 v83, v83, v242
    v_mul_f32 v84, v84, v242
    v_mul_f32 v85, v85, v242
    v_mul_f32 v86, v86, v242
    v_mul_f32 v87, v87, v242
    v_mul_f32 v88, v88, v242
    v_mul_f32 v89, v89, v242
    v_mul_f32 v90, v90, v242
    v_mul_f32 v91, v91, v242
    v_mul_f32 v92, v92, v242
    v_mul_f32 v93, v93, v242
    v_mul_f32 v94, v94, v242
    v_mul_f32 v95, v95, v242
    s_nop 1
    s_branch aback_73
arare_74:
    s_nop 15
    v_max3_f32 v240, v128, v129, v130
    v_max3_f32 v242, v131, v132, v133
    v_max3_f32 v240, v240, v134, v135
    v_max3_f32 v242, v242, v136, v137
    v_max3_f32 v240, v240, v138, v139
    v_max3_f32 v242, v242, v140, v141
    v_max3_f32 v240, v240, v142, v143
    v_max_f32 v240, v240, v242
    v_mov_b32 v242, v240
    v_mov_b32 v243, v240
    s_nop 1
    v_permlane32_swap_b32 v242, v243
    v_max_f32 v240, v242, v243
    v_max_f32 v240, 0, v240
    v_sub_f32 v128, v128, v240
    v_sub_f32 v96, v96, v240
    v_sub_f32 v129, v129, v240
    v_sub_f32 v97, v97, v240
    v_sub_f32 v130, v130, v240
    v_sub_f32 v98, v98, v240
    v_sub_f32 v131, v131, v240
    v_sub_f32 v99, v99, v240
    v_sub_f32 v132, v132, v240
    v_sub_f32 v100, v100, v240
    v_sub_f32 v133, v133, v240
    v_sub_f32 v101, v101, v240
    v_sub_f32 v134, v134, v240
    v_sub_f32 v102, v102, v240
    v_sub_f32 v135, v135, v240
    v_sub_f32 v103, v103, v240
    v_sub_f32 v136, v136, v240
    v_sub_f32 v104, v104, v240
    v_sub_f32 v137, v137, v240
    v_sub_f32 v105, v105, v240
    v_sub_f32 v138, v138, v240
    v_sub_f32 v106, v106, v240
    v_sub_f32 v139, v139, v240
    v_sub_f32 v107, v107, v240
    v_sub_f32 v140, v140, v240
    v_sub_f32 v108, v108, v240
    v_sub_f32 v141, v141, v240
    v_sub_f32 v109, v109, v240
    v_sub_f32 v142, v142, v240
    v_sub_f32 v110, v110, v240
    v_sub_f32 v143, v143, v240
    v_sub_f32 v111, v111, v240
    v_sub_f32 v242, 0, v240
    v_exp_f32 v242, v242
    s_nop 0
    v_mul_f32 v64, v64, v242
    v_mul_f32 v65, v65, v242
    v_mul_f32 v66, v66, v242
    v_mul_f32 v67, v67, v242
    v_mul_f32 v68, v68, v242
    v_mul_f32 v69, v69, v242
    v_mul_f32 v70, v70, v242
    v_mul_f32 v71, v71, v242
    v_mul_f32 v72, v72, v242
    v_mul_f32 v73, v73, v242
    v_mul_f32 v74, v74, v242
    v_mul_f32 v75, v75, v242
    v_mul_f32 v76, v76, v242
    v_mul_f32 v77, v77, v242
    v_mul_f32 v78, v78, v242
    v_mul_f32 v79, v79, v242
    s_nop 1
    v_max3_f32 v241, v144, v145, v146
    v_max3_f32 v242, v147, v148, v149
    v_max3_f32 v241, v241, v150, v151
    v_max3_f32 v242, v242, v152, v153
    v_max3_f32 v241, v241, v154, v155
    v_max3_f32 v242, v242, v156, v157
    v_max3_f32 v241, v241, v158, v159
    v_max_f32 v241, v241, v242
    v_mov_b32 v242, v241
    v_mov_b32 v243, v241
    s_nop 1
    v_permlane32_swap_b32 v242, v243
    v_max_f32 v241, v242, v243
    v_max_f32 v241, 0, v241
    v_sub_f32 v144, v144, v241
    v_sub_f32 v112, v112, v241
    v_sub_f32 v145, v145, v241
    v_sub_f32 v113, v113, v241
    v_sub_f32 v146, v146, v241
    v_sub_f32 v114, v114, v241
    v_sub_f32 v147, v147, v241
    v_sub_f32 v115, v115, v241
    v_sub_f32 v148, v148, v241
    v_sub_f32 v116, v116, v241
    v_sub_f32 v149, v149, v241
    v_sub_f32 v117, v117, v241
    v_sub_f32 v150, v150, v241
    v_sub_f32 v118, v118, v241
    v_sub_f32 v151, v151, v241
    v_sub_f32 v119, v119, v241
    v_sub_f32 v152, v152, v241
    v_sub_f32 v120, v120, v241
    v_sub_f32 v153, v153, v241
    v_sub_f32 v121, v121, v241
    v_sub_f32 v154, v154, v241
    v_sub_f32 v122, v122, v241
    v_sub_f32 v155, v155, v241
    v_sub_f32 v123, v123, v241
    v_sub_f32 v156, v156, v241
    v_sub_f32 v124, v124, v241
    v_sub_f32 v157, v157, v241
    v_sub_f32 v125, v125, v241
    v_sub_f32 v158, v158, v241
    v_sub_f32 v126, v126, v241
    v_sub_f32 v159, v159, v241
    v_sub_f32 v127, v127, v241
    v_sub_f32 v242, 0, v241
    v_exp_f32 v242, v242
    s_nop 0
    v_mul_f32 v80, v80, v242
    v_mul_f32 v81, v81, v242
    v_mul_f32 v82, v82, v242
    v_mul_f32 v83, v83, v242
    v_mul_f32 v84, v84, v242
    v_mul_f32 v85, v85, v242
    v_mul_f32 v86, v86, v242
    v_mul_f32 v87, v87, v242
    v_mul_f32 v88, v88, v242
    v_mul_f32 v89, v89, v242
    v_mul_f32 v90, v90, v242
    v_mul_f32 v91, v91, v242
    v_mul_f32 v92, v92, v242
    v_mul_f32 v93, v93, v242
    v_mul_f32 v94, v94, v242
    v_mul_f32 v95, v95, v242
    s_nop 1
    s_branch aback_75
arare_76:
    s_nop 15
    v_max3_f32 v240, v160, v161, v162
    v_max3_f32 v242, v163, v164, v165
    v_max3_f32 v240, v240, v166, v167
    v_max3_f32 v242, v242, v168, v169
    v_max3_f32 v240, v240, v170, v171
    v_max3_f32 v242, v242, v172, v173
    v_max3_f32 v240, v240, v174, v175
    v_max_f32 v240, v240, v242
    v_mov_b32 v242, v240
    v_mov_b32 v243, v240
    s_nop 1
    v_permlane32_swap_b32 v242, v243
    v_max_f32 v240, v242, v243
    v_max_f32 v240, 0, v240
    v_sub_f32 v160, v160, v240
    v_sub_f32 v96, v96, v240
    v_sub_f32 v161, v161, v240
    v_sub_f32 v97, v97, v240
    v_sub_f32 v162, v162, v240
    v_sub_f32 v98, v98, v240
    v_sub_f32 v163, v163, v240
    v_sub_f32 v99, v99, v240
    v_sub_f32 v164, v164, v240
    v_sub_f32 v100, v100, v240
    v_sub_f32 v165, v165, v240
    v_sub_f32 v101, v101, v240
    v_sub_f32 v166, v166, v240
    v_sub_f32 v102, v102, v240
    v_sub_f32 v167, v167, v240
    v_sub_f32 v103, v103, v240
    v_sub_f32 v168, v168, v240
    v_sub_f32 v104, v104, v240
    v_sub_f32 v169, v169, v240
    v_sub_f32 v105, v105, v240
    v_sub_f32 v170, v170, v240
    v_sub_f32 v106, v106, v240
    v_sub_f32 v171, v171, v240
    v_sub_f32 v107, v107, v240
    v_sub_f32 v172, v172, v240
    v_sub_f32 v108, v108, v240
    v_sub_f32 v173, v173, v240
    v_sub_f32 v109, v109, v240
    v_sub_f32 v174, v174, v240
    v_sub_f32 v110, v110, v240
    v_sub_f32 v175, v175, v240
    v_sub_f32 v111, v111, v240
    v_sub_f32 v242, 0, v240
    v_exp_f32 v242, v242
    s_nop 0
    v_mul_f32 v64, v64, v242
    v_mul_f32 v65, v65, v242
    v_mul_f32 v66, v66, v242
    v_mul_f32 v67, v67, v242
    v_mul_f32 v68, v68, v242
    v_mul_f32 v69, v69, v242
    v_mul_f32 v70, v70, v242
    v_mul_f32 v71, v71, v242
    v_mul_f32 v72, v72, v242
    v_mul_f32 v73, v73, v242
    v_mul_f32 v74, v74, v242
    v_mul_f32 v75, v75, v242
    v_mul_f32 v76, v76, v242
    v_mul_f32 v77, v77, v242
    v_mul_f32 v78, v78, v242
    v_mul_f32 v79, v79, v242
    s_nop 1
    v_max3_f32 v241, v176, v177, v178
    v_max3_f32 v242, v179, v180, v181
    v_max3_f32 v241, v241, v182, v183
    v_max3_f32 v242, v242, v184, v185
    v_max3_f32 v241, v241, v186, v187
    v_max3_f32 v242, v242, v188, v189
    v_max3_f32 v241, v241, v190, v191
    v_max_f32 v241, v241, v242
    v_mov_b32 v242, v241
    v_mov_b32 v243, v241
    s_nop 1
    v_permlane32_swap_b32 v242, v243
    v_max_f32 v241, v242, v243
    v_max_f32 v241, 0, v241
    v_sub_f32 v176, v176, v241
    v_sub_f32 v112, v112, v241
    v_sub_f32 v177, v177, v241
    v_sub_f32 v113, v113, v241
    v_sub_f32 v178, v178, v241
    v_sub_f32 v114, v114, v241
    v_sub_f32 v179, v179, v241
    v_sub_f32 v115, v115, v241
    v_sub_f32 v180, v180, v241
    v_sub_f32 v116, v116, v241
    v_sub_f32 v181, v181, v241
    v_sub_f32 v117, v117, v241
    v_sub_f32 v182, v182, v241
    v_sub_f32 v118, v118, v241
    v_sub_f32 v183, v183, v241
    v_sub_f32 v119, v119, v241
    v_sub_f32 v184, v184, v241
    v_sub_f32 v120, v120, v241
    v_sub_f32 v185, v185, v241
    v_sub_f32 v121, v121, v241
    v_sub_f32 v186, v186, v241
    v_sub_f32 v122, v122, v241
    v_sub_f32 v187, v187, v241
    v_sub_f32 v123, v123, v241
    v_sub_f32 v188, v188, v241
    v_sub_f32 v124, v124, v241
    v_sub_f32 v189, v189, v241
    v_sub_f32 v125, v125, v241
    v_sub_f32 v190, v190, v241
    v_sub_f32 v126, v126, v241
    v_sub_f32 v191, v191, v241
    v_sub_f32 v127, v127, v241
    v_sub_f32 v242, 0, v241
    v_exp_f32 v242, v242
    s_nop 0
    v_mul_f32 v80, v80, v242
    v_mul_f32 v81, v81, v242
    v_mul_f32 v82, v82, v242
    v_mul_f32 v83, v83, v242
    v_mul_f32 v84, v84, v242
    v_mul_f32 v85, v85, v242
    v_mul_f32 v86, v86, v242
    v_mul_f32 v87, v87, v242
    v_mul_f32 v88, v88, v242
    v_mul_f32 v89, v89, v242
    v_mul_f32 v90, v90, v242
    v_mul_f32 v91, v91, v242
    v_mul_f32 v92, v92, v242
    v_mul_f32 v93, v93, v242
    v_mul_f32 v94, v94, v242
    v_mul_f32 v95, v95, v242
    s_nop 1
    s_branch aback_77
.globl outp_kernel
.p2align 8
.type outp_kernel,@function
outp_kernel:
    s_cmp_ge_u32 s2, 320
    s_cbranch_scc1 oend_78
    s_load_dwordx16 s[16:31], s[0:1], 0
    s_load_dwordx8 s[32:39], s[0:1], 64
    s_waitcnt lgkmcnt(0)
    s_cmp_ge_u32 s2, 160
    s_cselect_b32 s3, 160, 0
    s_sub_u32 s3, s2, s3
    s_and_b32 s5, s3, 15
    s_lshr_b32 s4, s3, 4
    s_lshl_b32 s52, s5, 7
    s_lshl_b32 s53, s4, 6
    s_cmp_ge_u32 s2, 160
    s_cbranch_scc1 oj_79
    s_add_u32 s40, s38, 67108864
    s_addc_u32 s41, s39, 0
    s_and_b32 s41, s41, 0xffff
    s_mov_b32 s42, 16777216
    s_mov_b32 s43, 0x00020000
    s_mov_b32 s44, s32
    s_mov_b32 s45, s33
    s_and_b32 s45, s45, 0xffff
    s_mov_b32 s46, 5242880
    s_mov_b32 s47, 0x00020000
    v_and_b32 v1, 63, v0
    v_lshrrev_b32 v2, 6, v0
    s_nop 0
    v_readfirstlane_b32 s57, v2
    v_and_b32 v2, 31, v1
    v_add_u32 v2, s52, v2
    v_lshlrev_b32 v2, 5, v2
    v_lshrrev_b32 v3, 5, v1
    v_lshl_add_u32 v8, v3, 4, v2
    v_lshrrev_b32 v2, 3, v1
    v_and_b32 v3, 7, v1
    v_lshrrev_b32 v4, 2, v3
    v_bfe_u32 v5, v1, 4, 1
    v_xor_b32 v4, v4, v5
    v_and_b32 v3, 3, v3
    v_lshlrev_b32 v3, 4, v3
    v_lshl_add_u32 v3, v4, 6, v3
    s_mov_b32 s61, 1280
    v_mul_lo_u32 v2, v2, s61
    v_add_u32 v2, v2, v3
    s_lshl_b32 s60, s53, 1
    v_add_u32 v2, s60, v2
    v_add_u32 v12, 0, v2
    v_add_u32 v13, 9216, v2
    v_add_u32 v14, 18432, v2
    v_add_u32 v15, 27648, v2
    s_lshl_b32 s63, s57, 15
    v_bfe_u32 v2, v1, 2, 2
    v_lshrrev_b32 v3, 5, v1
    v_lshl_add_u32 v3, v3, 3, v2
    v_mul_u32_u24 v3, 128, v3
    v_lshrrev_b32 v4, 1, v2
    v_lshl_add_u32 v3, v4, 6, v3
    v_bfe_u32 v4, v1, 4, 1
    v_and_b32 v5, 3, v1
    v_lshlrev_b32 v5, 3, v5
    v_lshl_add_u32 v5, v4, 5, v5
    v_add_u32 v3, v3, v5
    v_add_u32 v18, s63, v3
    v_xor_b32 v19, 64, v18
    s_mul_i32 s54, s57, 4194304
    s_add_u32 s55, s54, 65536
    s_mul_i32 s58, s57, 1310720
    v_accvgpr_write_b32 a0, 0
    v_accvgpr_write_b32 a1, 0
    v_accvgpr_write_b32 a2, 0
    v_accvgpr_write_b32 a3, 0
    v_accvgpr_write_b32 a4, 0
    v_accvgpr_write_b32 a5, 0
    v_accvgpr_write_b32 a6, 0
    v_accvgpr_write_b32 a7, 0
    v_accvgpr_write_b32 a8, 0
    v_accvgpr_write_b32 a9, 0
    v_accvgpr_write_b32 a10, 0
    v_accvgpr_write_b32 a11, 0
    v_accvgpr_write_b32 a12, 0
    v_accvgpr_write_b32 a13, 0
    v_accvgpr_write_b32 a14, 0
    v_accvgpr_write_b32 a15, 0
    v_accvgpr_write_b32 a16, 0
    v_accvgpr_write_b32 a17, 0
    v_accvgpr_write_b32 a18, 0
    v_accvgpr_write_b32 a19, 0
    v_accvgpr_write_b32 a20, 0
    v_accvgpr_write_b32 a21, 0
    v_accvgpr_write_b32 a22, 0
    v_accvgpr_write_b32 a23, 0
    v_accvgpr_write_b32 a24, 0
    v_accvgpr_write_b32 a25, 0
    v_accvgpr_write_b32 a26, 0
    v_accvgpr_write_b32 a27, 0
    v_accvgpr_write_b32 a28, 0
    v_accvgpr_write_b32 a29, 0
    v_accvgpr_write_b32 a30, 0
    v_accvgpr_write_b32 a31, 0
    v_accvgpr_write_b32 a32, 0
    v_accvgpr_write_b32 a33, 0
    v_accvgpr_write_b32 a34, 0
    v_accvgpr_write_b32 a35, 0
    v_accvgpr_write_b32 a36, 0
    v_accvgpr_write_b32 a37, 0
    v_accvgpr_write_b32 a38, 0
    v_accvgpr_write_b32 a39, 0
    v_accvgpr_write_b32 a40, 0
    v_accvgpr_write_b32 a41, 0
    v_accvgpr_write_b32 a42, 0
    v_accvgpr_write_b32 a43, 0
    v_accvgpr_write_b32 a44, 0
    v_accvgpr_write_b32 a45, 0
    v_accvgpr_write_b32 a46, 0
    v_accvgpr_write_b32 a47, 0
    v_accvgpr_write_b32 a48, 0
    v_accvgpr_write_b32 a49, 0
    v_accvgpr_write_b32 a50, 0
    v_accvgpr_write_b32 a51, 0
    v_accvgpr_write_b32 a52, 0
    v_accvgpr_write_b32 a53, 0
    v_accvgpr_write_b32 a54, 0
    v_accvgpr_write_b32 a55, 0
    v_accvgpr_write_b32 a56, 0
    v_accvgpr_write_b32 a57, 0
    v_accvgpr_write_b32 a58, 0
    v_accvgpr_write_b32 a59, 0
    v_accvgpr_write_b32 a60, 0
    v_accvgpr_write_b32 a61, 0
    v_accvgpr_write_b32 a62, 0
    v_accvgpr_write_b32 a63, 0
    v_accvgpr_write_b32 a64, 0
    v_accvgpr_write_b32 a65, 0
    v_accvgpr_write_b32 a66, 0
    v_accvgpr_write_b32 a67, 0
    v_accvgpr_write_b32 a68, 0
    v_accvgpr_write_b32 a69, 0
    v_accvgpr_write_b32 a70, 0
    v_accvgpr_write_b32 a71, 0
    v_accvgpr_write_b32 a72, 0
    v_accvgpr_write_b32 a73, 0
    v_accvgpr_write_b32 a74, 0
    v_accvgpr_write_b32 a75, 0
    v_accvgpr_write_b32 a76, 0
    v_accvgpr_write_b32 a77, 0
    v_accvgpr_write_b32 a78, 0
    v_accvgpr_write_b32 a79, 0
    v_accvgpr_write_b32 a80, 0
    v_accvgpr_write_b32 a81, 0
    v_accvgpr_write_b32 a82, 0
    v_accvgpr_write_b32 a83, 0
    v_accvgpr_write_b32 a84, 0
    v_accvgpr_write_b32 a85, 0
    v_accvgpr_write_b32 a86, 0
    v_accvgpr_write_b32 a87, 0
    v_accvgpr_write_b32 a88, 0
    v_accvgpr_write_b32 a89, 0
    v_accvgpr_write_b32 a90, 0
    v_accvgpr_write_b32 a91, 0
    v_accvgpr_write_b32 a92, 0
    v_accvgpr_write_b32 a93, 0
    v_accvgpr_write_b32 a94, 0
    v_accvgpr_write_b32 a95, 0
    v_accvgpr_write_b32 a96, 0
    v_accvgpr_write_b32 a97, 0
    v_accvgpr_write_b32 a98, 0
    v_accvgpr_write_b32 a99, 0
    v_accvgpr_write_b32 a100, 0
    v_accvgpr_write_b32 a101, 0
    v_accvgpr_write_b32 a102, 0
    v_accvgpr_write_b32 a103, 0
    v_accvgpr_write_b32 a104, 0
    v_accvgpr_write_b32 a105, 0
    v_accvgpr_write_b32 a106, 0
    v_accvgpr_write_b32 a107, 0
    v_accvgpr_write_b32 a108, 0
    v_accvgpr_write_b32 a109, 0
    v_accvgpr_write_b32 a110, 0
    v_accvgpr_write_b32 a111, 0
    v_accvgpr_write_b32 a112, 0
    v_accvgpr_write_b32 a113, 0
    v_accvgpr_write_b32 a114, 0
    v_accvgpr_write_b32 a115, 0
    v_accvgpr_write_b32 a116, 0
    v_accvgpr_write_b32 a117, 0
    v_accvgpr_write_b32 a118, 0
    v_accvgpr_write_b32 a119, 0
    v_accvgpr_write_b32 a120, 0
    v_accvgpr_write_b32 a121, 0
    v_accvgpr_write_b32 a122, 0
    v_accvgpr_write_b32 a123, 0
    v_accvgpr_write_b32 a124, 0
    v_accvgpr_write_b32 a125, 0
    v_accvgpr_write_b32 a126, 0
    v_accvgpr_write_b32 a127, 0
    s_add_u32 m0, s63, 0
    s_nop 0
    buffer_load_dwordx4 v12, s[44:47], s58 offen offset:0 lds
    buffer_load_dwordx4 v13, s[44:47], s58 offen offset:1024 lds
    buffer_load_dwordx4 v14, s[44:47], s58 offen offset:2048 lds
    buffer_load_dwordx4 v15, s[44:47], s58 offen offset:3072 lds
    buffer_load_dwordx4 v[32:35], v8, s[40:43], s54 offen offset:0
    buffer_load_dwordx4 v[36:39], v8, s[40:43], s54 offen offset:1024
    buffer_load_dwordx4 v[40:43], v8, s[40:43], s54 offen offset:2048
    buffer_load_dwordx4 v[44:47], v8, s[40:43], s54 offen offset:3072
    buffer_load_dwordx4 v[48:51], v8, s[40:43], s55 offen offset:0
    buffer_load_dwordx4 v[52:55], v8, s[40:43], s55 offen offset:1024
    buffer_load_dwordx4 v[56:59], v8, s[40:43], s55 offen offset:2048
    buffer_load_dwordx4 v[60:63], v8, s[40:43], s55 offen offset:3072
    s_add_u32 s54, s54, 131072
    s_add_u32 s55, s55, 131072
    s_add_u32 s58, s58, 40960
    s_add_u32 m0, s63, 4096
    s_nop 0
    buffer_load_dwordx4 v12, s[44:47], s58 offen offset:0 lds
    buffer_load_dwordx4 v13, s[44:47], s58 offen offset:1024 lds
    buffer_load_dwordx4 v14, s[44:47], s58 offen offset:2048 lds
    buffer_load_dwordx4 v15, s[44:47], s58 offen offset:3072 lds
    buffer_load_dwordx4 v[64:67], v8, s[40:43], s54 offen offset:0
    buffer_load_dwordx4 v[68:71], v8, s[40:43], s54 offen offset:1024
    buffer_load_dwordx4 v[72:75], v8, s[40:43], s54 offen offset:2048
    buffer_load_dwordx4 v[76:79], v8, s[40:43], s54 offen offset:3072
    buffer_load_dwordx4 v[80:83], v8, s[40:43], s55 offen offset:0
    buffer_load_dwordx4 v[84:87], v8, s[40:43], s55 offen offset:1024
    buffer_load_dwordx4 v[88:91], v8, s[40:43], s55 offen offset:2048
    buffer_load_dwordx4 v[92:95], v8, s[40:43], s55 offen offset:3072
    s_add_u32 s54, s54, 131072
    s_add_u32 s55, s55, 131072
    s_add_u32 s58, s58, 40960
    s_add_u32 m0, s63, 8192
    s_nop 0
    buffer_load_dwordx4 v12, s[44:47], s58 offen offset:0 lds
    buffer_load_dwordx4 v13, s[44:47], s58 offen offset:1024 lds
    buffer_load_dwordx4 v14, s[44:47], s58 offen offset:2048 lds
    buffer_load_dwordx4 v15, s[44:47], s58 offen offset:3072 lds
    buffer_load_dwordx4 v[96:99], v8, s[40:43], s54 offen offset:0
    buffer_load_dwordx4 v[100:103], v8, s[40:43], s54 offen offset:1024
    buffer_load_dwordx4 v[104:107], v8, s[40:43], s54 offen offset:2048
    buffer_load_dwordx4 v[108:111], v8, s[40:43], s54 offen offset:3072
    buffer_load_dwordx4 v[112:115], v8, s[40:43], s55 offen offset:0
    buffer_load_dwordx4 v[116:119], v8, s[40:43], s55 offen offset:1024
    buffer_load_dwordx4 v[120:123], v8, s[40:43], s55 offen offset:2048
    buffer_load_dwordx4 v[124:127], v8, s[40:43], s55 offen offset:3072
    s_add_u32 s54, s54, 131072
    s_add_u32 s55, s55, 131072
    s_add_u32 s58, s58, 40960
    s_mov_b32 s56, 32
    s_waitcnt vmcnt(24)
    ds_read_b64_tr_b16 v[160:161], v18 offset:0
    ds_read_b64_tr_b16 v[162:163], v18 offset:512
    ds_read_b64_tr_b16 v[164:165], v19 offset:0
    ds_read_b64_tr_b16 v[166:167], v19 offset:512
    s_waitcnt lgkmcnt(0)
ol_80:
    s_cmp_le_u32 s56, 3
    s_cselect_b32 s42, 0, s42
    s_cselect_b32 s46, 0, s46
    s_add_u32 m0, s63, 12288
    s_nop 0
    buffer_load_dwordx4 v12, s[44:47], s58 offen offset:0 lds
    buffer_load_dwordx4 v13, s[44:47], s58 offen offset:1024 lds
    buffer_load_dwordx4 v14, s[44:47], s58 offen offset:2048 lds
    buffer_load_dwordx4 v15, s[44:47], s58 offen offset:3072 lds
    buffer_load_dwordx4 v[128:131], v8, s[40:43], s54 offen offset:0
    buffer_load_dwordx4 v[132:135], v8, s[40:43], s54 offen offset:1024
    buffer_load_dwordx4 v[136:139], v8, s[40:43], s54 offen offset:2048
    buffer_load_dwordx4 v[140:143], v8, s[40:43], s54 offen offset:3072
    buffer_load_dwordx4 v[144:147], v8, s[40:43], s55 offen offset:0
    buffer_load_dwordx4 v[148:151], v8, s[40:43], s55 offen offset:1024
    buffer_load_dwordx4 v[152:155], v8, s[40:43], s55 offen offset:2048
    buffer_load_dwordx4 v[156:159], v8, s[40:43], s55 offen offset:3072
    s_add_u32 s54, s54, 131072
    s_add_u32 s55, s55, 131072
    s_add_u32 s58, s58, 40960
    v_mfma_f32_32x32x16_bf16 a[0:15], v[160:163], v[32:35], a[0:15]
    ds_read_b64_tr_b16 v[168:169], v18 offset:2048
    v_mfma_f32_32x32x16_bf16 a[16:31], v[164:167], v[32:35], a[16:31]
    ds_read_b64_tr_b16 v[170:171], v18 offset:2560
    v_mfma_f32_32x32x16_bf16 a[32:47], v[160:163], v[36:39], a[32:47]
    ds_read_b64_tr_b16 v[172:173], v19 offset:2048
    v_mfma_f32_32x32x16_bf16 a[48:63], v[164:167], v[36:39], a[48:63]
    ds_read_b64_tr_b16 v[174:175], v19 offset:2560
    v_mfma_f32_32x32x16_bf16 a[64:79], v[160:163], v[40:43], a[64:79]
    v_mfma_f32_32x32x16_bf16 a[80:95], v[164:167], v[40:43], a[80:95]
    v_mfma_f32_32x32x16_bf16 a[96:111], v[160:163], v[44:47], a[96:111]
    v_mfma_f32_32x32x16_bf16 a[112:127], v[164:167], v[44:47], a[112:127]
    s_waitcnt vmcnt(24)
    s_waitcnt lgkmcnt(2)
    v_mfma_f32_32x32x16_bf16 a[0:15], v[168:171], v[48:51], a[0:15]
    ds_read_b64_tr_b16 v[160:161], v18 offset:4096
    s_waitcnt lgkmcnt(1)
    v_mfma_f32_32x32x16_bf16 a[16:31], v[172:175], v[48:51], a[16:31]
    ds_read_b64_tr_b16 v[162:163], v18 offset:4608
    v_mfma_f32_32x32x16_bf16 a[32:47], v[168:171], v[52:55], a[32:47]
    ds_read_b64_tr_b16 v[164:165], v19 offset:4096
    v_mfma_f32_32x32x16_bf16 a[48:63], v[172:175], v[52:55], a[48:63]
    ds_read_b64_tr_b16 v[166:167], v19 offset:4608
    v_mfma_f32_32x32x16_bf16 a[64:79], v[168:171], v[56:59], a[64:79]
    v_mfma_f32_32x32x16_bf16 a[80:95], v[172:175], v[56:59], a[80:95]
    v_mfma_f32_32x32x16_bf16 a[96:111], v[168:171], v[60:63], a[96:111]
    v_mfma_f32_32x32x16_bf16 a[112:127], v[172:175], v[60:63], a[112:127]
    s_sub_u32 s56, s56, 1
    s_cmp_le_u32 s56, 3
    s_cselect_b32 s42, 0, s42
    s_cselect_b32 s46, 0, s46
    s_add_u32 m0, s63, 0
    s_nop 0
    buffer_load_dwordx4 v12, s[44:47], s58 offen offset:0 lds
    buffer_load_dwordx4 v13, s[44:47], s58 offen offset:1024 lds
    buffer_load_dwordx4 v14, s[44:47], s58 offen offset:2048 lds
    buffer_load_dwordx4 v15, s[44:47], s58 offen offset:3072 lds
    buffer_load_dwordx4 v[32:35], v8, s[40:43], s54 offen offset:0
    buffer_load_dwordx4 v[36:39], v8, s[40:43], s54 offen offset:1024
    buffer_load_dwordx4 v[40:43], v8, s[40:43], s54 offen offset:2048
    buffer_load_dwordx4 v[44:47], v8, s[40:43], s54 offen offset:3072
    buffer_load_dwordx4 v[48:51], v8, s[40:43], s55 offen offset:0
    buffer_load_dwordx4 v[52:55], v8, s[40:43], s55 offen offset:1024
    buffer_load_dwordx4 v[56:59], v8, s[40:43], s55 offen offset:2048
    buffer_load_dwordx4 v[60:63], v8, s[40:43], s55 offen offset:3072
    s_add_u32 s54, s54, 131072
    s_add_u32 s55, s55, 131072
    s_add_u32 s58, s58, 40960
    s_waitcnt lgkmcnt(2)
    v_mfma_f32_32x32x16_bf16 a[0:15], v[160:163], v[64:67], a[0:15]
    ds_read_b64_tr_b16 v[168:169], v18 offset:6144
    s_waitcnt lgkmcnt(1)
    v_mfma_f32_32x32x16_bf16 a[16:31], v[164:167], v[64:67], a[16:31]
    ds_read_b64_tr_b16 v[170:171], v18 offset:6656
    v_mfma_f32_32x32x16_bf16 a[32:47], v[160:163], v[68:71], a[32:47]
    ds_read_b64_tr_b16 v[172:173], v19 offset:6144
    v_mfma_f32_32x32x16_bf16 a[48:63], v[164:167], v[68:71], a[48:63]
    ds_read_b64_tr_b16 v[174:175], v19 offset:6656
    v_mfma_f32_32x32x16_bf16 a[64:79], v[160:163], v[72:75], a[64:79]
    v_mfma_f32_32x32x16_bf16 a[80:95], v[164:167], v[72:75], a[80:95]
    v_mfma_f32_32x32x16_bf16 a[96:111], v[160:163], v[76:79], a[96:111]
    v_mfma_f32_32x32x16_bf16 a[112:127], v[164:167], v[76:79], a[112:127]
    s_waitcnt vmcnt(24)
    s_waitcnt lgkmcnt(2)
    v_mfma_f32_32x32x16_bf16 a[0:15], v[168:171], v[80:83], a[0:15]
    ds_read_b64_tr_b16 v[160:161], v18 offset:8192
    s_waitcnt lgkmcnt(1)
    v_mfma_f32_32x32x16_bf16 a[16:31], v[172:175], v[80:83], a[16:31]
    ds_read_b64_tr_b16 v[162:163], v18 offset:8704
    v_mfma_f32_32x32x16_bf16 a[32:47], v[168:171], v[84:87], a[32:47]
    ds_read_b64_tr_b16 v[164:165], v19 offset:8192
    v_mfma_f32_32x32x16_bf16 a[48:63], v[172:175], v[84:87], a[48:63]
    ds_read_b64_tr_b16 v[166:167], v19 offset:8704
    v_mfma_f32_32x32x16_bf16 a[64:79], v[168:171], v[88:91], a[64:79]
    v_mfma_f32_32x32x16_bf16 a[80:95], v[172:175], v[88:91], a[80:95]
    v_mfma_f32_32x32x16_bf16 a[96:111], v[168:171], v[92:95], a[96:111]
    v_mfma_f32_32x32x16_bf16 a[112:127], v[172:175], v[92:95], a[112:127]
    s_sub_u32 s56, s56, 1
    s_cmp_le_u32 s56, 3
    s_cselect_b32 s42, 0, s42
    s_cselect_b32 s46, 0, s46
    s_add_u32 m0, s63, 4096
    s_nop 0
    buffer_load_dwordx4 v12, s[44:47], s58 offen offset:0 lds
    buffer_load_dwordx4 v13, s[44:47], s58 offen offset:1024 lds
    buffer_load_dwordx4 v14, s[44:47], s58 offen offset:2048 lds
    buffer_load_dwordx4 v15, s[44:47], s58 offen offset:3072 lds
    buffer_load_dwordx4 v[64:67], v8, s[40:43], s54 offen offset:0
    buffer_load_dwordx4 v[68:71], v8, s[40:43], s54 offen offset:1024
    buffer_load_dwordx4 v[72:75], v8, s[40:43], s54 offen offset:2048
    buffer_load_dwordx4 v[76:79], v8, s[40:43], s54 offen offset:3072
    buffer_load_dwordx4 v[80:83], v8, s[40:43], s55 offen offset:0
    buffer_load_dwordx4 v[84:87], v8, s[40:43], s55 offen offset:1024
    buffer_load_dwordx4 v[88:91], v8, s[40:43], s55 offen offset:2048
    buffer_load_dwordx4 v[92:95], v8, s[40:43], s55 offen offset:3072
    s_add_u32 s54, s54, 131072
    s_add_u32 s55, s55, 131072
    s_add_u32 s58, s58, 40960
    s_waitcnt lgkmcnt(2)
    v_mfma_f32_32x32x16_bf16 a[0:15], v[160:163], v[96:99], a[0:15]
    ds_read_b64_tr_b16 v[168:169], v18 offset:10240
    s_waitcnt lgkmcnt(1)
    v_mfma_f32_32x32x16_bf16 a[16:31], v[164:167], v[96:99], a[16:31]
    ds_read_b64_tr_b16 v[170:171], v18 offset:10752
    v_mfma_f32_32x32x16_bf16 a[32:47], v[160:163], v[100:103], a[32:47]
    ds_read_b64_tr_b16 v[172:173], v19 offset:10240
    v_mfma_f32_32x32x16_bf16 a[48:63], v[164:167], v[100:103], a[48:63]
    ds_read_b64_tr_b16 v[174:175], v19 offset:10752
    v_mfma_f32_32x32x16_bf16 a[64:79], v[160:163], v[104:107], a[64:79]
    v_mfma_f32_32x32x16_bf16 a[80:95], v[164:167], v[104:107], a[80:95]
    v_mfma_f32_32x32x16_bf16 a[96:111], v[160:163], v[108:111], a[96:111]
    v_mfma_f32_32x32x16_bf16 a[112:127], v[164:167], v[108:111], a[112:127]
    s_waitcnt vmcnt(24)
    s_waitcnt lgkmcnt(2)
    v_mfma_f32_32x32x16_bf16 a[0:15], v[168:171], v[112:115], a[0:15]
    ds_read_b64_tr_b16 v[160:161], v18 offset:12288
    s_waitcnt lgkmcnt(1)
    v_mfma_f32_32x32x16_bf16 a[16:31], v[172:175], v[112:115], a[16:31]
    ds_read_b64_tr_b16 v[162:163], v18 offset:12800
    v_mfma_f32_32x32x16_bf16 a[32:47], v[168:171], v[116:119], a[32:47]
    ds_read_b64_tr_b16 v[164:165], v19 offset:12288
    v_mfma_f32_32x32x16_bf16 a[48:63], v[172:175], v[116:119], a[48:63]
    ds_read_b64_tr_b16 v[166:167], v19 offset:12800
    v_mfma_f32_32x32x16_bf16 a[64:79], v[168:171], v[120:123], a[64:79]
    v_mfma_f32_32x32x16_bf16 a[80:95], v[172:175], v[120:123], a[80:95]
    v_mfma_f32_32x32x16_bf16 a[96:111], v[168:171], v[124:127], a[96:111]
    v_mfma_f32_32x32x16_bf16 a[112:127], v[172:175], v[124:127], a[112:127]
    s_sub_u32 s56, s56, 1
    s_cmp_le_u32 s56, 3
    s_cselect_b32 s42, 0, s42
    s_cselect_b32 s46, 0, s46
    s_add_u32 m0, s63, 8192
    s_nop 0
    buffer_load_dwordx4 v12, s[44:47], s58 offen offset:0 lds
    buffer_load_dwordx4 v13, s[44:47], s58 offen offset:1024 lds
    buffer_load_dwordx4 v14, s[44:47], s58 offen offset:2048 lds
    buffer_load_dwordx4 v15, s[44:47], s58 offen offset:3072 lds
    buffer_load_dwordx4 v[96:99], v8, s[40:43], s54 offen offset:0
    buffer_load_dwordx4 v[100:103], v8, s[40:43], s54 offen offset:1024
    buffer_load_dwordx4 v[104:107], v8, s[40:43], s54 offen offset:2048
    buffer_load_dwordx4 v[108:111], v8, s[40:43], s54 offen offset:3072
    buffer_load_dwordx4 v[112:115], v8, s[40:43], s55 offen offset:0
    buffer_load_dwordx4 v[116:119], v8, s[40:43], s55 offen offset:1024
    buffer_load_dwordx4 v[120:123], v8, s[40:43], s55 offen offset:2048
    buffer_load_dwordx4 v[124:127], v8, s[40:43], s55 offen offset:3072
    s_add_u32 s54, s54, 131072
    s_add_u32 s55, s55, 131072
    s_add_u32 s58, s58, 40960
    s_waitcnt lgkmcnt(2)
    v_mfma_f32_32x32x16_bf16 a[0:15], v[160:163], v[128:131], a[0:15]
    ds_read_b64_tr_b16 v[168:169], v18 offset:14336
    s_waitcnt lgkmcnt(1)
    v_mfma_f32_32x32x16_bf16 a[16:31], v[164:167], v[128:131], a[16:31]
    ds_read_b64_tr_b16 v[170:171], v18 offset:14848
    v_mfma_f32_32x32x16_bf16 a[32:47], v[160:163], v[132:135], a[32:47]
    ds_read_b64_tr_b16 v[172:173], v19 offset:14336
    v_mfma_f32_32x32x16_bf16 a[48:63], v[164:167], v[132:135], a[48:63]
    ds_read_b64_tr_b16 v[174:175], v19 offset:14848
    v_mfma_f32_32x32x16_bf16 a[64:79], v[160:163], v[136:139], a[64:79]
    v_mfma_f32_32x32x16_bf16 a[80:95], v[164:167], v[136:139], a[80:95]
    v_mfma_f32_32x32x16_bf16 a[96:111], v[160:163], v[140:143], a[96:111]
    v_mfma_f32_32x32x16_bf16 a[112:127], v[164:167], v[140:143], a[112:127]
    s_waitcnt vmcnt(24)
    s_waitcnt lgkmcnt(2)
    v_mfma_f32_32x32x16_bf16 a[0:15], v[168:171], v[144:147], a[0:15]
    ds_read_b64_tr_b16 v[160:161], v18 offset:0
    s_waitcnt lgkmcnt(1)
    v_mfma_f32_32x32x16_bf16 a[16:31], v[172:175], v[144:147], a[16:31]
    ds_read_b64_tr_b16 v[162:163], v18 offset:512
    v_mfma_f32_32x32x16_bf16 a[32:47], v[168:171], v[148:151], a[32:47]
    ds_read_b64_tr_b16 v[164:165], v19 offset:0
    v_mfma_f32_32x32x16_bf16 a[48:63], v[172:175], v[148:151], a[48:63]
    ds_read_b64_tr_b16 v[166:167], v19 offset:512
    v_mfma_f32_32x32x16_bf16 a[64:79], v[168:171], v[152:155], a[64:79]
    v_mfma_f32_32x32x16_bf16 a[80:95], v[172:175], v[152:155], a[80:95]
    v_mfma_f32_32x32x16_bf16 a[96:111], v[168:171], v[156:159], a[96:111]
    v_mfma_f32_32x32x16_bf16 a[112:127], v[172:175], v[156:159], a[112:127]
    s_sub_u32 s56, s56, 1
    s_cmp_eq_u32 s56, 0
    s_waitcnt lgkmcnt(0)
    s_nop 8
    s_cbranch_scc1 od_81
    s_branch ol_80
od_81:
    s_waitcnt vmcnt(0) lgkmcnt(0)
    s_nop 15
    v_lshlrev_b32 v2, 4, v1
    v_add_u32 v3, s63, v2
    ds_write_b128 v3, a[0:3] offset:0
    ds_write_b128 v3, a[4:7] offset:1024
    ds_write_b128 v3, a[8:11] offset:2048
    ds_write_b128 v3, a[12:15] offset:3072
    ds_write_b128 v3, a[16:19] offset:4096
    ds_write_b128 v3, a[20:23] offset:5120
    ds_write_b128 v3, a[24:27] offset:6144
    ds_write_b128 v3, a[28:31] offset:7168
    s_waitcnt lgkmcnt(0)
    ds_write_b128 v3, a[32:35] offset:8192
    ds_write_b128 v3, a[36:39] offset:9216
    ds_write_b128 v3, a[40:43] offset:10240
    ds_write_b128 v3, a[44:47] offset:11264
    ds_write_b128 v3, a[48:51] offset:12288
    ds_write_b128 v3, a[52:55] offset:13312
    ds_write_b128 v3, a[56:59] offset:14336
    ds_write_b128 v3, a[60:63] offset:15360
    s_waitcnt lgkmcnt(0)
    ds_write_b128 v3, a[64:67] offset:16384
    ds_write_b128 v3, a[68:71] offset:17408
    ds_write_b128 v3, a[72:75] offset:18432
    ds_write_b128 v3, a[76:79] offset:19456
    ds_write_b128 v3, a[80:83] offset:20480
    ds_write_b128 v3, a[84:87] offset:21504
    ds_write_b128 v3, a[88:91] offset:22528
    ds_write_b128 v3, a[92:95] offset:23552
    s_waitcnt lgkmcnt(0)
    ds_write_b128 v3, a[96:99] offset:24576
    ds_write_b128 v3, a[100:103] offset:25600
    ds_write_b128 v3, a[104:107] offset:26624
    ds_write_b128 v3, a[108:111] offset:27648
    ds_write_b128 v3, a[112:115] offset:28672
    ds_write_b128 v3, a[116:119] offset:29696
    ds_write_b128 v3, a[120:123] offset:30720
    ds_write_b128 v3, a[124:127] offset:31744
    s_waitcnt lgkmcnt(0)
    s_barrier
    s_lshl_b32 s60, s57, 13
    v_add_u32 v3, s60, v2
    v_add_u32 v4, 0x10000, v3
    ds_read_b128 v[32:35], v3 offset:0
    ds_read_b128 v[36:39], v3 offset:1024
    ds_read_b128 v[40:43], v3 offset:2048
    ds_read_b128 v[44:47], v3 offset:3072
    ds_read_b128 v[48:51], v3 offset:4096
    ds_read_b128 v[52:55], v3 offset:5120
    ds_read_b128 v[56:59], v3 offset:6144
    ds_read_b128 v[60:63], v3 offset:7168
    s_waitcnt lgkmcnt(0)
    ds_read_b128 v[64:67], v3 offset:32768
    ds_read_b128 v[68:71], v3 offset:33792
    ds_read_b128 v[72:75], v3 offset:34816
    ds_read_b128 v[76:79], v3 offset:35840
    ds_read_b128 v[80:83], v3 offset:36864
    ds_read_b128 v[84:87], v3 offset:37888
    ds_read_b128 v[88:91], v3 offset:38912
    ds_read_b128 v[92:95], v3 offset:39936
    s_waitcnt lgkmcnt(7)
    v_add_f32 v32, v32, v64
    v_add_f32 v33, v33, v65
    v_add_f32 v34, v34, v66
    v_add_f32 v35, v35, v67
    s_waitcnt lgkmcnt(6)
    v_add_f32 v36, v36, v68
    v_add_f32 v37, v37, v69
    v_add_f32 v38, v38, v70
    v_add_f32 v39, v39, v71
    s_waitcnt lgkmcnt(5)
    v_add_f32 v40, v40, v72
    v_add_f32 v41, v41, v73
    v_add_f32 v42, v42, v74
    v_add_f32 v43, v43, v75
    s_waitcnt lgkmcnt(4)
    v_add_f32 v44, v44, v76
    v_add_f32 v45, v45, v77
    v_add_f32 v46, v46, v78
    v_add_f32 v47, v47, v79
    s_waitcnt lgkmcnt(3)
    v_add_f32 v48, v48, v80
    v_add_f32 v49, v49, v81
    v_add_f32 v50, v50, v82
    v_add_f32 v51, v51, v83
    s_waitcnt lgkmcnt(2)
    v_add_f32 v52, v52, v84
    v_add_f32 v53, v53, v85
    v_add_f32 v54, v54, v86
    v_add_f32 v55, v55, v87
    s_waitcnt lgkmcnt(1)
    v_add_f32 v56, v56, v88
    v_add_f32 v57, v57, v89
    v_add_f32 v58, v58, v90
    v_add_f32 v59, v59, v91
    s_waitcnt lgkmcnt(0)
    v_add_f32 v60, v60, v92
    v_add_f32 v61, v61, v93
    v_add_f32 v62, v62, v94
    v_add_f32 v63, v63, v95
    ds_read_b128 v[96:99], v4 offset:0
    ds_read_b128 v[100:103], v4 offset:1024
    ds_read_b128 v[104:107], v4 offset:2048
    ds_read_b128 v[108:111], v4 offset:3072
    ds_read_b128 v[112:115], v4 offset:4096
    ds_read_b128 v[116:119], v4 offset:5120
    ds_read_b128 v[120:123], v4 offset:6144
    ds_read_b128 v[124:127], v4 offset:7168
    s_waitcnt lgkmcnt(0)
    ds_read_b128 v[128:131], v4 offset:32768
    ds_read_b128 v[132:135], v4 offset:33792
    ds_read_b128 v[136:139], v4 offset:34816
    ds_read_b128 v[140:143], v4 offset:35840
    ds_read_b128 v[144:147], v4 offset:36864
    ds_read_b128 v[148:151], v4 offset:37888
    ds_read_b128 v[152:155], v4 offset:38912
    ds_read_b128 v[156:159], v4 offset:39936
    s_waitcnt lgkmcnt(7)
    v_add_f32 v96, v96, v128
    v_add_f32 v97, v97, v129
    v_add_f32 v98, v98, v130
    v_add_f32 v99, v99, v131
    s_waitcnt lgkmcnt(6)
    v_add_f32 v100, v100, v132
    v_add_f32 v101, v101, v133
    v_add_f32 v102, v102, v134
    v_add_f32 v103, v103, v135
    s_waitcnt lgkmcnt(5)
    v_add_f32 v104, v104, v136
    v_add_f32 v105, v105, v137
    v_add_f32 v106, v106, v138
    v_add_f32 v107, v107, v139
    s_waitcnt lgkmcnt(4)
    v_add_f32 v108, v108, v140
    v_add_f32 v109, v109, v141
    v_add_f32 v110, v110, v142
    v_add_f32 v111, v111, v143
    s_waitcnt lgkmcnt(3)
    v_add_f32 v112, v112, v144
    v_add_f32 v113, v113, v145
    v_add_f32 v114, v114, v146
    v_add_f32 v115, v115, v147
    s_waitcnt lgkmcnt(2)
    v_add_f32 v116, v116, v148
    v_add_f32 v117, v117, v149
    v_add_f32 v118, v118, v150
    v_add_f32 v119, v119, v151
    s_waitcnt lgkmcnt(1)
    v_add_f32 v120, v120, v152
    v_add_f32 v121, v121, v153
    v_add_f32 v122, v122, v154
    v_add_f32 v123, v123, v155
    s_waitcnt lgkmcnt(0)
    v_add_f32 v124, v124, v156
    v_add_f32 v125, v125, v157
    v_add_f32 v126, v126, v158
    v_add_f32 v127, v127, v159
    v_add_f32 v32, v32, v96
    v_add_f32 v33, v33, v97
    v_add_f32 v34, v34, v98
    v_add_f32 v35, v35, v99
    v_add_f32 v36, v36, v100
    v_add_f32 v37, v37, v101
    v_add_f32 v38, v38, v102
    v_add_f32 v39, v39, v103
    v_add_f32 v40, v40, v104
    v_add_f32 v41, v41, v105
    v_add_f32 v42, v42, v106
    v_add_f32 v43, v43, v107
    v_add_f32 v44, v44, v108
    v_add_f32 v45, v45, v109
    v_add_f32 v46, v46, v110
    v_add_f32 v47, v47, v111
    v_add_f32 v48, v48, v112
    v_add_f32 v49, v49, v113
    v_add_f32 v50, v50, v114
    v_add_f32 v51, v51, v115
    v_add_f32 v52, v52, v116
    v_add_f32 v53, v53, v117
    v_add_f32 v54, v54, v118
    v_add_f32 v55, v55, v119
    v_add_f32 v56, v56, v120
    v_add_f32 v57, v57, v121
    v_add_f32 v58, v58, v122
    v_add_f32 v59, v59, v123
    v_add_f32 v60, v60, v124
    v_add_f32 v61, v61, v125
    v_add_f32 v62, v62, v126
    v_add_f32 v63, v63, v127
    s_mov_b32 s48, s34
    s_mov_b32 s49, s35
    s_and_b32 s49, s49, 0xffff
    s_mov_b32 s50, 5242880
    s_mov_b32 s51, 0x00020000
    v_and_b32 v2, 31, v1
    s_lshl_b32 s60, s57, 5
    s_add_u32 s60, s60, s52
    v_add_u32 v2, s60, v2
    v_mul_u32_u24 v2, 2560, v2
    v_lshrrev_b32 v3, 5, v1
    v_lshlrev_b32 v3, 3, v3
    s_lshl_b32 s60, s53, 1
    s_add_u32 s60, s60, 1280
    v_add3_u32 v2, v2, v3, s60
    v_cvt_pk_bf16_f32 v176, v32, v33
    v_cvt_pk_bf16_f32 v177, v34, v35
    buffer_store_dwordx2 v[176:177], v2, s[48:51], 0 offen offset:0
    v_cvt_pk_bf16_f32 v178, v36, v37
    v_cvt_pk_bf16_f32 v179, v38, v39
    buffer_store_dwordx2 v[178:179], v2, s[48:51], 0 offen offset:16
    v_cvt_pk_bf16_f32 v180, v40, v41
    v_cvt_pk_bf16_f32 v181, v42, v43
    buffer_store_dwordx2 v[180:181], v2, s[48:51], 0 offen offset:32
    v_cvt_pk_bf16_f32 v182, v44, v45
    v_cvt_pk_bf16_f32 v183, v46, v47
    buffer_store_dwordx2 v[182:183], v2, s[48:51], 0 offen offset:48
    v_cvt_pk_bf16_f32 v184, v48, v49
    v_cvt_pk_bf16_f32 v185, v50, v51
    buffer_store_dwordx2 v[184:185], v2, s[48:51], 0 offen offset:64
    v_cvt_pk_bf16_f32 v186, v52, v53
    v_cvt_pk_bf16_f32 v187, v54, v55
    buffer_store_dwordx2 v[186:187], v2, s[48:51], 0 offen offset:80
    v_cvt_pk_bf16_f32 v188, v56, v57
    v_cvt_pk_bf16_f32 v189, v58, v59
    buffer_store_dwordx2 v[188:189], v2, s[48:51], 0 offen offset:96
    v_cvt_pk_bf16_f32 v190, v60, v61
    v_cvt_pk_bf16_f32 v191, v62, v63
    buffer_store_dwordx2 v[190:191], v2, s[48:51], 0 offen offset:112
    s_endpgm
oj_79:
    s_add_u32 s40, s38, 62914560
    s_addc_u32 s41, s39, 0
    s_and_b32 s41, s41, 0xffff
    s_mov_b32 s42, 2621440
    s_mov_b32 s43, 0x00020000
    s_mov_b32 s44, s20
    s_mov_b32 s45, s21
    s_and_b32 s45, s45, 0xffff
    s_mov_b32 s46, 819200
    s_mov_b32 s47, 0x00020000
    v_and_b32 v1, 63, v0
    v_lshrrev_b32 v2, 6, v0
    s_nop 0
    v_readfirstlane_b32 s57, v2
    v_and_b32 v2, 31, v1
    v_add_u32 v2, s52, v2
    v_lshlrev_b32 v2, 5, v2
    v_lshrrev_b32 v3, 5, v1
    v_lshl_add_u32 v8, v3, 4, v2
    v_lshrrev_b32 v2, 3, v1
    v_and_b32 v3, 7, v1
    v_lshrrev_b32 v4, 2, v3
    v_bfe_u32 v5, v1, 4, 1
    v_xor_b32 v4, v4, v5
    v_and_b32 v3, 3, v3
    v_lshlrev_b32 v3, 4, v3
    v_lshl_add_u32 v3, v4, 6, v3
    s_mov_b32 s61, 1280
    v_mul_lo_u32 v2, v2, s61
    v_add_u32 v2, v2, v3
    s_lshl_b32 s60, s53, 1
    v_add_u32 v2, s60, v2
    v_add_u32 v12, 0, v2
    v_add_u32 v13, 9216, v2
    v_add_u32 v14, 18432, v2
    v_add_u32 v15, 27648, v2
    s_lshl_b32 s63, s57, 15
    v_bfe_u32 v2, v1, 2, 2
    v_lshrrev_b32 v3, 5, v1
    v_lshl_add_u32 v3, v3, 3, v2
    v_mul_u32_u24 v3, 128, v3
    v_lshrrev_b32 v4, 1, v2
    v_lshl_add_u32 v3, v4, 6, v3
    v_bfe_u32 v4, v1, 4, 1
    v_and_b32 v5, 3, v1
    v_lshlrev_b32 v5, 3, v5
    v_lshl_add_u32 v5, v4, 5, v5
    v_add_u32 v3, v3, v5
    v_add_u32 v18, s63, v3
    v_xor_b32 v19, 64, v18
    s_mul_i32 s54, s57, 655360
    s_add_u32 s55, s54, 65536
    s_mul_i32 s58, s57, 204800
    v_accvgpr_write_b32 a0, 0
    v_accvgpr_write_b32 a1, 0
    v_accvgpr_write_b32 a2, 0
    v_accvgpr_write_b32 a3, 0
    v_accvgpr_write_b32 a4, 0
    v_accvgpr_write_b32 a5, 0
    v_accvgpr_write_b32 a6, 0
    v_accvgpr_write_b32 a7, 0
    v_accvgpr_write_b32 a8, 0
    v_accvgpr_write_b32 a9, 0
    v_accvgpr_write_b32 a10, 0
    v_accvgpr_write_b32 a11, 0
    v_accvgpr_write_b32 a12, 0
    v_accvgpr_write_b32 a13, 0
    v_accvgpr_write_b32 a14, 0
    v_accvgpr_write_b32 a15, 0
    v_accvgpr_write_b32 a16, 0
    v_accvgpr_write_b32 a17, 0
    v_accvgpr_write_b32 a18, 0
    v_accvgpr_write_b32 a19, 0
    v_accvgpr_write_b32 a20, 0
    v_accvgpr_write_b32 a21, 0
    v_accvgpr_write_b32 a22, 0
    v_accvgpr_write_b32 a23, 0
    v_accvgpr_write_b32 a24, 0
    v_accvgpr_write_b32 a25, 0
    v_accvgpr_write_b32 a26, 0
    v_accvgpr_write_b32 a27, 0
    v_accvgpr_write_b32 a28, 0
    v_accvgpr_write_b32 a29, 0
    v_accvgpr_write_b32 a30, 0
    v_accvgpr_write_b32 a31, 0
    v_accvgpr_write_b32 a32, 0
    v_accvgpr_write_b32 a33, 0
    v_accvgpr_write_b32 a34, 0
    v_accvgpr_write_b32 a35, 0
    v_accvgpr_write_b32 a36, 0
    v_accvgpr_write_b32 a37, 0
    v_accvgpr_write_b32 a38, 0
    v_accvgpr_write_b32 a39, 0
    v_accvgpr_write_b32 a40, 0
    v_accvgpr_write_b32 a41, 0
    v_accvgpr_write_b32 a42, 0
    v_accvgpr_write_b32 a43, 0
    v_accvgpr_write_b32 a44, 0
    v_accvgpr_write_b32 a45, 0
    v_accvgpr_write_b32 a46, 0
    v_accvgpr_write_b32 a47, 0
    v_accvgpr_write_b32 a48, 0
    v_accvgpr_write_b32 a49, 0
    v_accvgpr_write_b32 a50, 0
    v_accvgpr_write_b32 a51, 0
    v_accvgpr_write_b32 a52, 0
    v_accvgpr_write_b32 a53, 0
    v_accvgpr_write_b32 a54, 0
    v_accvgpr_write_b32 a55, 0
    v_accvgpr_write_b32 a56, 0
    v_accvgpr_write_b32 a57, 0
    v_accvgpr_write_b32 a58, 0
    v_accvgpr_write_b32 a59, 0
    v_accvgpr_write_b32 a60, 0
    v_accvgpr_write_b32 a61, 0
    v_accvgpr_write_b32 a62, 0
    v_accvgpr_write_b32 a63, 0
    v_accvgpr_write_b32 a64, 0
    v_accvgpr_write_b32 a65, 0
    v_accvgpr_write_b32 a66, 0
    v_accvgpr_write_b32 a67, 0
    v_accvgpr_write_b32 a68, 0
    v_accvgpr_write_b32 a69, 0
    v_accvgpr_write_b32 a70, 0
    v_accvgpr_write_b32 a71, 0
    v_accvgpr_write_b32 a72, 0
    v_accvgpr_write_b32 a73, 0
    v_accvgpr_write_b32 a74, 0
    v_accvgpr_write_b32 a75, 0
    v_accvgpr_write_b32 a76, 0
    v_accvgpr_write_b32 a77, 0
    v_accvgpr_write_b32 a78, 0
    v_accvgpr_write_b32 a79, 0
    v_accvgpr_write_b32 a80, 0
    v_accvgpr_write_b32 a81, 0
    v_accvgpr_write_b32 a82, 0
    v_accvgpr_write_b32 a83, 0
    v_accvgpr_write_b32 a84, 0
    v_accvgpr_write_b32 a85, 0
    v_accvgpr_write_b32 a86, 0
    v_accvgpr_write_b32 a87, 0
    v_accvgpr_write_b32 a88, 0
    v_accvgpr_write_b32 a89, 0
    v_accvgpr_write_b32 a90, 0
    v_accvgpr_write_b32 a91, 0
    v_accvgpr_write_b32 a92, 0
    v_accvgpr_write_b32 a93, 0
    v_accvgpr_write_b32 a94, 0
    v_accvgpr_write_b32 a95, 0
    v_accvgpr_write_b32 a96, 0
    v_accvgpr_write_b32 a97, 0
    v_accvgpr_write_b32 a98, 0
    v_accvgpr_write_b32 a99, 0
    v_accvgpr_write_b32 a100, 0
    v_accvgpr_write_b32 a101, 0
    v_accvgpr_write_b32 a102, 0
    v_accvgpr_write_b32 a103, 0
    v_accvgpr_write_b32 a104, 0
    v_accvgpr_write_b32 a105, 0
    v_accvgpr_write_b32 a106, 0
    v_accvgpr_write_b32 a107, 0
    v_accvgpr_write_b32 a108, 0
    v_accvgpr_write_b32 a109, 0
    v_accvgpr_write_b32 a110, 0
    v_accvgpr_write_b32 a111, 0
    v_accvgpr_write_b32 a112, 0
    v_accvgpr_write_b32 a113, 0
    v_accvgpr_write_b32 a114, 0
    v_accvgpr_write_b32 a115, 0
    v_accvgpr_write_b32 a116, 0
    v_accvgpr_write_b32 a117, 0
    v_accvgpr_write_b32 a118, 0
    v_accvgpr_write_b32 a119, 0
    v_accvgpr_write_b32 a120, 0
    v_accvgpr_write_b32 a121, 0
    v_accvgpr_write_b32 a122, 0
    v_accvgpr_write_b32 a123, 0
    v_accvgpr_write_b32 a124, 0
    v_accvgpr_write_b32 a125, 0
    v_accvgpr_write_b32 a126, 0
    v_accvgpr_write_b32 a127, 0
    s_add_u32 m0, s63, 0
    s_nop 0
    buffer_load_dwordx4 v12, s[44:47], s58 offen offset:0 lds
    buffer_load_dwordx4 v13, s[44:47], s58 offen offset:1024 lds
    buffer_load_dwordx4 v14, s[44:47], s58 offen offset:2048 lds
    buffer_load_dwordx4 v15, s[44:47], s58 offen offset:3072 lds
    buffer_load_dwordx4 v[32:35], v8, s[40:43], s54 offen offset:0
    buffer_load_dwordx4 v[36:39], v8, s[40:43], s54 offen offset:1024
    buffer_load_dwordx4 v[40:43], v8, s[40:43], s54 offen offset:2048
    buffer_load_dwordx4 v[44:47], v8, s[40:43], s54 offen offset:3072
    buffer_load_dwordx4 v[48:51], v8, s[40:43], s55 offen offset:0
    buffer_load_dwordx4 v[52:55], v8, s[40:43], s55 offen offset:1024
    buffer_load_dwordx4 v[56:59], v8, s[40:43], s55 offen offset:2048
    buffer_load_dwordx4 v[60:63], v8, s[40:43], s55 offen offset:3072
    s_add_u32 s54, s54, 131072
    s_add_u32 s55, s55, 131072
    s_add_u32 s58, s58, 40960
    s_add_u32 m0, s63, 4096
    s_nop 0
    buffer_load_dwordx4 v12, s[44:47], s58 offen offset:0 lds
    buffer_load_dwordx4 v13, s[44:47], s58 offen offset:1024 lds
    buffer_load_dwordx4 v14, s[44:47], s58 offen offset:2048 lds
    buffer_load_dwordx4 v15, s[44:47], s58 offen offset:3072 lds
    buffer_load_dwordx4 v[64:67], v8, s[40:43], s54 offen offset:0
    buffer_load_dwordx4 v[68:71], v8, s[40:43], s54 offen offset:1024
    buffer_load_dwordx4 v[72:75], v8, s[40:43], s54 offen offset:2048
    buffer_load_dwordx4 v[76:79], v8, s[40:43], s54 offen offset:3072
    buffer_load_dwordx4 v[80:83], v8, s[40:43], s55 offen offset:0
    buffer_load_dwordx4 v[84:87], v8, s[40:43], s55 offen offset:1024
    buffer_load_dwordx4 v[88:91], v8, s[40:43], s55 offen offset:2048
    buffer_load_dwordx4 v[92:95], v8, s[40:43], s55 offen offset:3072
    s_add_u32 s54, s54, 131072
    s_add_u32 s55, s55, 131072
    s_add_u32 s58, s58, 40960
    s_add_u32 m0, s63, 8192
    s_nop 0
    buffer_load_dwordx4 v12, s[44:47], s58 offen offset:0 lds
    buffer_load_dwordx4 v13, s[44:47], s58 offen offset:1024 lds
    buffer_load_dwordx4 v14, s[44:47], s58 offen offset:2048 lds
    buffer_load_dwordx4 v15, s[44:47], s58 offen offset:3072 lds
    buffer_load_dwordx4 v[96:99], v8, s[40:43], s54 offen offset:0
    buffer_load_dwordx4 v[100:103], v8, s[40:43], s54 offen offset:1024
    buffer_load_dwordx4 v[104:107], v8, s[40:43], s54 offen offset:2048
    buffer_load_dwordx4 v[108:111], v8, s[40:43], s54 offen offset:3072
    buffer_load_dwordx4 v[112:115], v8, s[40:43], s55 offen offset:0
    buffer_load_dwordx4 v[116:119], v8, s[40:43], s55 offen offset:1024
    buffer_load_dwordx4 v[120:123], v8, s[40:43], s55 offen offset:2048
    buffer_load_dwordx4 v[124:127], v8, s[40:43], s55 offen offset:3072
    s_add_u32 s54, s54, 131072
    s_add_u32 s55, s55, 131072
    s_add_u32 s58, s58, 40960
    s_mov_b32 s56, 5
    s_waitcnt vmcnt(24)
    ds_read_b64_tr_b16 v[160:161], v18 offset:0
    ds_read_b64_tr_b16 v[162:163], v18 offset:512
    ds_read_b64_tr_b16 v[164:165], v19 offset:0
    ds_read_b64_tr_b16 v[166:167], v19 offset:512
    s_waitcnt lgkmcnt(0)
ol_82:
    s_cmp_le_u32 s56, 3
    s_cselect_b32 s42, 0, s42
    s_cselect_b32 s46, 0, s46
    s_add_u32 m0, s63, 12288
    s_nop 0
    buffer_load_dwordx4 v12, s[44:47], s58 offen offset:0 lds
    buffer_load_dwordx4 v13, s[44:47], s58 offen offset:1024 lds
    buffer_load_dwordx4 v14, s[44:47], s58 offen offset:2048 lds
    buffer_load_dwordx4 v15, s[44:47], s58 offen offset:3072 lds
    buffer_load_dwordx4 v[128:131], v8, s[40:43], s54 offen offset:0
    buffer_load_dwordx4 v[132:135], v8, s[40:43], s54 offen offset:1024
    buffer_load_dwordx4 v[136:139], v8, s[40:43], s54 offen offset:2048
    buffer_load_dwordx4 v[140:143], v8, s[40:43], s54 offen offset:3072
    buffer_load_dwordx4 v[144:147], v8, s[40:43], s55 offen offset:0
    buffer_load_dwordx4 v[148:151], v8, s[40:43], s55 offen offset:1024
    buffer_load_dwordx4 v[152:155], v8, s[40:43], s55 offen offset:2048
    buffer_load_dwordx4 v[156:159], v8, s[40:43], s55 offen offset:3072
    s_add_u32 s54, s54, 131072
    s_add_u32 s55, s55, 131072
    s_add_u32 s58, s58, 40960
    v_mfma_f32_32x32x16_bf16 a[0:15], v[160:163], v[32:35], a[0:15]
    ds_read_b64_tr_b16 v[168:169], v18 offset:2048
    v_mfma_f32_32x32x16_bf16 a[16:31], v[164:167], v[32:35], a[16:31]
    ds_read_b64_tr_b16 v[170:171], v18 offset:2560
    v_mfma_f32_32x32x16_bf16 a[32:47], v[160:163], v[36:39], a[32:47]
    ds_read_b64_tr_b16 v[172:173], v19 offset:2048
    v_mfma_f32_32x32x16_bf16 a[48:63], v[164:167], v[36:39], a[48:63]
    ds_read_b64_tr_b16 v[174:175], v19 offset:2560
    v_mfma_f32_32x32x16_bf16 a[64:79], v[160:163], v[40:43], a[64:79]
    v_mfma_f32_32x32x16_bf16 a[80:95], v[164:167], v[40:43], a[80:95]
    v_mfma_f32_32x32x16_bf16 a[96:111], v[160:163], v[44:47], a[96:111]
    v_mfma_f32_32x32x16_bf16 a[112:127], v[164:167], v[44:47], a[112:127]
    s_waitcnt vmcnt(24)
    s_waitcnt lgkmcnt(2)
    v_mfma_f32_32x32x16_bf16 a[0:15], v[168:171], v[48:51], a[0:15]
    ds_read_b64_tr_b16 v[160:161], v18 offset:4096
    s_waitcnt lgkmcnt(1)
    v_mfma_f32_32x32x16_bf16 a[16:31], v[172:175], v[48:51], a[16:31]
    ds_read_b64_tr_b16 v[162:163], v18 offset:4608
    v_mfma_f32_32x32x16_bf16 a[32:47], v[168:171], v[52:55], a[32:47]
    ds_read_b64_tr_b16 v[164:165], v19 offset:4096
    v_mfma_f32_32x32x16_bf16 a[48:63], v[172:175], v[52:55], a[48:63]
    ds_read_b64_tr_b16 v[166:167], v19 offset:4608
    v_mfma_f32_32x32x16_bf16 a[64:79], v[168:171], v[56:59], a[64:79]
    v_mfma_f32_32x32x16_bf16 a[80:95], v[172:175], v[56:59], a[80:95]
    v_mfma_f32_32x32x16_bf16 a[96:111], v[168:171], v[60:63], a[96:111]
    v_mfma_f32_32x32x16_bf16 a[112:127], v[172:175], v[60:63], a[112:127]
    s_sub_u32 s56, s56, 1
    s_cmp_eq_u32 s56, 0
    s_waitcnt lgkmcnt(0)
    s_nop 8
    s_cbranch_scc1 od_83
    s_cmp_le_u32 s56, 3
    s_cselect_b32 s42, 0, s42
    s_cselect_b32 s46, 0, s46
    s_add_u32 m0, s63, 0
    s_nop 0
    buffer_load_dwordx4 v12, s[44:47], s58 offen offset:0 lds
    buffer_load_dwordx4 v13, s[44:47], s58 offen offset:1024 lds
    buffer_load_dwordx4 v14, s[44:47], s58 offen offset:2048 lds
    buffer_load_dwordx4 v15, s[44:47], s58 offen offset:3072 lds
    buffer_load_dwordx4 v[32:35], v8, s[40:43], s54 offen offset:0
    buffer_load_dwordx4 v[36:39], v8, s[40:43], s54 offen offset:1024
    buffer_load_dwordx4 v[40:43], v8, s[40:43], s54 offen offset:2048
    buffer_load_dwordx4 v[44:47], v8, s[40:43], s54 offen offset:3072
    buffer_load_dwordx4 v[48:51], v8, s[40:43], s55 offen offset:0
    buffer_load_dwordx4 v[52:55], v8, s[40:43], s55 offen offset:1024
    buffer_load_dwordx4 v[56:59], v8, s[40:43], s55 offen offset:2048
    buffer_load_dwordx4 v[60:63], v8, s[40:43], s55 offen offset:3072
    s_add_u32 s54, s54, 131072
    s_add_u32 s55, s55, 131072
    s_add_u32 s58, s58, 40960
    v_mfma_f32_32x32x16_bf16 a[0:15], v[160:163], v[64:67], a[0:15]
    ds_read_b64_tr_b16 v[168:169], v18 offset:6144
    v_mfma_f32_32x32x16_bf16 a[16:31], v[164:167], v[64:67], a[16:31]
    ds_read_b64_tr_b16 v[170:171], v18 offset:6656
    v_mfma_f32_32x32x16_bf16 a[32:47], v[160:163], v[68:71], a[32:47]
    ds_read_b64_tr_b16 v[172:173], v19 offset:6144
    v_mfma_f32_32x32x16_bf16 a[48:63], v[164:167], v[68:71], a[48:63]
    ds_read_b64_tr_b16 v[174:175], v19 offset:6656
    v_mfma_f32_32x32x16_bf16 a[64:79], v[160:163], v[72:75], a[64:79]
    v_mfma_f32_32x32x16_bf16 a[80:95], v[164:167], v[72:75], a[80:95]
    v_mfma_f32_32x32x16_bf16 a[96:111], v[160:163], v[76:79], a[96:111]
    v_mfma_f32_32x32x16_bf16 a[112:127], v[164:167], v[76:79], a[112:127]
    s_waitcnt vmcnt(24)
    s_waitcnt lgkmcnt(2)
    v_mfma_f32_32x32x16_bf16 a[0:15], v[168:171], v[80:83], a[0:15]
    ds_read_b64_tr_b16 v[160:161], v18 offset:8192
    s_waitcnt lgkmcnt(1)
    v_mfma_f32_32x32x16_bf16 a[16:31], v[172:175], v[80:83], a[16:31]
    ds_read_b64_tr_b16 v[162:163], v18 offset:8704
    v_mfma_f32_32x32x16_bf16 a[32:47], v[168:171], v[84:87], a[32:47]
    ds_read_b64_tr_b16 v[164:165], v19 offset:8192
    v_mfma_f32_32x32x16_bf16 a[48:63], v[172:175], v[84:87], a[48:63]
    ds_read_b64_tr_b16 v[166:167], v19 offset:8704
    v_mfma_f32_32x32x16_bf16 a[64:79], v[168:171], v[88:91], a[64:79]
    v_mfma_f32_32x32x16_bf16 a[80:95], v[172:175], v[88:91], a[80:95]
    v_mfma_f32_32x32x16_bf16 a[96:111], v[168:171], v[92:95], a[96:111]
    v_mfma_f32_32x32x16_bf16 a[112:127], v[172:175], v[92:95], a[112:127]
    s_sub_u32 s56, s56, 1
    s_cmp_eq_u32 s56, 0
    s_waitcnt lgkmcnt(0)
    s_nop 8
    s_cbranch_scc1 od_83
    s_cmp_le_u32 s56, 3
    s_cselect_b32 s42, 0, s42
    s_cselect_b32 s46, 0, s46
    s_add_u32 m0, s63, 4096
    s_nop 0
    buffer_load_dwordx4 v12, s[44:47], s58 offen offset:0 lds
    buffer_load_dwordx4 v13, s[44:47], s58 offen offset:1024 lds
    buffer_load_dwordx4 v14, s[44:47], s58 offen offset:2048 lds
    buffer_load_dwordx4 v15, s[44:47], s58 offen offset:3072 lds
    buffer_load_dwordx4 v[64:67], v8, s[40:43], s54 offen offset:0
    buffer_load_dwordx4 v[68:71], v8, s[40:43], s54 offen offset:1024
    buffer_load_dwordx4 v[72:75], v8, s[40:43], s54 offen offset:2048
    buffer_load_dwordx4 v[76:79], v8, s[40:43], s54 offen offset:3072
    buffer_load_dwordx4 v[80:83], v8, s[40:43], s55 offen offset:0
    buffer_load_dwordx4 v[84:87], v8, s[40:43], s55 offen offset:1024
    buffer_load_dwordx4 v[88:91], v8, s[40:43], s55 offen offset:2048
    buffer_load_dwordx4 v[92:95], v8, s[40:43], s55 offen offset:3072
    s_add_u32 s54, s54, 131072
    s_add_u32 s55, s55, 131072
    s_add_u32 s58, s58, 40960
    v_mfma_f32_32x32x16_bf16 a[0:15], v[160:163], v[96:99], a[0:15]
    ds_read_b64_tr_b16 v[168:169], v18 offset:10240
    v_mfma_f32_32x32x16_bf16 a[16:31], v[164:167], v[96:99], a[16:31]
    ds_read_b64_tr_b16 v[170:171], v18 offset:10752
    v_mfma_f32_32x32x16_bf16 a[32:47], v[160:163], v[100:103], a[32:47]
    ds_read_b64_tr_b16 v[172:173], v19 offset:10240
    v_mfma_f32_32x32x16_bf16 a[48:63], v[164:167], v[100:103], a[48:63]
    ds_read_b64_tr_b16 v[174:175], v19 offset:10752
    v_mfma_f32_32x32x16_bf16 a[64:79], v[160:163], v[104:107], a[64:79]
    v_mfma_f32_32x32x16_bf16 a[80:95], v[164:167], v[104:107], a[80:95]
    v_mfma_f32_32x32x16_bf16 a[96:111], v[160:163], v[108:111], a[96:111]
    v_mfma_f32_32x32x16_bf16 a[112:127], v[164:167], v[108:111], a[112:127]
    s_waitcnt vmcnt(24)
    s_waitcnt lgkmcnt(2)
    v_mfma_f32_32x32x16_bf16 a[0:15], v[168:171], v[112:115], a[0:15]
    ds_read_b64_tr_b16 v[160:161], v18 offset:12288
    s_waitcnt lgkmcnt(1)
    v_mfma_f32_32x32x16_bf16 a[16:31], v[172:175], v[112:115], a[16:31]
    ds_read_b64_tr_b16 v[162:163], v18 offset:12800
    v_mfma_f32_32x32x16_bf16 a[32:47], v[168:171], v[116:119], a[32:47]
    ds_read_b64_tr_b16 v[164:165], v19 offset:12288
    v_mfma_f32_32x32x16_bf16 a[48:63], v[172:175], v[116:119], a[48:63]
    ds_read_b64_tr_b16 v[166:167], v19 offset:12800
    v_mfma_f32_32x32x16_bf16 a[64:79], v[168:171], v[120:123], a[64:79]
    v_mfma_f32_32x32x16_bf16 a[80:95], v[172:175], v[120:123], a[80:95]
    v_mfma_f32_32x32x16_bf16 a[96:111], v[168:171], v[124:127], a[96:111]
    v_mfma_f32_32x32x16_bf16 a[112:127], v[172:175], v[124:127], a[112:127]
    s_sub_u32 s56, s56, 1
    s_cmp_eq_u32 s56, 0
    s_waitcnt lgkmcnt(0)
    s_nop 8
    s_cbranch_scc1 od_83
    s_cmp_le_u32 s56, 3
    s_cselect_b32 s42, 0, s42
    s_cselect_b32 s46, 0, s46
    s_add_u32 m0, s63, 8192
    s_nop 0
    buffer_load_dwordx4 v12, s[44:47], s58 offen offset:0 lds
    buffer_load_dwordx4 v13, s[44:47], s58 offen offset:1024 lds
    buffer_load_dwordx4 v14, s[44:47], s58 offen offset:2048 lds
    buffer_load_dwordx4 v15, s[44:47], s58 offen offset:3072 lds
    buffer_load_dwordx4 v[96:99], v8, s[40:43], s54 offen offset:0
    buffer_load_dwordx4 v[100:103], v8, s[40:43], s54 offen offset:1024
    buffer_load_dwordx4 v[104:107], v8, s[40:43], s54 offen offset:2048
    buffer_load_dwordx4 v[108:111], v8, s[40:43], s54 offen offset:3072
    buffer_load_dwordx4 v[112:115], v8, s[40:43], s55 offen offset:0
    buffer_load_dwordx4 v[116:119], v8, s[40:43], s55 offen offset:1024
    buffer_load_dwordx4 v[120:123], v8, s[40:43], s55 offen offset:2048
    buffer_load_dwordx4 v[124:127], v8, s[40:43], s55 offen offset:3072
    s_add_u32 s54, s54, 131072
    s_add_u32 s55, s55, 131072
    s_add_u32 s58, s58, 40960
    v_mfma_f32_32x32x16_bf16 a[0:15], v[160:163], v[128:131], a[0:15]
    ds_read_b64_tr_b16 v[168:169], v18 offset:14336
    v_mfma_f32_32x32x16_bf16 a[16:31], v[164:167], v[128:131], a[16:31]
    ds_read_b64_tr_b16 v[170:171], v18 offset:14848
    v_mfma_f32_32x32x16_bf16 a[32:47], v[160:163], v[132:135], a[32:47]
    ds_read_b64_tr_b16 v[172:173], v19 offset:14336
    v_mfma_f32_32x32x16_bf16 a[48:63], v[164:167], v[132:135], a[48:63]
    ds_read_b64_tr_b16 v[174:175], v19 offset:14848
    v_mfma_f32_32x32x16_bf16 a[64:79], v[160:163], v[136:139], a[64:79]
    v_mfma_f32_32x32x16_bf16 a[80:95], v[164:167], v[136:139], a[80:95]
    v_mfma_f32_32x32x16_bf16 a[96:111], v[160:163], v[140:143], a[96:111]
    v_mfma_f32_32x32x16_bf16 a[112:127], v[164:167], v[140:143], a[112:127]
    s_waitcnt vmcnt(24)
    s_waitcnt lgkmcnt(2)
    v_mfma_f32_32x32x16_bf16 a[0:15], v[168:171], v[144:147], a[0:15]
    ds_read_b64_tr_b16 v[160:161], v18 offset:0
    s_waitcnt lgkmcnt(1)
    v_mfma_f32_32x32x16_bf16 a[16:31], v[172:175], v[144:147], a[16:31]
    ds_read_b64_tr_b16 v[162:163], v18 offset:512
    v_mfma_f32_32x32x16_bf16 a[32:47], v[168:171], v[148:151], a[32:47]
    ds_read_b64_tr_b16 v[164:165], v19 offset:0
    v_mfma_f32_32x32x16_bf16 a[48:63], v[172:175], v[148:151], a[48:63]
    ds_read_b64_tr_b16 v[166:167], v19 offset:512
    v_mfma_f32_32x32x16_bf16 a[64:79], v[168:171], v[152:155], a[64:79]
    v_mfma_f32_32x32x16_bf16 a[80:95], v[172:175], v[152:155], a[80:95]
    v_mfma_f32_32x32x16_bf16 a[96:111], v[168:171], v[156:159], a[96:111]
    v_mfma_f32_32x32x16_bf16 a[112:127], v[172:175], v[156:159], a[112:127]
    s_sub_u32 s56, s56, 1
    s_cmp_eq_u32 s56, 0
    s_waitcnt lgkmcnt(0)
    s_nop 8
    s_cbranch_scc1 od_83
    s_branch ol_82
od_83:
    s_waitcnt vmcnt(0) lgkmcnt(0)
    s_nop 15
    v_lshlrev_b32 v2, 4, v1
    v_add_u32 v3, s63, v2
    ds_write_b128 v3, a[0:3] offset:0
    ds_write_b128 v3, a[4:7] offset:1024
    ds_write_b128 v3, a[8:11] offset:2048
    ds_write_b128 v3, a[12:15] offset:3072
    ds_write_b128 v3, a[16:19] offset:4096
    ds_write_b128 v3, a[20:23] offset:5120
    ds_write_b128 v3, a[24:27] offset:6144
    ds_write_b128 v3, a[28:31] offset:7168
    s_waitcnt lgkmcnt(0)
    ds_write_b128 v3, a[32:35] offset:8192
    ds_write_b128 v3, a[36:39] offset:9216
    ds_write_b128 v3, a[40:43] offset:10240
    ds_write_b128 v3, a[44:47] offset:11264
    ds_write_b128 v3, a[48:51] offset:12288
    ds_write_b128 v3, a[52:55] offset:13312
    ds_write_b128 v3, a[56:59] offset:14336
    ds_write_b128 v3, a[60:63] offset:15360
    s_waitcnt lgkmcnt(0)
    ds_write_b128 v3, a[64:67] offset:16384
    ds_write_b128 v3, a[68:71] offset:17408
    ds_write_b128 v3, a[72:75] offset:18432
    ds_write_b128 v3, a[76:79] offset:19456
    ds_write_b128 v3, a[80:83] offset:20480
    ds_write_b128 v3, a[84:87] offset:21504
    ds_write_b128 v3, a[88:91] offset:22528
    ds_write_b128 v3, a[92:95] offset:23552
    s_waitcnt lgkmcnt(0)
    ds_write_b128 v3, a[96:99] offset:24576
    ds_write_b128 v3, a[100:103] offset:25600
    ds_write_b128 v3, a[104:107] offset:26624
    ds_write_b128 v3, a[108:111] offset:27648
    ds_write_b128 v3, a[112:115] offset:28672
    ds_write_b128 v3, a[116:119] offset:29696
    ds_write_b128 v3, a[120:123] offset:30720
    ds_write_b128 v3, a[124:127] offset:31744
    s_waitcnt lgkmcnt(0)
    s_barrier
    s_lshl_b32 s60, s57, 13
    v_add_u32 v3, s60, v2
    v_add_u32 v4, 0x10000, v3
    ds_read_b128 v[32:35], v3 offset:0
    ds_read_b128 v[36:39], v3 offset:1024
    ds_read_b128 v[40:43], v3 offset:2048
    ds_read_b128 v[44:47], v3 offset:3072
    ds_read_b128 v[48:51], v3 offset:4096
    ds_read_b128 v[52:55], v3 offset:5120
    ds_read_b128 v[56:59], v3 offset:6144
    ds_read_b128 v[60:63], v3 offset:7168
    s_waitcnt lgkmcnt(0)
    ds_read_b128 v[64:67], v3 offset:32768
    ds_read_b128 v[68:71], v3 offset:33792
    ds_read_b128 v[72:75], v3 offset:34816
    ds_read_b128 v[76:79], v3 offset:35840
    ds_read_b128 v[80:83], v3 offset:36864
    ds_read_b128 v[84:87], v3 offset:37888
    ds_read_b128 v[88:91], v3 offset:38912
    ds_read_b128 v[92:95], v3 offset:39936
    s_waitcnt lgkmcnt(7)
    v_add_f32 v32, v32, v64
    v_add_f32 v33, v33, v65
    v_add_f32 v34, v34, v66
    v_add_f32 v35, v35, v67
    s_waitcnt lgkmcnt(6)
    v_add_f32 v36, v36, v68
    v_add_f32 v37, v37, v69
    v_add_f32 v38, v38, v70
    v_add_f32 v39, v39, v71
    s_waitcnt lgkmcnt(5)
    v_add_f32 v40, v40, v72
    v_add_f32 v41, v41, v73
    v_add_f32 v42, v42, v74
    v_add_f32 v43, v43, v75
    s_waitcnt lgkmcnt(4)
    v_add_f32 v44, v44, v76
    v_add_f32 v45, v45, v77
    v_add_f32 v46, v46, v78
    v_add_f32 v47, v47, v79
    s_waitcnt lgkmcnt(3)
    v_add_f32 v48, v48, v80
    v_add_f32 v49, v49, v81
    v_add_f32 v50, v50, v82
    v_add_f32 v51, v51, v83
    s_waitcnt lgkmcnt(2)
    v_add_f32 v52, v52, v84
    v_add_f32 v53, v53, v85
    v_add_f32 v54, v54, v86
    v_add_f32 v55, v55, v87
    s_waitcnt lgkmcnt(1)
    v_add_f32 v56, v56, v88
    v_add_f32 v57, v57, v89
    v_add_f32 v58, v58, v90
    v_add_f32 v59, v59, v91
    s_waitcnt lgkmcnt(0)
    v_add_f32 v60, v60, v92
    v_add_f32 v61, v61, v93
    v_add_f32 v62, v62, v94
    v_add_f32 v63, v63, v95
    ds_read_b128 v[96:99], v4 offset:0
    ds_read_b128 v[100:103], v4 offset:1024
    ds_read_b128 v[104:107], v4 offset:2048
    ds_read_b128 v[108:111], v4 offset:3072
    ds_read_b128 v[112:115], v4 offset:4096
    ds_read_b128 v[116:119], v4 offset:5120
    ds_read_b128 v[120:123], v4 offset:6144
    ds_read_b128 v[124:127], v4 offset:7168
    s_waitcnt lgkmcnt(0)
    ds_read_b128 v[128:131], v4 offset:32768
    ds_read_b128 v[132:135], v4 offset:33792
    ds_read_b128 v[136:139], v4 offset:34816
    ds_read_b128 v[140:143], v4 offset:35840
    ds_read_b128 v[144:147], v4 offset:36864
    ds_read_b128 v[148:151], v4 offset:37888
    ds_read_b128 v[152:155], v4 offset:38912
    ds_read_b128 v[156:159], v4 offset:39936
    s_waitcnt lgkmcnt(7)
    v_add_f32 v96, v96, v128
    v_add_f32 v97, v97, v129
    v_add_f32 v98, v98, v130
    v_add_f32 v99, v99, v131
    s_waitcnt lgkmcnt(6)
    v_add_f32 v100, v100, v132
    v_add_f32 v101, v101, v133
    v_add_f32 v102, v102, v134
    v_add_f32 v103, v103, v135
    s_waitcnt lgkmcnt(5)
    v_add_f32 v104, v104, v136
    v_add_f32 v105, v105, v137
    v_add_f32 v106, v106, v138
    v_add_f32 v107, v107, v139
    s_waitcnt lgkmcnt(4)
    v_add_f32 v108, v108, v140
    v_add_f32 v109, v109, v141
    v_add_f32 v110, v110, v142
    v_add_f32 v111, v111, v143
    s_waitcnt lgkmcnt(3)
    v_add_f32 v112, v112, v144
    v_add_f32 v113, v113, v145
    v_add_f32 v114, v114, v146
    v_add_f32 v115, v115, v147
    s_waitcnt lgkmcnt(2)
    v_add_f32 v116, v116, v148
    v_add_f32 v117, v117, v149
    v_add_f32 v118, v118, v150
    v_add_f32 v119, v119, v151
    s_waitcnt lgkmcnt(1)
    v_add_f32 v120, v120, v152
    v_add_f32 v121, v121, v153
    v_add_f32 v122, v122, v154
    v_add_f32 v123, v123, v155
    s_waitcnt lgkmcnt(0)
    v_add_f32 v124, v124, v156
    v_add_f32 v125, v125, v157
    v_add_f32 v126, v126, v158
    v_add_f32 v127, v127, v159
    v_add_f32 v32, v32, v96
    v_add_f32 v33, v33, v97
    v_add_f32 v34, v34, v98
    v_add_f32 v35, v35, v99
    v_add_f32 v36, v36, v100
    v_add_f32 v37, v37, v101
    v_add_f32 v38, v38, v102
    v_add_f32 v39, v39, v103
    v_add_f32 v40, v40, v104
    v_add_f32 v41, v41, v105
    v_add_f32 v42, v42, v106
    v_add_f32 v43, v43, v107
    v_add_f32 v44, v44, v108
    v_add_f32 v45, v45, v109
    v_add_f32 v46, v46, v110
    v_add_f32 v47, v47, v111
    v_add_f32 v48, v48, v112
    v_add_f32 v49, v49, v113
    v_add_f32 v50, v50, v114
    v_add_f32 v51, v51, v115
    v_add_f32 v52, v52, v116
    v_add_f32 v53, v53, v117
    v_add_f32 v54, v54, v118
    v_add_f32 v55, v55, v119
    v_add_f32 v56, v56, v120
    v_add_f32 v57, v57, v121
    v_add_f32 v58, v58, v122
    v_add_f32 v59, v59, v123
    v_add_f32 v60, v60, v124
    v_add_f32 v61, v61, v125
    v_add_f32 v62, v62, v126
    v_add_f32 v63, v63, v127
    s_mov_b32 s48, s34
    s_mov_b32 s49, s35
    s_and_b32 s49, s49, 0xffff
    s_mov_b32 s50, 5242880
    s_mov_b32 s51, 0x00020000
    v_and_b32 v2, 31, v1
    s_lshl_b32 s60, s57, 5
    s_add_u32 s60, s60, s52
    v_add_u32 v2, s60, v2
    v_mul_u32_u24 v2, 2560, v2
    v_lshrrev_b32 v3, 5, v1
    v_lshlrev_b32 v3, 3, v3
    s_lshl_b32 s60, s53, 1
    s_add_u32 s60, s60, 0
    v_add3_u32 v2, v2, v3, s60
    v_cvt_pk_bf16_f32 v176, v32, v33
    v_cvt_pk_bf16_f32 v177, v34, v35
    buffer_store_dwordx2 v[176:177], v2, s[48:51], 0 offen offset:0
    v_cvt_pk_bf16_f32 v178, v36, v37
    v_cvt_pk_bf16_f32 v179, v38, v39
    buffer_store_dwordx2 v[178:179], v2, s[48:51], 0 offen offset:16
    v_cvt_pk_bf16_f32 v180, v40, v41
    v_cvt_pk_bf16_f32 v181, v42, v43
    buffer_store_dwordx2 v[180:181], v2, s[48:51], 0 offen offset:32
    v_cvt_pk_bf16_f32 v182, v44, v45
    v_cvt_pk_bf16_f32 v183, v46, v47
    buffer_store_dwordx2 v[182:183], v2, s[48:51], 0 offen offset:48
    v_cvt_pk_bf16_f32 v184, v48, v49
    v_cvt_pk_bf16_f32 v185, v50, v51
    buffer_store_dwordx2 v[184:185], v2, s[48:51], 0 offen offset:64
    v_cvt_pk_bf16_f32 v186, v52, v53
    v_cvt_pk_bf16_f32 v187, v54, v55
    buffer_store_dwordx2 v[186:187], v2, s[48:51], 0 offen offset:80
    v_cvt_pk_bf16_f32 v188, v56, v57
    v_cvt_pk_bf16_f32 v189, v58, v59
    buffer_store_dwordx2 v[188:189], v2, s[48:51], 0 offen offset:96
    v_cvt_pk_bf16_f32 v190, v60, v61
    v_cvt_pk_bf16_f32 v191, v62, v63
    buffer_store_dwordx2 v[190:191], v2, s[48:51], 0 offen offset:112
    s_endpgm
oend_78:
    s_endpgm
.section .rodata,"a"
.p2align 6
.amdhsa_kernel proj_kernel
  .amdhsa_next_free_vgpr 240
  .amdhsa_next_free_sgpr 102
  .amdhsa_accum_offset 240
  .amdhsa_group_segment_fixed_size 0
  .amdhsa_kernarg_size 96
  .amdhsa_user_sgpr_count 2
  .amdhsa_user_sgpr_kernarg_segment_ptr 1
  .amdhsa_system_sgpr_workgroup_id_x 1
.end_amdhsa_kernel
.section .rodata,"a"
.p2align 6
.amdhsa_kernel attn_kernel
  .amdhsa_next_free_vgpr 256
  .amdhsa_next_free_sgpr 102
  .amdhsa_accum_offset 256
  .amdhsa_group_segment_fixed_size 0
  .amdhsa_kernarg_size 96
  .amdhsa_user_sgpr_count 2
  .amdhsa_user_sgpr_kernarg_segment_ptr 1
  .amdhsa_system_sgpr_workgroup_id_x 1
.end_amdhsa_kernel
.section .rodata,"a"
.p2align 6
.amdhsa_kernel outp_kernel
  .amdhsa_next_free_vgpr 384
  .amdhsa_next_free_sgpr 102
  .amdhsa_accum_offset 256
  .amdhsa_group_segment_fixed_size 0
  .amdhsa_kernarg_size 96
  .amdhsa_user_sgpr_count 2
  .amdhsa_user_sgpr_kernarg_segment_ptr 1
  .amdhsa_system_sgpr_workgroup_id_x 1
.end_amdhsa_kernel
```
